```python
import torch

def _softmax(x, axis=-1):
    return torch.softmax(x, dim=axis)

def _gelu(x):
    return torch.nn.functional.gelu(x, approximate='tanh')

def _silu(x):
    return torch.nn.functional.silu(x)

def _sigmoid(x):
    return torch.sigmoid(x)

def _layernorm(x, axis=-1, eps=1e-05):
    m = x.mean(dim=axis, keepdim=True)
    v = x.var(dim=axis, keepdim=True, unbiased=False)
    return (x - m) / torch.sqrt(v + eps)

def _scatter_add(tgt, idx, src, axis=0):
    return tgt.clone().index_add_(axis, idx, src)

def _segment_sum(src, seg, n):
    out = torch.zeros((n,) + src.shape[1:], dtype=src.dtype)
    return out.index_add_(0, seg, src)

def _pad(x, pw):
    flat = tuple((v for pair in reversed(pw) for v in pair))
    return torch.nn.functional.pad(x, flat)
kernel_name = 'sequential_preLN__sliding_block__mixer_gmlp__prompt'

def setup_inputs():

    _w = lambda a: (lambda t: t.to(torch.bfloat16) if t.is_floating_point() else t)(torch.as_tensor(a))

    def _A_setup():
        B, S, D = (1, 2048, 1024)
        return {'x': _w((lambda *s: torch.randn(*s, dtype=torch.bfloat16) * 0.05)(B, S, D)), 'wqkv': _w((lambda *s: torch.randn(*s, dtype=torch.bfloat16) * 0.05)(D, 3 * D)), 'wo': _w((lambda *s: torch.randn(*s, dtype=torch.bfloat16) * 0.05)(D, D))}
    _A_in = _A_setup()

    def _B_setup():
        B, S, D, F = (1, 2048, 1024, 3584)
        Fh = F // 2
        return {'x': _w((lambda *s: torch.randn(*s, dtype=torch.bfloat16) * 0.05)(B, S, D)), 'w_in': _w((lambda *s: torch.randn(*s, dtype=torch.bfloat16) * 0.8)(D, 2 * Fh)), 'w_sp': _w(0.01 * (lambda *s: torch.randn(*s, dtype=torch.bfloat16) * 0.8)(S, S)), 'b_sp': _w(1.0 + 0.01 * (lambda *s: torch.randn(*s, dtype=torch.bfloat16) * 0.05)(S)), 'w_out': _w((lambda *s: torch.randn(*s, dtype=torch.bfloat16) * 0.05)(Fh, D))}
    _B_in = _B_setup()
    return {'A_x': _A_in['x'], 'A_wqkv': _A_in['wqkv'], 'A_wo': _A_in['wo'], 'B_x': _B_in['x'], 'B_w_in': _B_in['w_in'], 'B_w_sp': _B_in['w_sp'], 'B_b_sp': _B_in['b_sp'], 'B_w_out': _B_in['w_out']}

def reference(A_x, A_wqkv, A_wo, B_x, B_w_in, B_w_sp, B_b_sp, B_w_out):

    def _A_ref(x, wqkv, wo):
        B, S, D = x.shape
        H = 32
        Dh = D // H
        W = 256
        qkv = (lambda x, *d: x.permute(*d))((x @ wqkv).reshape(B, S, 3, H, Dh), 2, 0, 3, 1, 4)
        q, k, v = (qkv[0], qkv[1], qkv[2])
        scores = torch.einsum('bhqd,bhkd->bhqk', q, k) * Dh ** (-0.5)
        idx = torch.arange(S)
        mask = (idx[:, None] - idx[None, :] >= 0) & (idx[:, None] - idx[None, :] < W)
        scores = torch.where(mask[None, None], scores, -1000000000.0)
        p = _softmax(scores, axis=-1)
        o = torch.einsum('bhqk,bhkd->bhqd', p, v)
        return (lambda x, *d: x.permute(*d))(o, 0, 2, 1, 3).reshape(B, S, D) @ wo

    def _B_ref(x, w_in, w_sp, b_sp, w_out):
        B, S, D = x.shape
        F = w_in.shape[-1]
        Fh = F // 2
        z = _gelu(torch.einsum('bsd,df->bsf', x, w_in))
        z1 = z[..., :Fh].clone()
        z2 = _layernorm(z[..., Fh:], axis=-1)
        g = torch.einsum('ts,bsf->btf', w_sp, z2) + b_sp[None, :, None]
        return torch.einsum('bsf,fd->bsd', z1 * g, w_out)
    x = A_x
    h = x + _A_ref(_layernorm(x, axis=-1), A_wqkv, A_wo)
    h2 = h + _B_ref(_layernorm(h, axis=-1), B_w_in, B_w_sp, B_b_sp, B_w_out)
    return h2
```

```asm
; @launch grid=(256,1,1) block=(512,1,1) lds=163840
.amdgcn_target "amdgcn-amd-amdhsa--gfx950"
.text
.globl sequential_preLN__sliding_block__mixer_gmlp__prompt_kernel
.p2align 8
.type sequential_preLN__sliding_block__mixer_gmlp__prompt_kernel,@function
sequential_preLN__sliding_block__mixer_gmlp__prompt_kernel:
    s_cmp_ge_u32 s2, 256
    s_cbranch_scc1 L_end
    s_load_dwordx16 s[64:79], s[0:1], 0
    s_load_dwordx4 s[80:83], s[0:1], 64
    s_load_dwordx2 s[84:85], s[0:1], 80
    v_lshrrev_b32 v1, 6, v0
    v_and_b32 v0, 63, v0
    v_readfirstlane_b32 s3, v1
    s_and_b32 s6, s2, 7
    s_lshr_b32 s7, s2, 3
    s_lshr_b32 s4, s6, 1
    s_lshl_b32 s4, s4, 2
    s_and_b32 s28, s7, 3
    s_add_u32 s4, s4, s28
    s_and_b32 s5, s6, 1
    s_mul_i32 s5, s5, 8
    s_lshr_b32 s28, s7, 2
    s_add_u32 s5, s5, s28
    s_xor_b32 s5, s5, 0
    v_and_b32 v1, 15, v0
    v_lshrrev_b32 v2, 4, v0
    s_mov_b32 s37, 1000000
    v_mov_b32 v254, 155648
    s_sub_u32 s29, s3, 4
    s_waitcnt lgkmcnt(0)
    s_add_u32 s60, s84, 59801600
    s_addc_u32 s61, s85, 0
    s_mov_b32 s62, 65536
    s_mov_b32 s63, 0x20000
    s_cmp_lt_u32 s3, 4
    s_cbranch_scc1 L_cq
    s_mul_i32 s6, s4, 262144
    s_add_u32 s8, s64, 0
    s_addc_u32 s9, s65, 0
    s_add_u32 s8, s8, s6
    s_addc_u32 s9, s9, 0
    s_mov_b32 s10, 262144
    s_mov_b32 s11, 0x20000
    s_mul_i32 s6, s5, 128
    s_add_u32 s12, s66, 0
    s_addc_u32 s13, s67, 0
    s_add_u32 s12, s12, s6
    s_addc_u32 s13, s13, 0
    s_mov_b32 s14, 6291456
    s_mov_b32 s15, 0x20000
    s_sub_u32 s14, s14, s6
    v_lshrrev_b32 v3, 3, v0
    s_lshl_b32 s6, s29, 3
    v_add_u32 v3, s6, v3
    v_lshrrev_b32 v4, 1, v3
    v_xor_b32 v4, v4, v0
    v_and_b32 v4, 7, v4
    v_lshlrev_b32 v4, 4, v4
    s_mov_b32 s6, 2048
    v_mad_u32_u24 v4, v3, s6, v4
    v_add_u32 v5, 65536, v4
    v_add_u32 v6, 131072, v4
    v_add_u32 v7, 196608, v4
    s_lshl_b32 s6, s29, 6
    s_add_u32 s6, s6, 0
    v_add_u32 v3, s6, v0
    s_mov_b32 s6, 2731
    v_mul_u32_u24 v20, s6, v3
    v_lshrrev_b32 v20, 16, v20
    v_mul_u32_u24 v21, 24, v20
    v_sub_u32 v21, v3, v21
    v_bfe_u32 v22, v20, 3, 1
    v_bfe_u32 v23, v20, 1, 1
    v_lshl_add_u32 v22, v22, 1, v23
    v_lshlrev_b32 v22, 1, v22
    v_xor_b32 v21, v21, v22
    v_mov_b32 v22, 0
    v_cmp_le_u32 vcc, 4, v21
    v_mov_b32 v23, 1984
    s_nop 0
    v_cndmask_b32 v22, v22, v23, vcc
    v_cmp_le_u32 vcc, 8, v21
    v_mov_b32 v23, 3968
    s_nop 0
    v_cndmask_b32 v22, v22, v23, vcc
    v_cmp_le_u32 vcc, 12, v21
    v_mov_b32 v23, -128
    s_nop 0
    v_cndmask_b32 v22, v22, v23, vcc
    v_cmp_le_u32 vcc, 16, v21
    v_mov_b32 v23, 1856
    s_nop 0
    v_cndmask_b32 v22, v22, v23, vcc
    v_cmp_le_u32 vcc, 20, v21
    v_mov_b32 v23, 3840
    s_nop 0
    v_cndmask_b32 v22, v22, v23, vcc
    v_lshl_add_u32 v21, v21, 4, v22
    s_mov_b32 s6, 6144
    v_mad_u32_u24 v8, v20, s6, v21
    s_lshl_b32 s6, s29, 6
    s_add_u32 s6, s6, 256
    v_add_u32 v3, s6, v0
    s_mov_b32 s6, 2731
    v_mul_u32_u24 v20, s6, v3
    v_lshrrev_b32 v20, 16, v20
    v_mul_u32_u24 v21, 24, v20
    v_sub_u32 v21, v3, v21
    v_bfe_u32 v22, v20, 3, 1
    v_bfe_u32 v23, v20, 1, 1
    v_lshl_add_u32 v22, v22, 1, v23
    v_lshlrev_b32 v22, 1, v22
    v_xor_b32 v21, v21, v22
    v_mov_b32 v22, 0
    v_cmp_le_u32 vcc, 4, v21
    v_mov_b32 v23, 1984
    s_nop 0
    v_cndmask_b32 v22, v22, v23, vcc
    v_cmp_le_u32 vcc, 8, v21
    v_mov_b32 v23, 3968
    s_nop 0
    v_cndmask_b32 v22, v22, v23, vcc
    v_cmp_le_u32 vcc, 12, v21
    v_mov_b32 v23, -128
    s_nop 0
    v_cndmask_b32 v22, v22, v23, vcc
    v_cmp_le_u32 vcc, 16, v21
    v_mov_b32 v23, 1856
    s_nop 0
    v_cndmask_b32 v22, v22, v23, vcc
    v_cmp_le_u32 vcc, 20, v21
    v_mov_b32 v23, 3840
    s_nop 0
    v_cndmask_b32 v22, v22, v23, vcc
    v_lshl_add_u32 v21, v21, 4, v22
    s_mov_b32 s6, 6144
    v_mad_u32_u24 v9, v20, s6, v21
    s_lshl_b32 s6, s29, 6
    s_add_u32 s6, s6, 512
    v_add_u32 v3, s6, v0
    s_mov_b32 s6, 2731
    v_mul_u32_u24 v20, s6, v3
    v_lshrrev_b32 v20, 16, v20
    v_mul_u32_u24 v21, 24, v20
    v_sub_u32 v21, v3, v21
    v_bfe_u32 v22, v20, 3, 1
    v_bfe_u32 v23, v20, 1, 1
    v_lshl_add_u32 v22, v22, 1, v23
    v_lshlrev_b32 v22, 1, v22
    v_xor_b32 v21, v21, v22
    v_mov_b32 v22, 0
    v_cmp_le_u32 vcc, 4, v21
    v_mov_b32 v23, 1984
    s_nop 0
    v_cndmask_b32 v22, v22, v23, vcc
    v_cmp_le_u32 vcc, 8, v21
    v_mov_b32 v23, 3968
    s_nop 0
    v_cndmask_b32 v22, v22, v23, vcc
    v_cmp_le_u32 vcc, 12, v21
    v_mov_b32 v23, -128
    s_nop 0
    v_cndmask_b32 v22, v22, v23, vcc
    v_cmp_le_u32 vcc, 16, v21
    v_mov_b32 v23, 1856
    s_nop 0
    v_cndmask_b32 v22, v22, v23, vcc
    v_cmp_le_u32 vcc, 20, v21
    v_mov_b32 v23, 3840
    s_nop 0
    v_cndmask_b32 v22, v22, v23, vcc
    v_lshl_add_u32 v21, v21, 4, v22
    s_mov_b32 s6, 6144
    v_mad_u32_u24 v10, v20, s6, v21
    s_lshl_b32 s6, s29, 6
    s_add_u32 s6, s6, 768
    v_add_u32 v3, s6, v0
    s_mov_b32 s6, 2731
    v_mul_u32_u24 v20, s6, v3
    v_lshrrev_b32 v20, 16, v20
    v_mul_u32_u24 v21, 24, v20
    v_sub_u32 v21, v3, v21
    v_bfe_u32 v22, v20, 3, 1
    v_bfe_u32 v23, v20, 1, 1
    v_lshl_add_u32 v22, v22, 1, v23
    v_lshlrev_b32 v22, 1, v22
    v_xor_b32 v21, v21, v22
    v_mov_b32 v22, 0
    v_cmp_le_u32 vcc, 4, v21
    v_mov_b32 v23, 1984
    s_nop 0
    v_cndmask_b32 v22, v22, v23, vcc
    v_cmp_le_u32 vcc, 8, v21
    v_mov_b32 v23, 3968
    s_nop 0
    v_cndmask_b32 v22, v22, v23, vcc
    v_cmp_le_u32 vcc, 12, v21
    v_mov_b32 v23, -128
    s_nop 0
    v_cndmask_b32 v22, v22, v23, vcc
    v_cmp_le_u32 vcc, 16, v21
    v_mov_b32 v23, 1856
    s_nop 0
    v_cndmask_b32 v22, v22, v23, vcc
    v_cmp_le_u32 vcc, 20, v21
    v_mov_b32 v23, 3840
    s_nop 0
    v_cndmask_b32 v22, v22, v23, vcc
    v_lshl_add_u32 v21, v21, 4, v22
    s_mov_b32 s6, 6144
    v_mad_u32_u24 v11, v20, s6, v21
    s_lshl_b32 s6, s29, 6
    s_add_u32 s6, s6, 1024
    v_add_u32 v3, s6, v0
    s_mov_b32 s6, 2731
    v_mul_u32_u24 v20, s6, v3
    v_lshrrev_b32 v20, 16, v20
    v_mul_u32_u24 v21, 24, v20
    v_sub_u32 v21, v3, v21
    v_bfe_u32 v22, v20, 3, 1
    v_bfe_u32 v23, v20, 1, 1
    v_lshl_add_u32 v22, v22, 1, v23
    v_lshlrev_b32 v22, 1, v22
    v_xor_b32 v21, v21, v22
    v_mov_b32 v22, 0
    v_cmp_le_u32 vcc, 4, v21
    v_mov_b32 v23, 1984
    s_nop 0
    v_cndmask_b32 v22, v22, v23, vcc
    v_cmp_le_u32 vcc, 8, v21
    v_mov_b32 v23, 3968
    s_nop 0
    v_cndmask_b32 v22, v22, v23, vcc
    v_cmp_le_u32 vcc, 12, v21
    v_mov_b32 v23, -128
    s_nop 0
    v_cndmask_b32 v22, v22, v23, vcc
    v_cmp_le_u32 vcc, 16, v21
    v_mov_b32 v23, 1856
    s_nop 0
    v_cndmask_b32 v22, v22, v23, vcc
    v_cmp_le_u32 vcc, 20, v21
    v_mov_b32 v23, 3840
    s_nop 0
    v_cndmask_b32 v22, v22, v23, vcc
    v_lshl_add_u32 v21, v21, 4, v22
    s_mov_b32 s6, 6144
    v_mad_u32_u24 v12, v20, s6, v21
    s_lshl_b32 s6, s29, 6
    s_add_u32 s6, s6, 1280
    v_add_u32 v3, s6, v0
    s_mov_b32 s6, 2731
    v_mul_u32_u24 v20, s6, v3
    v_lshrrev_b32 v20, 16, v20
    v_mul_u32_u24 v21, 24, v20
    v_sub_u32 v21, v3, v21
    v_bfe_u32 v22, v20, 3, 1
    v_bfe_u32 v23, v20, 1, 1
    v_lshl_add_u32 v22, v22, 1, v23
    v_lshlrev_b32 v22, 1, v22
    v_xor_b32 v21, v21, v22
    v_mov_b32 v22, 0
    v_cmp_le_u32 vcc, 4, v21
    v_mov_b32 v23, 1984
    s_nop 0
    v_cndmask_b32 v22, v22, v23, vcc
    v_cmp_le_u32 vcc, 8, v21
    v_mov_b32 v23, 3968
    s_nop 0
    v_cndmask_b32 v22, v22, v23, vcc
    v_cmp_le_u32 vcc, 12, v21
    v_mov_b32 v23, -128
    s_nop 0
    v_cndmask_b32 v22, v22, v23, vcc
    v_cmp_le_u32 vcc, 16, v21
    v_mov_b32 v23, 1856
    s_nop 0
    v_cndmask_b32 v22, v22, v23, vcc
    v_cmp_le_u32 vcc, 20, v21
    v_mov_b32 v23, 3840
    s_nop 0
    v_cndmask_b32 v22, v22, v23, vcc
    v_lshl_add_u32 v21, v21, 4, v22
    s_mov_b32 s6, 6144
    v_mad_u32_u24 v13, v20, s6, v21
    s_lshl_b32 s32, s29, 10
    s_mov_b32 s33, 0
    s_mov_b32 s34, 0
    s_add_u32 s35, s32, 163840
L_qlda:
    s_add_u32 m0, s32, 0
    s_nop 0
    buffer_load_dwordx4 v4, s[8:11], s33 offen lds
    s_add_u32 m0, s32, 4096
    s_nop 0
    buffer_load_dwordx4 v5, s[8:11], s33 offen lds
    s_add_u32 m0, s32, 8192
    s_nop 0
    buffer_load_dwordx4 v6, s[8:11], s33 offen lds
    s_add_u32 m0, s32, 12288
    s_nop 0
    buffer_load_dwordx4 v7, s[8:11], s33 offen lds
    s_add_u32 s33, s33, 128
    s_add_u32 m0, s32, 16384
    s_nop 0
    buffer_load_dwordx4 v8, s[12:15], s34 offen lds
    s_add_u32 m0, s32, 20480
    s_nop 0
    buffer_load_dwordx4 v9, s[12:15], s34 offen lds
    s_add_u32 m0, s32, 24576
    s_nop 0
    buffer_load_dwordx4 v10, s[12:15], s34 offen lds
    s_add_u32 m0, s32, 28672
    s_nop 0
    buffer_load_dwordx4 v11, s[12:15], s34 offen lds
    s_add_u32 m0, s32, 32768
    s_nop 0
    buffer_load_dwordx4 v12, s[12:15], s34 offen lds
    s_add_u32 m0, s32, 36864
    s_nop 0
    buffer_load_dwordx4 v13, s[12:15], s34 offen lds
    s_add_u32 s34, s34, 393216
    s_add_u32 m0, s32, 40960
    s_nop 0
    buffer_load_dwordx4 v4, s[8:11], s33 offen lds
    s_add_u32 m0, s32, 45056
    s_nop 0
    buffer_load_dwordx4 v5, s[8:11], s33 offen lds
    s_add_u32 m0, s32, 49152
    s_nop 0
    buffer_load_dwordx4 v6, s[8:11], s33 offen lds
    s_add_u32 m0, s32, 53248
    s_nop 0
    buffer_load_dwordx4 v7, s[8:11], s33 offen lds
    s_add_u32 s33, s33, 128
    s_add_u32 m0, s32, 57344
    s_nop 0
    buffer_load_dwordx4 v8, s[12:15], s34 offen lds
    s_add_u32 m0, s32, 61440
    s_nop 0
    buffer_load_dwordx4 v9, s[12:15], s34 offen lds
    s_add_u32 m0, s32, 65536
    s_nop 0
    buffer_load_dwordx4 v10, s[12:15], s34 offen lds
    s_add_u32 m0, s32, 69632
    s_nop 0
    buffer_load_dwordx4 v11, s[12:15], s34 offen lds
    s_add_u32 m0, s32, 73728
    s_nop 0
    buffer_load_dwordx4 v12, s[12:15], s34 offen lds
    s_add_u32 m0, s32, 77824
    s_nop 0
    buffer_load_dwordx4 v13, s[12:15], s34 offen lds
    s_add_u32 s34, s34, 393216
    s_add_u32 m0, s32, 81920
    s_nop 0
    buffer_load_dwordx4 v4, s[8:11], s33 offen lds
    s_add_u32 m0, s32, 86016
    s_nop 0
    buffer_load_dwordx4 v5, s[8:11], s33 offen lds
    s_add_u32 m0, s32, 90112
    s_nop 0
    buffer_load_dwordx4 v6, s[8:11], s33 offen lds
    s_add_u32 m0, s32, 94208
    s_nop 0
    buffer_load_dwordx4 v7, s[8:11], s33 offen lds
    s_add_u32 s33, s33, 128
    s_add_u32 m0, s32, 98304
    s_nop 0
    buffer_load_dwordx4 v8, s[12:15], s34 offen lds
    s_add_u32 m0, s32, 102400
    s_nop 0
    buffer_load_dwordx4 v9, s[12:15], s34 offen lds
    s_add_u32 m0, s32, 106496
    s_nop 0
    buffer_load_dwordx4 v10, s[12:15], s34 offen lds
    s_add_u32 m0, s32, 110592
    s_nop 0
    buffer_load_dwordx4 v11, s[12:15], s34 offen lds
    s_add_u32 m0, s32, 114688
    s_nop 0
    buffer_load_dwordx4 v12, s[12:15], s34 offen lds
    s_add_u32 m0, s32, 118784
    s_nop 0
    buffer_load_dwordx4 v13, s[12:15], s34 offen lds
    s_add_u32 s34, s34, 393216
    s_add_u32 s32, s32, 122880
    s_waitcnt vmcnt(20)
    s_barrier
    s_add_u32 m0, s32, 0
    s_nop 0
    buffer_load_dwordx4 v4, s[8:11], s33 offen lds
    s_add_u32 m0, s32, 4096
    s_nop 0
    buffer_load_dwordx4 v5, s[8:11], s33 offen lds
    s_add_u32 m0, s32, 8192
    s_nop 0
    buffer_load_dwordx4 v6, s[8:11], s33 offen lds
    s_add_u32 m0, s32, 12288
    s_nop 0
    buffer_load_dwordx4 v7, s[8:11], s33 offen lds
    s_add_u32 s33, s33, 128
    s_add_u32 m0, s32, 16384
    s_nop 0
    buffer_load_dwordx4 v8, s[12:15], s34 offen lds
    s_add_u32 m0, s32, 20480
    s_nop 0
    buffer_load_dwordx4 v9, s[12:15], s34 offen lds
    s_add_u32 m0, s32, 24576
    s_nop 0
    buffer_load_dwordx4 v10, s[12:15], s34 offen lds
    s_add_u32 m0, s32, 28672
    s_nop 0
    buffer_load_dwordx4 v11, s[12:15], s34 offen lds
    s_add_u32 m0, s32, 32768
    s_nop 0
    buffer_load_dwordx4 v12, s[12:15], s34 offen lds
    s_add_u32 m0, s32, 36864
    s_nop 0
    buffer_load_dwordx4 v13, s[12:15], s34 offen lds
    s_add_u32 s34, s34, 393216
    s_add_u32 s32, s32, 40960
    s_cmp_ge_u32 s32, s35
    s_cselect_b32 s6, 163840, 0
    s_sub_u32 s32, s32, s6
    s_waitcnt vmcnt(20)
    s_barrier
    s_add_u32 m0, s32, 0
    s_nop 0
    buffer_load_dwordx4 v4, s[8:11], s33 offen lds
    s_add_u32 m0, s32, 4096
    s_nop 0
    buffer_load_dwordx4 v5, s[8:11], s33 offen lds
    s_add_u32 m0, s32, 8192
    s_nop 0
    buffer_load_dwordx4 v6, s[8:11], s33 offen lds
    s_add_u32 m0, s32, 12288
    s_nop 0
    buffer_load_dwordx4 v7, s[8:11], s33 offen lds
    s_add_u32 s33, s33, 128
    s_add_u32 m0, s32, 16384
    s_nop 0
    buffer_load_dwordx4 v8, s[12:15], s34 offen lds
    s_add_u32 m0, s32, 20480
    s_nop 0
    buffer_load_dwordx4 v9, s[12:15], s34 offen lds
    s_add_u32 m0, s32, 24576
    s_nop 0
    buffer_load_dwordx4 v10, s[12:15], s34 offen lds
    s_add_u32 m0, s32, 28672
    s_nop 0
    buffer_load_dwordx4 v11, s[12:15], s34 offen lds
    s_add_u32 m0, s32, 32768
    s_nop 0
    buffer_load_dwordx4 v12, s[12:15], s34 offen lds
    s_add_u32 m0, s32, 36864
    s_nop 0
    buffer_load_dwordx4 v13, s[12:15], s34 offen lds
    s_add_u32 s34, s34, 393216
    s_add_u32 s32, s32, 40960
    s_cmp_ge_u32 s32, s35
    s_cselect_b32 s6, 163840, 0
    s_sub_u32 s32, s32, s6
    s_mov_b32 s36, 11
L_qlpa:
    s_waitcnt vmcnt(20)
    s_barrier
    s_add_u32 m0, s32, 0
    s_nop 0
    buffer_load_dwordx4 v4, s[8:11], s33 offen lds
    s_add_u32 m0, s32, 4096
    s_nop 0
    buffer_load_dwordx4 v5, s[8:11], s33 offen lds
    s_add_u32 m0, s32, 8192
    s_nop 0
    buffer_load_dwordx4 v6, s[8:11], s33 offen lds
    s_add_u32 m0, s32, 12288
    s_nop 0
    buffer_load_dwordx4 v7, s[8:11], s33 offen lds
    s_add_u32 s33, s33, 128
    s_add_u32 m0, s32, 16384
    s_nop 0
    buffer_load_dwordx4 v8, s[12:15], s34 offen lds
    s_add_u32 m0, s32, 20480
    s_nop 0
    buffer_load_dwordx4 v9, s[12:15], s34 offen lds
    s_add_u32 m0, s32, 24576
    s_nop 0
    buffer_load_dwordx4 v10, s[12:15], s34 offen lds
    s_add_u32 m0, s32, 28672
    s_nop 0
    buffer_load_dwordx4 v11, s[12:15], s34 offen lds
    s_add_u32 m0, s32, 32768
    s_nop 0
    buffer_load_dwordx4 v12, s[12:15], s34 offen lds
    s_add_u32 m0, s32, 36864
    s_nop 0
    buffer_load_dwordx4 v13, s[12:15], s34 offen lds
    s_add_u32 s34, s34, 393216
    s_add_u32 s32, s32, 40960
    s_cmp_ge_u32 s32, s35
    s_cselect_b32 s6, 163840, 0
    s_sub_u32 s32, s32, s6
    s_sub_u32 s36, s36, 1
    s_cmp_lg_u32 s36, 0
    s_cbranch_scc1 L_qlpa
    s_waitcnt vmcnt(20)
    s_barrier
    s_waitcnt vmcnt(10)
    s_barrier
    s_add_u32 s44, s84, 59867136
    s_addc_u32 s45, s85, 0
    s_mov_b32 s46, 16384
    s_mov_b32 s47, 0x20000
    s_add_u32 s40, s84, 58720256
    s_addc_u32 s41, s85, 0
    s_mov_b32 s42, 196608
    s_mov_b32 s43, 0x20000
    s_lshl_b32 s7, s4, 7
    s_add_u32 s7, s7, s5
    s_lshl_b32 s7, s7, 2
    s_add_u32 s7, s7, 57344
L_dbg1:
    buffer_load_dword v16, off, s[60:63], s7 sc1
    s_sub_u32 s37, s37, 1
    s_cselect_b32 s37, 0, s37
    s_cbranch_scc1 L_dbg1x
    s_waitcnt vmcnt(0)
    v_readfirstlane_b32 s6, v16
    s_cmp_lg_u32 s6, 1
    s_cbranch_scc1 L_dbg1
L_dbg1x:
    s_lshl_b32 s6, s29, 6
    v_add_u32 v24, s6, v0
    v_and_b32 v25, 127, v24
    v_lshlrev_b32 v23, 3, v25
    s_lshl_b32 s6, s4, 10
    buffer_load_dwordx2 v[26:27], v23, s[44:47], s6 offen sc1
    v_min_u32 v22, 191, v24
    v_lshlrev_b32 v22, 2, v22
    s_mul_i32 s6, s5, 768
    buffer_load_dword v28, v22, s[40:43], s6 offen sc1
    s_add_u32 s6, s6, 12288
    buffer_load_dword v29, v22, s[40:43], s6 offen sc1
    s_add_u32 s6, s6, 12288
    buffer_load_dword v30, v22, s[40:43], s6 offen sc1
    s_add_u32 s6, s6, 12288
    buffer_load_dword v31, v22, s[40:43], s6 offen sc1
    s_add_u32 s6, s6, 12288
    buffer_load_dword v32, v22, s[40:43], s6 offen sc1
    s_add_u32 s6, s6, 12288
    buffer_load_dword v33, v22, s[40:43], s6 offen sc1
    s_add_u32 s6, s6, 12288
    buffer_load_dword v34, v22, s[40:43], s6 offen sc1
    s_add_u32 s6, s6, 12288
    buffer_load_dword v35, v22, s[40:43], s6 offen sc1
    s_add_u32 s6, s6, 12288
    buffer_load_dword v36, v22, s[40:43], s6 offen sc1
    s_add_u32 s6, s6, 12288
    buffer_load_dword v37, v22, s[40:43], s6 offen sc1
    s_add_u32 s6, s6, 12288
    buffer_load_dword v38, v22, s[40:43], s6 offen sc1
    s_add_u32 s6, s6, 12288
    buffer_load_dword v39, v22, s[40:43], s6 offen sc1
    s_add_u32 s6, s6, 12288
    buffer_load_dword v40, v22, s[40:43], s6 offen sc1
    s_add_u32 s6, s6, 12288
    buffer_load_dword v41, v22, s[40:43], s6 offen sc1
    s_add_u32 s6, s6, 12288
    buffer_load_dword v42, v22, s[40:43], s6 offen sc1
    s_add_u32 s6, s6, 12288
    buffer_load_dword v43, v22, s[40:43], s6 offen sc1
    s_add_u32 s6, s6, 12288
    s_add_u32 s96, s68, 0
    s_addc_u32 s97, s69, 0
    s_mov_b32 s98, 2097152
    s_mov_b32 s99, 0x20000
    s_mul_i32 s6, s2, 4
    s_add_u32 s6, s6, s29
    s_mul_i32 s6, s6, 2048
    v_mul_u32_u24 v252, 32, v0
    buffer_load_dword v253, v252, s[96:99], s6 offen offset:0
    s_waitcnt vmcnt(18)
    s_barrier
L_qldx:
    s_barrier
    v_lshl_add_u32 v3, v1, 2, v254
    v_mov_b32 v4, 0
    ds_write_b32 v3, v4
    s_waitcnt vmcnt(1)
    v_add_f32 v28, v28, v29
    v_add_f32 v28, v28, v30
    v_add_f32 v28, v28, v31
    v_add_f32 v28, v28, v32
    v_add_f32 v28, v28, v33
    v_add_f32 v28, v28, v34
    v_add_f32 v28, v28, v35
    v_add_f32 v28, v28, v36
    v_add_f32 v28, v28, v37
    v_add_f32 v28, v28, v38
    v_add_f32 v28, v28, v39
    v_add_f32 v28, v28, v40
    v_add_f32 v28, v28, v41
    v_add_f32 v28, v28, v42
    v_add_f32 v28, v28, v43
    s_mov_b32 s6, 151552
    v_lshl_add_u32 v25, v25, 2, s6
    v_lshl_add_u32 v24, v24, 2, s6
    ds_write_b32 v25, v26
    ds_write_b32 v25, v27 offset:512
    ds_write_b32 v24, v28 offset:1024
    s_mul_i32 s33, s4, 458752
    s_lshl_b32 s32, s29, 10
    s_lshl_b32 s6, s2, 2
    s_add_u32 s6, s6, s29
    s_lshl_b32 s6, s6, 11
    v_lshlrev_b32 v4, 5, v0
    s_waitcnt lgkmcnt(0)
    s_barrier
    s_lshl_b32 s6, s29, 6
    s_add_u32 s6, s6, 0
    v_add_u32 v3, s6, v0
    s_mov_b32 s6, 2341
    v_mul_u32_u24 v20, s6, v3
    v_lshrrev_b32 v20, 16, v20
    v_mul_u32_u24 v21, 28, v20
    v_sub_u32 v21, v3, v21
    v_bfe_u32 v22, v20, 3, 1
    v_lshlrev_b32 v22, 1, v22
    v_xor_b32 v21, v21, v22
    v_mov_b32 v22, 3584
    v_cmp_le_u32 vcc, 8, v21
    v_mov_b32 v23, -128
    s_nop 0
    v_cndmask_b32 v22, v22, v23, vcc
    v_cmp_le_u32 vcc, 14, v21
    v_mov_b32 v23, 3488
    s_nop 0
    v_cndmask_b32 v22, v22, v23, vcc
    v_cmp_le_u32 vcc, 20, v21
    v_mov_b32 v23, -224
    s_nop 0
    v_cndmask_b32 v22, v22, v23, vcc
    v_lshl_add_u32 v21, v21, 4, v22
    s_mov_b32 s6, 7168
    v_mad_u32_u24 v16, v20, s6, v21
    s_lshl_b32 s6, s29, 6
    s_add_u32 s6, s6, 256
    v_add_u32 v3, s6, v0
    s_mov_b32 s6, 2341
    v_mul_u32_u24 v20, s6, v3
    v_lshrrev_b32 v20, 16, v20
    v_mul_u32_u24 v21, 28, v20
    v_sub_u32 v21, v3, v21
    v_bfe_u32 v22, v20, 3, 1
    v_lshlrev_b32 v22, 1, v22
    v_xor_b32 v21, v21, v22
    v_mov_b32 v22, 3584
    v_cmp_le_u32 vcc, 8, v21
    v_mov_b32 v23, -128
    s_nop 0
    v_cndmask_b32 v22, v22, v23, vcc
    v_cmp_le_u32 vcc, 14, v21
    v_mov_b32 v23, 3488
    s_nop 0
    v_cndmask_b32 v22, v22, v23, vcc
    v_cmp_le_u32 vcc, 20, v21
    v_mov_b32 v23, -224
    s_nop 0
    v_cndmask_b32 v22, v22, v23, vcc
    v_lshl_add_u32 v21, v21, 4, v22
    s_mov_b32 s6, 7168
    v_mad_u32_u24 v17, v20, s6, v21
    s_lshl_b32 s6, s29, 6
    s_add_u32 s6, s6, 512
    v_add_u32 v3, s6, v0
    s_mov_b32 s6, 2341
    v_mul_u32_u24 v20, s6, v3
    v_lshrrev_b32 v20, 16, v20
    v_mul_u32_u24 v21, 28, v20
    v_sub_u32 v21, v3, v21
    v_bfe_u32 v22, v20, 3, 1
    v_lshlrev_b32 v22, 1, v22
    v_xor_b32 v21, v21, v22
    v_mov_b32 v22, 3584
    v_cmp_le_u32 vcc, 8, v21
    v_mov_b32 v23, -128
    s_nop 0
    v_cndmask_b32 v22, v22, v23, vcc
    v_cmp_le_u32 vcc, 14, v21
    v_mov_b32 v23, 3488
    s_nop 0
    v_cndmask_b32 v22, v22, v23, vcc
    v_cmp_le_u32 vcc, 20, v21
    v_mov_b32 v23, -224
    s_nop 0
    v_cndmask_b32 v22, v22, v23, vcc
    v_lshl_add_u32 v21, v21, 4, v22
    s_mov_b32 s6, 7168
    v_mad_u32_u24 v18, v20, s6, v21
    s_lshl_b32 s6, s29, 6
    s_add_u32 s6, s6, 768
    v_add_u32 v3, s6, v0
    s_mov_b32 s6, 2341
    v_mul_u32_u24 v20, s6, v3
    v_lshrrev_b32 v20, 16, v20
    v_mul_u32_u24 v21, 28, v20
    v_sub_u32 v21, v3, v21
    v_bfe_u32 v22, v20, 3, 1
    v_lshlrev_b32 v22, 1, v22
    v_xor_b32 v21, v21, v22
    v_mov_b32 v22, 3584
    v_cmp_le_u32 vcc, 8, v21
    v_mov_b32 v23, -128
    s_nop 0
    v_cndmask_b32 v22, v22, v23, vcc
    v_cmp_le_u32 vcc, 14, v21
    v_mov_b32 v23, 3488
    s_nop 0
    v_cndmask_b32 v22, v22, v23, vcc
    v_cmp_le_u32 vcc, 20, v21
    v_mov_b32 v23, -224
    s_nop 0
    v_cndmask_b32 v22, v22, v23, vcc
    v_lshl_add_u32 v21, v21, 4, v22
    s_mov_b32 s6, 7168
    v_mad_u32_u24 v19, v20, s6, v21
    s_lshl_b32 s6, s29, 6
    s_add_u32 s6, s6, 1024
    v_add_u32 v3, s6, v0
    s_mov_b32 s6, 2341
    v_mul_u32_u24 v20, s6, v3
    v_lshrrev_b32 v20, 16, v20
    v_mul_u32_u24 v21, 28, v20
    v_sub_u32 v21, v3, v21
    v_bfe_u32 v22, v20, 3, 1
    v_lshlrev_b32 v22, 1, v22
    v_xor_b32 v21, v21, v22
    v_mov_b32 v22, 3584
    v_cmp_le_u32 vcc, 8, v21
    v_mov_b32 v23, -128
    s_nop 0
    v_cndmask_b32 v22, v22, v23, vcc
    v_cmp_le_u32 vcc, 14, v21
    v_mov_b32 v23, 3488
    s_nop 0
    v_cndmask_b32 v22, v22, v23, vcc
    v_cmp_le_u32 vcc, 20, v21
    v_mov_b32 v23, -224
    s_nop 0
    v_cndmask_b32 v22, v22, v23, vcc
    v_lshl_add_u32 v21, v21, 4, v22
    s_mov_b32 s6, 7168
    v_mad_u32_u24 v24, v20, s6, v21
    s_lshl_b32 s6, s29, 6
    s_add_u32 s6, s6, 1280
    v_add_u32 v3, s6, v0
    s_mov_b32 s6, 2341
    v_mul_u32_u24 v20, s6, v3
    v_lshrrev_b32 v20, 16, v20
    v_mul_u32_u24 v21, 28, v20
    v_sub_u32 v21, v3, v21
    v_bfe_u32 v22, v20, 3, 1
    v_lshlrev_b32 v22, 1, v22
    v_xor_b32 v21, v21, v22
    v_mov_b32 v22, 3584
    v_cmp_le_u32 vcc, 8, v21
    v_mov_b32 v23, -128
    s_nop 0
    v_cndmask_b32 v22, v22, v23, vcc
    v_cmp_le_u32 vcc, 14, v21
    v_mov_b32 v23, 3488
    s_nop 0
    v_cndmask_b32 v22, v22, v23, vcc
    v_cmp_le_u32 vcc, 20, v21
    v_mov_b32 v23, -224
    s_nop 0
    v_cndmask_b32 v22, v22, v23, vcc
    v_lshl_add_u32 v21, v21, 4, v22
    s_mov_b32 s6, 7168
    v_mad_u32_u24 v25, v20, s6, v21
    s_lshl_b32 s6, s29, 6
    s_add_u32 s6, s6, 1536
    v_add_u32 v3, s6, v0
    s_mov_b32 s6, 2341
    v_mul_u32_u24 v20, s6, v3
    v_lshrrev_b32 v20, 16, v20
    v_mul_u32_u24 v21, 28, v20
    v_sub_u32 v21, v3, v21
    v_bfe_u32 v22, v20, 3, 1
    v_lshlrev_b32 v22, 1, v22
    v_xor_b32 v21, v21, v22
    v_mov_b32 v22, 3584
    v_cmp_le_u32 vcc, 8, v21
    v_mov_b32 v23, -128
    s_nop 0
    v_cndmask_b32 v22, v22, v23, vcc
    v_cmp_le_u32 vcc, 14, v21
    v_mov_b32 v23, 3488
    s_nop 0
    v_cndmask_b32 v22, v22, v23, vcc
    v_cmp_le_u32 vcc, 20, v21
    v_mov_b32 v23, -224
    s_nop 0
    v_cndmask_b32 v22, v22, v23, vcc
    v_lshl_add_u32 v21, v21, 4, v22
    s_mov_b32 s6, 7168
    v_mad_u32_u24 v26, v20, s6, v21
    s_mul_i32 s6, s5, 224
    s_add_u32 s44, s72, 0
    s_addc_u32 s45, s73, 0
    s_add_u32 s44, s44, s6
    s_addc_u32 s45, s45, 0
    s_mov_b32 s46, 7340032
    s_mov_b32 s47, 0x20000
    s_sub_u32 s46, s46, s6
    s_branch L_attn
L_cq:
    s_and_b32 s31, s3, 1
    s_lshr_b32 s30, s3, 1
    v_lshrrev_b32 v3, 1, v1
    v_xor_b32 v3, v3, v2
    v_lshlrev_b32 v3, 4, v3
    v_lshl_add_u32 v3, v1, 7, v3
    s_mul_i32 s6, s30, 8192
    v_add_u32 v4, s6, v3
    v_xor_b32 v5, 64, v4
    v_lshrrev_b32 v10, 2, v1
    v_lshl_add_u32 v11, v2, 3, v10
    v_mul_u32_u24 v11, 384, v11
    v_and_b32 v12, 3, v0
    v_lshl_add_u32 v11, v12, 3, v11
    v_add_u32 v11, 16384, v11
    v_and_b32 v12, 1, v2
    v_lshrrev_b32 v10, 1, v10
    v_lshl_add_u32 v12, v12, 1, v10
    s_mul_i32 s6, s31, 6
    s_add_u32 s6, s6, 0
    v_xor_b32 v10, s6, v12
    v_lshl_add_u32 v6, v10, 5, v11
    s_mul_i32 s6, s31, 6
    s_add_u32 s6, s6, 1
    v_xor_b32 v10, s6, v12
    v_lshl_add_u32 v7, v10, 5, v11
    s_mul_i32 s6, s31, 6
    s_add_u32 s6, s6, 2
    v_xor_b32 v10, s6, v12
    v_lshl_add_u32 v8, v10, 5, v11
    s_mul_i32 s6, s31, 6
    s_add_u32 s6, s6, 3
    v_xor_b32 v10, s6, v12
    v_lshl_add_u32 v9, v10, 5, v11
    v_mov_b32 v16, 0
    v_mov_b32 v17, 0
    v_mov_b32 v18, 0
    v_mov_b32 v19, 0
    v_mov_b32 v20, 0
    v_mov_b32 v21, 0
    v_mov_b32 v22, 0
    v_mov_b32 v23, 0
    v_mov_b32 v24, 0
    v_mov_b32 v25, 0
    v_mov_b32 v26, 0
    v_mov_b32 v27, 0
    v_mov_b32 v28, 0
    v_mov_b32 v29, 0
    v_mov_b32 v30, 0
    v_mov_b32 v31, 0
    v_mov_b32 v32, 0
    v_mov_b32 v33, 0
    v_mov_b32 v34, 0
    v_mov_b32 v35, 0
    v_mov_b32 v36, 0
    v_mov_b32 v37, 0
    v_mov_b32 v38, 0
    v_mov_b32 v39, 0
    v_mov_b32 v40, 0
    v_mov_b32 v41, 0
    v_mov_b32 v42, 0
    v_mov_b32 v43, 0
    v_mov_b32 v44, 0
    v_mov_b32 v45, 0
    v_mov_b32 v46, 0
    v_mov_b32 v47, 0
    v_mov_b32 v48, 0
    v_mov_b32 v49, 0
    v_mov_b32 v50, 0
    v_mov_b32 v51, 0
    v_mov_b32 v52, 0
    v_mov_b32 v53, 0
    v_mov_b32 v54, 0
    v_mov_b32 v55, 0
    v_mov_b32 v56, 0
    v_mov_b32 v57, 0
    v_mov_b32 v58, 0
    v_mov_b32 v59, 0
    v_mov_b32 v60, 0
    v_mov_b32 v61, 0
    v_mov_b32 v62, 0
    v_mov_b32 v63, 0
    v_mov_b32 v64, 0
    v_mov_b32 v65, 0
    v_mov_b32 v66, 0
    v_mov_b32 v67, 0
    v_mov_b32 v68, 0
    v_mov_b32 v69, 0
    v_mov_b32 v70, 0
    v_mov_b32 v71, 0
    v_mov_b32 v72, 0
    v_mov_b32 v73, 0
    v_mov_b32 v74, 0
    v_mov_b32 v75, 0
    v_mov_b32 v76, 0
    v_mov_b32 v77, 0
    v_mov_b32 v78, 0
    v_mov_b32 v79, 0
    v_mov_b32 v80, 0
    v_mov_b32 v81, 0
    v_mov_b32 v82, 0
    v_mov_b32 v83, 0
    v_mov_b32 v84, 0
    v_mov_b32 v85, 0
    v_mov_b32 v86, 0
    v_mov_b32 v87, 0
    v_mov_b32 v88, 0
    v_mov_b32 v89, 0
    v_mov_b32 v90, 0
    v_mov_b32 v91, 0
    v_mov_b32 v92, 0
    v_mov_b32 v93, 0
    v_mov_b32 v94, 0
    v_mov_b32 v95, 0
    v_mov_b32 v96, 0
    v_mov_b32 v97, 0
    v_mov_b32 v98, 0
    v_mov_b32 v99, 0
    v_mov_b32 v100, 0
    v_mov_b32 v101, 0
    v_mov_b32 v102, 0
    v_mov_b32 v103, 0
    v_mov_b32 v104, 0
    v_mov_b32 v105, 0
    v_mov_b32 v106, 0
    v_mov_b32 v107, 0
    v_mov_b32 v108, 0
    v_mov_b32 v109, 0
    v_mov_b32 v110, 0
    v_mov_b32 v111, 0
    s_mov_b32 s32, 0
    s_add_u32 s8, s66, 0
    s_addc_u32 s9, s67, 0
    s_mov_b32 s10, 6291456
    s_mov_b32 s11, 0x20000
    s_add_u32 s12, s84, 58720256
    s_addc_u32 s13, s85, 0
    s_mov_b32 s14, 196608
    s_mov_b32 s15, 0x20000
    s_add_u32 s20, s64, 0
    s_addc_u32 s21, s65, 0
    s_mov_b32 s22, 4194304
    s_mov_b32 s23, 0x20000
    s_add_u32 s24, s84, 59768832
    s_addc_u32 s25, s85, 0
    s_mov_b32 s26, 114688
    s_mov_b32 s27, 0x20000
    s_lshl_b32 s28, s4, 4
    s_add_u32 s28, s28, s5
    s_lshl_b32 s6, s28, 2
    s_add_u32 s41, s6, s3
    s_lshl_b32 s6, s41, 12
    v_lshlrev_b32 v10, 4, v0
    buffer_load_dwordx4 v[224:227], v10, s[20:23], s6 offen offset:0
    buffer_load_dwordx4 v[228:231], v10, s[20:23], s6 offen offset:1024
    buffer_load_dwordx4 v[232:235], v10, s[20:23], s6 offen offset:2048
    buffer_load_dwordx4 v[236:239], v10, s[20:23], s6 offen offset:3072
    s_lshl_b32 s41, s41, 4
    s_add_u32 s41, s41, 98304
    s_mul_i32 s40, s28, 768
    s_lshl_b32 s7, s3, 8
    s_add_u32 s40, s40, s7
    s_cmp_eq_u32 s3, 3
    s_cbranch_scc1 L_xs
    v_lshrrev_b32 v10, 3, v0
    v_and_b32 v11, 7, v0
    v_lshlrev_b32 v11, 4, v11
    s_mov_b32 s6, 6144
    v_mad_u32_u24 v10, v10, s6, v11
    s_mul_i32 s6, s4, 393216
    s_lshl_b32 s7, s3, 11
    s_add_u32 s6, s6, s7
    s_lshl_b32 s7, s5, 7
    s_add_u32 s6, s6, s7
    buffer_load_dwordx4 v[192:195], v10, s[8:11], s6 offen
    s_add_u32 s6, s6, 49152
    buffer_load_dwordx4 v[196:199], v10, s[8:11], s6 offen
    s_add_u32 s6, s6, 49152
    buffer_load_dwordx4 v[200:203], v10, s[8:11], s6 offen
    s_add_u32 s6, s6, 49152
    buffer_load_dwordx4 v[204:207], v10, s[8:11], s6 offen
    s_add_u32 s6, s6, 49152
    buffer_load_dwordx4 v[208:211], v10, s[8:11], s6 offen
    s_add_u32 s6, s6, 49152
    buffer_load_dwordx4 v[212:215], v10, s[8:11], s6 offen
    s_add_u32 s6, s6, 49152
    buffer_load_dwordx4 v[216:219], v10, s[8:11], s6 offen
    s_add_u32 s6, s6, 49152
    buffer_load_dwordx4 v[220:223], v10, s[8:11], s6 offen
    s_add_u32 s6, s6, 49152
    s_branch L_qm
L_xs:
    s_lshl_b32 s28, s28, 6
    v_lshlrev_b32 v10, 14, v2
    v_lshl_add_u32 v10, v1, 2, v10
    v_lshlrev_b32 v11, 13, v0
    s_lshl_b32 s6, s4, 9
    s_lshl_b32 s7, s5, 2
    s_add_u32 s6, s6, s7
    s_mov_b32 exec_hi, 0
    buffer_store_dword v16, v10, s[24:27], s28 offen sc1
    s_mov_b64 exec, 0xff
    buffer_store_dword v16, v11, s[60:63], s6 offen sc1
    s_mov_b64 exec, -1
L_qm:
    v_mov_b32 v15, 1
    s_cmp_eq_u32 s3, 0
    s_cselect_b32 s39, 13, -1
    s_add_u32 s52, s82, 0
    s_addc_u32 s53, s83, 0
    s_mov_b32 s54, 256
    s_mov_b32 s55, 0x20000
    s_add_u32 s16, s84, 4194304
    s_addc_u32 s17, s85, 0
    s_mov_b32 s18, 12582912
    s_mov_b32 s19, 0x20000
    s_add_u32 s44, s72, 0
    s_addc_u32 s45, s73, 0
    s_mov_b32 s46, 64
    s_mov_b32 s47, 0x20000
    s_mov_b32 s33, 0
    v_lshlrev_b32 v13, 9, v2
    v_lshl_add_u32 v13, v1, 2, v13
    v_mov_b32 v14, 1
    s_sub_u32 s38, s39, 2
    s_mov_b32 s50, 57344
    s_mov_b32 s51, 61440
    s_add_u32 s96, s66, 0
    s_addc_u32 s97, s67, 0
    s_mov_b32 s98, 6291456
    s_mov_b32 s99, 0x20000
    s_and_b32 s6, s5, 7
    s_lshl_b32 s6, s6, 2
    s_and_b32 s7, s4, 3
    s_add_u32 s6, s6, s7
    s_lshl_b32 s6, s6, 2
    s_add_u32 s6, s6, s3
    s_mul_i32 s6, s6, 49152
    s_and_b32 s7, s5, 8
    s_lshl_b32 s7, s7, 7
    s_add_u32 s6, s6, s7
    v_lshrrev_b32 v252, 1, v0
    v_lshlrev_b32 v252, 11, v252
    v_and_b32 v251, 1, v0
    v_lshl_add_u32 v252, v251, 6, v252
    s_bfm_b64 exec, 48, 0
    buffer_load_dword v253, v252, s[96:99], s6 offen offset:384
    s_mov_b64 exec, -1
    s_waitcnt vmcnt(1)
    s_mov_b32 s6, 0x3f803f80
    v_dot2_f32_bf16 v240, v224, s6, 0
    v_dot2_f32_bf16 v241, v224, v224, 0
    v_dot2_f32_bf16 v240, v225, s6, v240
    v_dot2_f32_bf16 v241, v225, v225, v241
    v_dot2_f32_bf16 v240, v226, s6, v240
    v_dot2_f32_bf16 v241, v226, v226, v241
    v_dot2_f32_bf16 v240, v227, s6, v240
    v_dot2_f32_bf16 v241, v227, v227, v241
    v_dot2_f32_bf16 v240, v228, s6, v240
    v_dot2_f32_bf16 v241, v228, v228, v241
    v_dot2_f32_bf16 v240, v229, s6, v240
    v_dot2_f32_bf16 v241, v229, v229, v241
    v_dot2_f32_bf16 v240, v230, s6, v240
    v_dot2_f32_bf16 v241, v230, v230, v241
    v_dot2_f32_bf16 v240, v231, s6, v240
    v_dot2_f32_bf16 v241, v231, v231, v241
    v_dot2_f32_bf16 v242, v232, s6, 0
    v_dot2_f32_bf16 v243, v232, v232, 0
    v_dot2_f32_bf16 v242, v233, s6, v242
    v_dot2_f32_bf16 v243, v233, v233, v243
    v_dot2_f32_bf16 v242, v234, s6, v242
    v_dot2_f32_bf16 v243, v234, v234, v243
    v_dot2_f32_bf16 v242, v235, s6, v242
    v_dot2_f32_bf16 v243, v235, v235, v243
    v_dot2_f32_bf16 v242, v236, s6, v242
    v_dot2_f32_bf16 v243, v236, v236, v243
    v_dot2_f32_bf16 v242, v237, s6, v242
    v_dot2_f32_bf16 v243, v237, v237, v243
    v_dot2_f32_bf16 v242, v238, s6, v242
    v_dot2_f32_bf16 v243, v238, v238, v243
    v_dot2_f32_bf16 v242, v239, s6, v242
    v_dot2_f32_bf16 v243, v239, v239, v243
    s_nop 2
    v_add_f32_dpp v240, v240, v240 row_ror:8 row_mask:0xf bank_mask:0xf
    v_add_f32_dpp v241, v241, v241 row_ror:8 row_mask:0xf bank_mask:0xf
    v_add_f32_dpp v242, v242, v242 row_ror:8 row_mask:0xf bank_mask:0xf
    v_add_f32_dpp v243, v243, v243 row_ror:8 row_mask:0xf bank_mask:0xf
    v_add_f32_dpp v240, v240, v240 row_ror:4 row_mask:0xf bank_mask:0xf
    v_add_f32_dpp v241, v241, v241 row_ror:4 row_mask:0xf bank_mask:0xf
    v_add_f32_dpp v242, v242, v242 row_ror:4 row_mask:0xf bank_mask:0xf
    v_add_f32_dpp v243, v243, v243 row_ror:4 row_mask:0xf bank_mask:0xf
    v_add_f32_dpp v240, v240, v240 row_ror:2 row_mask:0xf bank_mask:0xf
    v_add_f32_dpp v241, v241, v241 row_ror:2 row_mask:0xf bank_mask:0xf
    v_add_f32_dpp v242, v242, v242 row_ror:2 row_mask:0xf bank_mask:0xf
    v_add_f32_dpp v243, v243, v243 row_ror:2 row_mask:0xf bank_mask:0xf
    v_add_f32_dpp v240, v240, v240 row_ror:1 row_mask:0xf bank_mask:0xf
    v_add_f32_dpp v241, v241, v241 row_ror:1 row_mask:0xf bank_mask:0xf
    v_add_f32_dpp v242, v242, v242 row_ror:1 row_mask:0xf bank_mask:0xf
    v_add_f32_dpp v243, v243, v243 row_ror:1 row_mask:0xf bank_mask:0xf
    v_mov_b32 v244, v240
    v_mov_b32 v245, v241
    v_mov_b32 v246, v242
    v_mov_b32 v247, v243
    v_permlane16_swap_b32 v244, v240
    v_permlane16_swap_b32 v245, v241
    v_permlane16_swap_b32 v246, v242
    v_permlane16_swap_b32 v247, v243
    v_add_f32 v240, v240, v244
    v_add_f32 v241, v241, v245
    v_add_f32 v242, v242, v246
    v_add_f32 v243, v243, v247
    v_mov_b32 v244, v240
    v_mov_b32 v245, v241
    v_mov_b32 v246, v242
    v_mov_b32 v247, v243
    v_permlane32_swap_b32 v244, v240
    v_permlane32_swap_b32 v245, v241
    v_permlane32_swap_b32 v246, v242
    v_permlane32_swap_b32 v247, v243
    v_add_f32 v240, v240, v244
    v_add_f32 v241, v241, v245
    v_add_f32 v242, v242, v246
    v_add_f32 v243, v243, v247
    v_mul_f32 v3, 0x3a800000, v240
    v_mul_f32 v241, 0x3a800000, v241
    v_fma_f32 v241, -v3, v3, v241
    v_max_f32 v241, 0, v241
    v_add_f32 v241, 0x3727c5ac, v241
    v_rsq_f32 v240, v241
    s_nop 0
    v_mul_f32_e64 v241, -v3, v240
    v_mul_f32 v3, 0x3a800000, v242
    v_mul_f32 v243, 0x3a800000, v243
    v_fma_f32 v243, -v3, v3, v243
    v_max_f32 v243, 0, v243
    v_add_f32 v243, 0x3727c5ac, v243
    v_rsq_f32 v242, v243
    s_nop 0
    v_mul_f32_e64 v243, -v3, v242
    s_mov_b64 exec, 1
    buffer_store_dwordx4 v[240:243], off, s[24:27], s41 sc1
    s_mov_b64 exec, -1
    s_cmp_eq_u32 s3, 3
    s_cbranch_scc1 L_np
    v_lshlrev_b32 v240, 16, v192
    v_and_b32 v241, 0xffff0000, v192
    v_lshlrev_b32 v242, 16, v193
    v_and_b32 v243, 0xffff0000, v193
    v_lshlrev_b32 v244, 16, v194
    v_and_b32 v245, 0xffff0000, v194
    v_lshlrev_b32 v246, 16, v195
    v_and_b32 v247, 0xffff0000, v195
    v_lshlrev_b32 v224, 16, v196
    v_and_b32 v225, 0xffff0000, v196
    v_lshlrev_b32 v226, 16, v197
    v_and_b32 v227, 0xffff0000, v197
    v_lshlrev_b32 v228, 16, v198
    v_and_b32 v229, 0xffff0000, v198
    v_lshlrev_b32 v230, 16, v199
    v_and_b32 v231, 0xffff0000, v199
    v_pk_add_f32 v[240:241], v[240:241], v[224:225]
    v_pk_add_f32 v[242:243], v[242:243], v[226:227]
    v_pk_add_f32 v[244:245], v[244:245], v[228:229]
    v_pk_add_f32 v[246:247], v[246:247], v[230:231]
    v_lshlrev_b32 v224, 16, v200
    v_and_b32 v225, 0xffff0000, v200
    v_lshlrev_b32 v226, 16, v201
    v_and_b32 v227, 0xffff0000, v201
    v_lshlrev_b32 v228, 16, v202
    v_and_b32 v229, 0xffff0000, v202
    v_lshlrev_b32 v230, 16, v203
    v_and_b32 v231, 0xffff0000, v203
    v_pk_add_f32 v[240:241], v[240:241], v[224:225]
    v_pk_add_f32 v[242:243], v[242:243], v[226:227]
    v_pk_add_f32 v[244:245], v[244:245], v[228:229]
    v_pk_add_f32 v[246:247], v[246:247], v[230:231]
    v_lshlrev_b32 v224, 16, v204
    v_and_b32 v225, 0xffff0000, v204
    v_lshlrev_b32 v226, 16, v205
    v_and_b32 v227, 0xffff0000, v205
    v_lshlrev_b32 v228, 16, v206
    v_and_b32 v229, 0xffff0000, v206
    v_lshlrev_b32 v230, 16, v207
    v_and_b32 v231, 0xffff0000, v207
    v_pk_add_f32 v[240:241], v[240:241], v[224:225]
    v_pk_add_f32 v[242:243], v[242:243], v[226:227]
    v_pk_add_f32 v[244:245], v[244:245], v[228:229]
    v_pk_add_f32 v[246:247], v[246:247], v[230:231]
    v_lshlrev_b32 v224, 16, v208
    v_and_b32 v225, 0xffff0000, v208
    v_lshlrev_b32 v226, 16, v209
    v_and_b32 v227, 0xffff0000, v209
    v_lshlrev_b32 v228, 16, v210
    v_and_b32 v229, 0xffff0000, v210
    v_lshlrev_b32 v230, 16, v211
    v_and_b32 v231, 0xffff0000, v211
    v_pk_add_f32 v[240:241], v[240:241], v[224:225]
    v_pk_add_f32 v[242:243], v[242:243], v[226:227]
    v_pk_add_f32 v[244:245], v[244:245], v[228:229]
    v_pk_add_f32 v[246:247], v[246:247], v[230:231]
    v_lshlrev_b32 v224, 16, v212
    v_and_b32 v225, 0xffff0000, v212
    v_lshlrev_b32 v226, 16, v213
    v_and_b32 v227, 0xffff0000, v213
    v_lshlrev_b32 v228, 16, v214
    v_and_b32 v229, 0xffff0000, v214
    v_lshlrev_b32 v230, 16, v215
    v_and_b32 v231, 0xffff0000, v215
    v_pk_add_f32 v[240:241], v[240:241], v[224:225]
    v_pk_add_f32 v[242:243], v[242:243], v[226:227]
    v_pk_add_f32 v[244:245], v[244:245], v[228:229]
    v_pk_add_f32 v[246:247], v[246:247], v[230:231]
    v_lshlrev_b32 v224, 16, v216
    v_and_b32 v225, 0xffff0000, v216
    v_lshlrev_b32 v226, 16, v217
    v_and_b32 v227, 0xffff0000, v217
    v_lshlrev_b32 v228, 16, v218
    v_and_b32 v229, 0xffff0000, v218
    v_lshlrev_b32 v230, 16, v219
    v_and_b32 v231, 0xffff0000, v219
    v_pk_add_f32 v[240:241], v[240:241], v[224:225]
    v_pk_add_f32 v[242:243], v[242:243], v[226:227]
    v_pk_add_f32 v[244:245], v[244:245], v[228:229]
    v_pk_add_f32 v[246:247], v[246:247], v[230:231]
    v_lshlrev_b32 v224, 16, v220
    v_and_b32 v225, 0xffff0000, v220
    v_lshlrev_b32 v226, 16, v221
    v_and_b32 v227, 0xffff0000, v221
    v_lshlrev_b32 v228, 16, v222
    v_and_b32 v229, 0xffff0000, v222
    v_lshlrev_b32 v230, 16, v223
    v_and_b32 v231, 0xffff0000, v223
    v_pk_add_f32 v[240:241], v[240:241], v[224:225]
    v_pk_add_f32 v[242:243], v[242:243], v[226:227]
    v_pk_add_f32 v[244:245], v[244:245], v[228:229]
    v_pk_add_f32 v[246:247], v[246:247], v[230:231]
    v_add_f32_dpp v240, v240, v240 row_ror:8 row_mask:0xf bank_mask:0xf
    v_add_f32_dpp v241, v241, v241 row_ror:8 row_mask:0xf bank_mask:0xf
    v_add_f32_dpp v242, v242, v242 row_ror:8 row_mask:0xf bank_mask:0xf
    v_add_f32_dpp v243, v243, v243 row_ror:8 row_mask:0xf bank_mask:0xf
    v_add_f32_dpp v244, v244, v244 row_ror:8 row_mask:0xf bank_mask:0xf
    v_add_f32_dpp v245, v245, v245 row_ror:8 row_mask:0xf bank_mask:0xf
    v_add_f32_dpp v246, v246, v246 row_ror:8 row_mask:0xf bank_mask:0xf
    v_add_f32_dpp v247, v247, v247 row_ror:8 row_mask:0xf bank_mask:0xf
    v_mov_b32 v224, v240
    v_mov_b32 v225, v241
    v_mov_b32 v226, v242
    v_mov_b32 v227, v243
    v_mov_b32 v228, v244
    v_mov_b32 v229, v245
    v_mov_b32 v230, v246
    v_mov_b32 v231, v247
    v_permlane16_swap_b32 v224, v240
    v_permlane16_swap_b32 v225, v241
    v_permlane16_swap_b32 v226, v242
    v_permlane16_swap_b32 v227, v243
    v_permlane16_swap_b32 v228, v244
    v_permlane16_swap_b32 v229, v245
    v_permlane16_swap_b32 v230, v246
    v_permlane16_swap_b32 v231, v247
    v_add_f32 v240, v240, v224
    v_add_f32 v241, v241, v225
    v_add_f32 v242, v242, v226
    v_add_f32 v243, v243, v227
    v_add_f32 v244, v244, v228
    v_add_f32 v245, v245, v229
    v_add_f32 v246, v246, v230
    v_add_f32 v247, v247, v231
    v_mov_b32 v224, v240
    v_mov_b32 v225, v241
    v_mov_b32 v226, v242
    v_mov_b32 v227, v243
    v_mov_b32 v228, v244
    v_mov_b32 v229, v245
    v_mov_b32 v230, v246
    v_mov_b32 v231, v247
    v_permlane32_swap_b32 v224, v240
    v_permlane32_swap_b32 v225, v241
    v_permlane32_swap_b32 v226, v242
    v_permlane32_swap_b32 v227, v243
    v_permlane32_swap_b32 v228, v244
    v_permlane32_swap_b32 v229, v245
    v_permlane32_swap_b32 v230, v246
    v_permlane32_swap_b32 v231, v247
    v_add_f32 v240, v240, v224
    v_add_f32 v241, v241, v225
    v_add_f32 v242, v242, v226
    v_add_f32 v243, v243, v227
    v_add_f32 v244, v244, v228
    v_add_f32 v245, v245, v229
    v_add_f32 v246, v246, v230
    v_add_f32 v247, v247, v231
    v_lshlrev_b32 v10, 5, v0
    s_mov_b64 exec, 0xff
    buffer_store_dwordx4 v[240:243], v10, s[12:15], s40 offen sc1
    buffer_store_dwordx4 v[244:247], v10, s[12:15], s40 offen offset:16 sc1
    s_mov_b64 exec, -1
L_np:
    s_barrier
    ds_read_b128 v[112:115], v4 offset:0
    ds_read_b128 v[116:119], v4 offset:2048
    ds_read_b128 v[120:123], v4 offset:4096
    ds_read_b128 v[124:127], v4 offset:6144
    ds_read_b64_tr_b16 v[128:129], v6 offset:0
    ds_read_b64_tr_b16 v[130:131], v6 offset:1536
    ds_read_b64_tr_b16 v[132:133], v7 offset:0
    ds_read_b64_tr_b16 v[134:135], v7 offset:1536
    ds_read_b64_tr_b16 v[136:137], v8 offset:0
    ds_read_b64_tr_b16 v[138:139], v8 offset:1536
    ds_read_b64_tr_b16 v[140:141], v9 offset:0
    ds_read_b64_tr_b16 v[142:143], v9 offset:1536
    ds_read_b64_tr_b16 v[144:145], v6 offset:128
    ds_read_b64_tr_b16 v[146:147], v6 offset:1664
    ds_read_b64_tr_b16 v[148:149], v7 offset:128
    ds_read_b64_tr_b16 v[150:151], v7 offset:1664
    s_mov_b32 s36, 16
    s_branch L_qmid
    .p2align 4
L_qloop:
    s_barrier
    v_mfma_f32_16x16x32_bf16 v[16:19], v[168:171], v[152:155], v[16:19]
    ds_read_b128 v[112:115], v4 offset:0
    v_mfma_f32_16x16x32_bf16 v[40:43], v[168:171], v[156:159], v[40:43]
    ds_read_b128 v[116:119], v4 offset:2048
    v_mfma_f32_16x16x32_bf16 v[64:67], v[168:171], v[160:163], v[64:67]
    ds_read_b128 v[120:123], v4 offset:4096
    v_mfma_f32_16x16x32_bf16 v[88:91], v[168:171], v[164:167], v[88:91]
    ds_read_b128 v[124:127], v4 offset:6144
    v_mfma_f32_16x16x32_bf16 v[20:23], v[172:175], v[152:155], v[20:23]
    ds_read_b64_tr_b16 v[128:129], v6 offset:0
    v_mfma_f32_16x16x32_bf16 v[44:47], v[172:175], v[156:159], v[44:47]
    ds_read_b64_tr_b16 v[130:131], v6 offset:1536
    v_mfma_f32_16x16x32_bf16 v[68:71], v[172:175], v[160:163], v[68:71]
    ds_read_b64_tr_b16 v[132:133], v7 offset:0
    v_mfma_f32_16x16x32_bf16 v[92:95], v[172:175], v[164:167], v[92:95]
    ds_read_b64_tr_b16 v[134:135], v7 offset:1536
    v_mfma_f32_16x16x32_bf16 v[24:27], v[176:179], v[152:155], v[24:27]
    ds_read_b64_tr_b16 v[136:137], v8 offset:0
    v_mfma_f32_16x16x32_bf16 v[48:51], v[176:179], v[156:159], v[48:51]
    ds_read_b64_tr_b16 v[138:139], v8 offset:1536
    v_mfma_f32_16x16x32_bf16 v[72:75], v[176:179], v[160:163], v[72:75]
    ds_read_b64_tr_b16 v[140:141], v9 offset:0
    v_mfma_f32_16x16x32_bf16 v[96:99], v[176:179], v[164:167], v[96:99]
    ds_read_b64_tr_b16 v[142:143], v9 offset:1536
    v_mfma_f32_16x16x32_bf16 v[28:31], v[180:183], v[152:155], v[28:31]
    ds_read_b64_tr_b16 v[144:145], v6 offset:128
    v_mfma_f32_16x16x32_bf16 v[52:55], v[180:183], v[156:159], v[52:55]
    ds_read_b64_tr_b16 v[146:147], v6 offset:1664
    v_mfma_f32_16x16x32_bf16 v[76:79], v[180:183], v[160:163], v[76:79]
    ds_read_b64_tr_b16 v[148:149], v7 offset:128
    v_mfma_f32_16x16x32_bf16 v[100:103], v[180:183], v[164:167], v[100:103]
    ds_read_b64_tr_b16 v[150:151], v7 offset:1664
    v_mfma_f32_16x16x32_bf16 v[32:35], v[184:187], v[152:155], v[32:35]
    s_cmp_lg_u32 s36, 14
    s_cbranch_scc1 L_nw
    s_waitcnt vmcnt(0)
L_nw:
    s_cmp_lg_u32 s36, s39
    s_cbranch_scc1 L_na
    s_mov_b64 exec, 1
    buffer_atomic_add v15, off, s[52:55], 0 sc0
    s_mov_b64 exec, -1
L_na:
    v_mfma_f32_16x16x32_bf16 v[56:59], v[184:187], v[156:159], v[56:59]
    s_cmp_lg_u32 s36, s38
    s_cbranch_scc1 L_nb
    s_waitcnt vmcnt(0)
    v_readfirstlane_b32 s6, v15
    s_and_b32 s6, s6, 255
    s_cmp_lg_u32 s6, 255
    s_cbranch_scc1 L_nb
    buffer_store_dword v14, v13, s[60:63], s50 offen offset:0 sc1
    buffer_store_dword v14, v13, s[60:63], s50 offen offset:2048 sc1
    buffer_store_dword v14, v13, s[60:63], s51 offen offset:0 sc1
    buffer_store_dword v14, v13, s[60:63], s51 offen offset:2048 sc1
L_nb:
    v_mfma_f32_16x16x32_bf16 v[80:83], v[184:187], v[160:163], v[80:83]
    v_mfma_f32_16x16x32_bf16 v[104:107], v[184:187], v[164:167], v[104:107]
    v_mfma_f32_16x16x32_bf16 v[36:39], v[188:191], v[152:155], v[36:39]
    v_mfma_f32_16x16x32_bf16 v[60:63], v[188:191], v[156:159], v[60:63]
    v_mfma_f32_16x16x32_bf16 v[84:87], v[188:191], v[160:163], v[84:87]
    v_mfma_f32_16x16x32_bf16 v[108:111], v[188:191], v[164:167], v[108:111]
L_qmid:
    s_waitcnt lgkmcnt(0)
    v_mfma_f32_16x16x32_bf16 v[16:19], v[128:131], v[112:115], v[16:19]
    ds_read_b128 v[152:155], v5 offset:0
    v_mfma_f32_16x16x32_bf16 v[40:43], v[128:131], v[116:119], v[40:43]
    ds_read_b128 v[156:159], v5 offset:2048
    v_mfma_f32_16x16x32_bf16 v[64:67], v[128:131], v[120:123], v[64:67]
    ds_read_b128 v[160:163], v5 offset:4096
    v_mfma_f32_16x16x32_bf16 v[88:91], v[128:131], v[124:127], v[88:91]
    ds_read_b128 v[164:167], v5 offset:6144
    v_mfma_f32_16x16x32_bf16 v[20:23], v[132:135], v[112:115], v[20:23]
    ds_read_b64_tr_b16 v[168:169], v6 offset:12288
    v_mfma_f32_16x16x32_bf16 v[44:47], v[132:135], v[116:119], v[44:47]
    ds_read_b64_tr_b16 v[170:171], v6 offset:13824
    v_mfma_f32_16x16x32_bf16 v[68:71], v[132:135], v[120:123], v[68:71]
    ds_read_b64_tr_b16 v[172:173], v7 offset:12288
    v_mfma_f32_16x16x32_bf16 v[92:95], v[132:135], v[124:127], v[92:95]
    ds_read_b64_tr_b16 v[174:175], v7 offset:13824
    v_mfma_f32_16x16x32_bf16 v[24:27], v[136:139], v[112:115], v[24:27]
    ds_read_b64_tr_b16 v[176:177], v8 offset:12288
    v_mfma_f32_16x16x32_bf16 v[48:51], v[136:139], v[116:119], v[48:51]
    ds_read_b64_tr_b16 v[178:179], v8 offset:13824
    v_mfma_f32_16x16x32_bf16 v[72:75], v[136:139], v[120:123], v[72:75]
    ds_read_b64_tr_b16 v[180:181], v9 offset:12288
    v_mfma_f32_16x16x32_bf16 v[96:99], v[136:139], v[124:127], v[96:99]
    ds_read_b64_tr_b16 v[182:183], v9 offset:13824
    v_mfma_f32_16x16x32_bf16 v[28:31], v[140:143], v[112:115], v[28:31]
    ds_read_b64_tr_b16 v[184:185], v6 offset:12416
    v_mfma_f32_16x16x32_bf16 v[52:55], v[140:143], v[116:119], v[52:55]
    ds_read_b64_tr_b16 v[186:187], v6 offset:13952
    v_mfma_f32_16x16x32_bf16 v[76:79], v[140:143], v[120:123], v[76:79]
    ds_read_b64_tr_b16 v[188:189], v7 offset:12416
    v_mfma_f32_16x16x32_bf16 v[100:103], v[140:143], v[124:127], v[100:103]
    ds_read_b64_tr_b16 v[190:191], v7 offset:13952
    v_mfma_f32_16x16x32_bf16 v[32:35], v[144:147], v[112:115], v[32:35]
    s_add_u32 s32, s32, 1
    s_cmp_eq_u32 s32, 4
    v_mfma_f32_16x16x32_bf16 v[56:59], v[144:147], v[116:119], v[56:59]
    s_mov_b32 s6, 40960
    s_cselect_b32 s6, -122880, s6
    v_mfma_f32_16x16x32_bf16 v[80:83], v[144:147], v[120:123], v[80:83]
    s_cselect_b32 s32, 0, s32
    v_add_u32 v4, s6, v4
    v_mfma_f32_16x16x32_bf16 v[104:107], v[144:147], v[124:127], v[104:107]
    v_add_u32 v5, s6, v5
    v_add_u32 v6, s6, v6
    v_mfma_f32_16x16x32_bf16 v[36:39], v[148:151], v[112:115], v[36:39]
    v_add_u32 v7, s6, v7
    v_add_u32 v8, s6, v8
    v_mfma_f32_16x16x32_bf16 v[60:63], v[148:151], v[116:119], v[60:63]
    v_add_u32 v9, s6, v9
    s_sub_u32 s36, s36, 1
    v_mfma_f32_16x16x32_bf16 v[84:87], v[148:151], v[120:123], v[84:87]
    s_cmp_lg_u32 s36, 0
    v_mfma_f32_16x16x32_bf16 v[108:111], v[148:151], v[124:127], v[108:111]
    s_waitcnt lgkmcnt(0)
    s_cbranch_scc1 L_qloop
    s_barrier
    v_mfma_f32_16x16x32_bf16 v[16:19], v[168:171], v[152:155], v[16:19]
    v_mfma_f32_16x16x32_bf16 v[40:43], v[168:171], v[156:159], v[40:43]
    v_mfma_f32_16x16x32_bf16 v[64:67], v[168:171], v[160:163], v[64:67]
    v_mfma_f32_16x16x32_bf16 v[88:91], v[168:171], v[164:167], v[88:91]
    v_mfma_f32_16x16x32_bf16 v[20:23], v[172:175], v[152:155], v[20:23]
    v_mfma_f32_16x16x32_bf16 v[44:47], v[172:175], v[156:159], v[44:47]
    v_mfma_f32_16x16x32_bf16 v[68:71], v[172:175], v[160:163], v[68:71]
    v_mfma_f32_16x16x32_bf16 v[92:95], v[172:175], v[164:167], v[92:95]
    v_mfma_f32_16x16x32_bf16 v[24:27], v[176:179], v[152:155], v[24:27]
    v_mfma_f32_16x16x32_bf16 v[48:51], v[176:179], v[156:159], v[48:51]
    v_mfma_f32_16x16x32_bf16 v[72:75], v[176:179], v[160:163], v[72:75]
    v_mfma_f32_16x16x32_bf16 v[96:99], v[176:179], v[164:167], v[96:99]
    v_mfma_f32_16x16x32_bf16 v[28:31], v[180:183], v[152:155], v[28:31]
    v_mfma_f32_16x16x32_bf16 v[52:55], v[180:183], v[156:159], v[52:55]
    v_mfma_f32_16x16x32_bf16 v[76:79], v[180:183], v[160:163], v[76:79]
    v_mfma_f32_16x16x32_bf16 v[100:103], v[180:183], v[164:167], v[100:103]
    v_mfma_f32_16x16x32_bf16 v[32:35], v[184:187], v[152:155], v[32:35]
    v_mfma_f32_16x16x32_bf16 v[56:59], v[184:187], v[156:159], v[56:59]
    v_mfma_f32_16x16x32_bf16 v[80:83], v[184:187], v[160:163], v[80:83]
    v_mfma_f32_16x16x32_bf16 v[104:107], v[184:187], v[164:167], v[104:107]
    v_mfma_f32_16x16x32_bf16 v[36:39], v[188:191], v[152:155], v[36:39]
    v_mfma_f32_16x16x32_bf16 v[60:63], v[188:191], v[156:159], v[60:63]
    v_mfma_f32_16x16x32_bf16 v[84:87], v[188:191], v[160:163], v[84:87]
    v_mfma_f32_16x16x32_bf16 v[108:111], v[188:191], v[164:167], v[108:111]
    s_nop 7
    s_barrier
    s_lshl_b32 s6, s30, 8
    s_add_u32 s6, s6, 151552
    v_lshl_add_u32 v6, v1, 2, s6
    s_lshl_b32 s6, s31, 7
    s_add_u32 s6, s6, 152576
    v_lshl_add_u32 v7, v2, 4, s6
    ds_read_b32 v160, v6 offset:0
    ds_read_b32 v161, v6 offset:512
    ds_read_b32 v162, v6 offset:64
    ds_read_b32 v163, v6 offset:576
    ds_read_b32 v164, v6 offset:128
    ds_read_b32 v165, v6 offset:640
    ds_read_b32 v166, v6 offset:192
    ds_read_b32 v167, v6 offset:704
    ds_read_b128 v[168:171], v7 offset:0
    ds_read_b128 v[172:175], v7 offset:64
    ds_read_b128 v[176:179], v7 offset:256
    ds_read_b128 v[180:183], v7 offset:320
    ds_read_b128 v[184:187], v7 offset:512
    ds_read_b128 v[188:191], v7 offset:576
    v_and_b32 v4, 1, v2
    v_lshlrev_b32 v4, 5, v4
    v_lshrrev_b32 v3, 1, v2
    v_lshl_add_u32 v4, v3, 4, v4
    v_lshl_add_u32 v4, v1, 6, v4
    s_lshl_b32 s6, s5, 1
    s_add_u32 s6, s6, s31
    s_lshl_b32 s6, s6, 17
    s_lshl_b32 s7, s4, 13
    s_add_u32 s6, s6, s7
    s_lshl_b32 s7, s30, 12
    s_add_u32 s6, s6, s7
    s_lshl_b32 s28, s31, 13
    s_add_u32 s7, s7, s28
    s_add_u32 s7, s7, 98304
    v_add_u32 v5, s7, v4
    s_waitcnt lgkmcnt(0)
    s_add_u32 s6, s6, 4194304
    v_pk_mul_f32 v[24:25], v[24:25], v[160:161] op_sel_hi:[1,0]
    v_pk_mul_f32 v[26:27], v[26:27], v[160:161] op_sel_hi:[1,0]
    v_pk_mul_f32 v[28:29], v[28:29], v[160:161] op_sel_hi:[1,0]
    v_pk_mul_f32 v[30:31], v[30:31], v[160:161] op_sel_hi:[1,0]
    v_pk_fma_f32 v[24:25], v[176:177], v[160:161], v[24:25] op_sel:[0,1,0]
    v_pk_fma_f32 v[26:27], v[178:179], v[160:161], v[26:27] op_sel:[0,1,0]
    v_pk_fma_f32 v[28:29], v[180:181], v[160:161], v[28:29] op_sel:[0,1,0]
    v_pk_fma_f32 v[30:31], v[182:183], v[160:161], v[30:31] op_sel:[0,1,0]
    v_cvt_pk_bf16_f32 v112, v24, v25
    v_cvt_pk_bf16_f32 v113, v26, v27
    v_cvt_pk_bf16_f32 v114, v28, v29
    v_cvt_pk_bf16_f32 v115, v30, v31
    s_nop 1
    v_permlane16_swap_b32 v112, v114
    v_permlane16_swap_b32 v113, v115
    buffer_store_dwordx4 v[112:115], v4, s[16:19], s6 offen offset:0 sc1
    v_pk_mul_f32 v[48:49], v[48:49], v[162:163] op_sel_hi:[1,0]
    v_pk_mul_f32 v[50:51], v[50:51], v[162:163] op_sel_hi:[1,0]
    v_pk_mul_f32 v[52:53], v[52:53], v[162:163] op_sel_hi:[1,0]
    v_pk_mul_f32 v[54:55], v[54:55], v[162:163] op_sel_hi:[1,0]
    v_pk_fma_f32 v[48:49], v[176:177], v[162:163], v[48:49] op_sel:[0,1,0]
    v_pk_fma_f32 v[50:51], v[178:179], v[162:163], v[50:51] op_sel:[0,1,0]
    v_pk_fma_f32 v[52:53], v[180:181], v[162:163], v[52:53] op_sel:[0,1,0]
    v_pk_fma_f32 v[54:55], v[182:183], v[162:163], v[54:55] op_sel:[0,1,0]
    v_cvt_pk_bf16_f32 v116, v48, v49
    v_cvt_pk_bf16_f32 v117, v50, v51
    v_cvt_pk_bf16_f32 v118, v52, v53
    v_cvt_pk_bf16_f32 v119, v54, v55
    s_nop 1
    v_permlane16_swap_b32 v116, v118
    v_permlane16_swap_b32 v117, v119
    buffer_store_dwordx4 v[116:119], v4, s[16:19], s6 offen offset:1024 sc1
    v_pk_mul_f32 v[72:73], v[72:73], v[164:165] op_sel_hi:[1,0]
    v_pk_mul_f32 v[74:75], v[74:75], v[164:165] op_sel_hi:[1,0]
    v_pk_mul_f32 v[76:77], v[76:77], v[164:165] op_sel_hi:[1,0]
    v_pk_mul_f32 v[78:79], v[78:79], v[164:165] op_sel_hi:[1,0]
    v_pk_fma_f32 v[72:73], v[176:177], v[164:165], v[72:73] op_sel:[0,1,0]
    v_pk_fma_f32 v[74:75], v[178:179], v[164:165], v[74:75] op_sel:[0,1,0]
    v_pk_fma_f32 v[76:77], v[180:181], v[164:165], v[76:77] op_sel:[0,1,0]
    v_pk_fma_f32 v[78:79], v[182:183], v[164:165], v[78:79] op_sel:[0,1,0]
    v_cvt_pk_bf16_f32 v120, v72, v73
    v_cvt_pk_bf16_f32 v121, v74, v75
    v_cvt_pk_bf16_f32 v122, v76, v77
    v_cvt_pk_bf16_f32 v123, v78, v79
    s_nop 1
    v_permlane16_swap_b32 v120, v122
    v_permlane16_swap_b32 v121, v123
    buffer_store_dwordx4 v[120:123], v4, s[16:19], s6 offen offset:2048 sc1
    v_pk_mul_f32 v[96:97], v[96:97], v[166:167] op_sel_hi:[1,0]
    v_pk_mul_f32 v[98:99], v[98:99], v[166:167] op_sel_hi:[1,0]
    v_pk_mul_f32 v[100:101], v[100:101], v[166:167] op_sel_hi:[1,0]
    v_pk_mul_f32 v[102:103], v[102:103], v[166:167] op_sel_hi:[1,0]
    v_pk_fma_f32 v[96:97], v[176:177], v[166:167], v[96:97] op_sel:[0,1,0]
    v_pk_fma_f32 v[98:99], v[178:179], v[166:167], v[98:99] op_sel:[0,1,0]
    v_pk_fma_f32 v[100:101], v[180:181], v[166:167], v[100:101] op_sel:[0,1,0]
    v_pk_fma_f32 v[102:103], v[182:183], v[166:167], v[102:103] op_sel:[0,1,0]
    v_cvt_pk_bf16_f32 v124, v96, v97
    v_cvt_pk_bf16_f32 v125, v98, v99
    v_cvt_pk_bf16_f32 v126, v100, v101
    v_cvt_pk_bf16_f32 v127, v102, v103
    s_nop 1
    v_permlane16_swap_b32 v124, v126
    v_permlane16_swap_b32 v125, v127
    buffer_store_dwordx4 v[124:127], v4, s[16:19], s6 offen offset:3072 sc1
    s_add_u32 s6, s6, 4194304
    v_pk_mul_f32 v[32:33], v[32:33], v[160:161] op_sel_hi:[1,0]
    v_pk_mul_f32 v[34:35], v[34:35], v[160:161] op_sel_hi:[1,0]
    v_pk_mul_f32 v[36:37], v[36:37], v[160:161] op_sel_hi:[1,0]
    v_pk_mul_f32 v[38:39], v[38:39], v[160:161] op_sel_hi:[1,0]
    v_pk_fma_f32 v[32:33], v[184:185], v[160:161], v[32:33] op_sel:[0,1,0]
    v_pk_fma_f32 v[34:35], v[186:187], v[160:161], v[34:35] op_sel:[0,1,0]
    v_pk_fma_f32 v[36:37], v[188:189], v[160:161], v[36:37] op_sel:[0,1,0]
    v_pk_fma_f32 v[38:39], v[190:191], v[160:161], v[38:39] op_sel:[0,1,0]
    v_cvt_pk_bf16_f32 v128, v32, v33
    v_cvt_pk_bf16_f32 v129, v34, v35
    v_cvt_pk_bf16_f32 v130, v36, v37
    v_cvt_pk_bf16_f32 v131, v38, v39
    s_nop 1
    v_permlane16_swap_b32 v128, v130
    v_permlane16_swap_b32 v129, v131
    buffer_store_dwordx4 v[128:131], v4, s[16:19], s6 offen offset:0 sc1
    v_pk_mul_f32 v[56:57], v[56:57], v[162:163] op_sel_hi:[1,0]
    v_pk_mul_f32 v[58:59], v[58:59], v[162:163] op_sel_hi:[1,0]
    v_pk_mul_f32 v[60:61], v[60:61], v[162:163] op_sel_hi:[1,0]
    v_pk_mul_f32 v[62:63], v[62:63], v[162:163] op_sel_hi:[1,0]
    v_pk_fma_f32 v[56:57], v[184:185], v[162:163], v[56:57] op_sel:[0,1,0]
    v_pk_fma_f32 v[58:59], v[186:187], v[162:163], v[58:59] op_sel:[0,1,0]
    v_pk_fma_f32 v[60:61], v[188:189], v[162:163], v[60:61] op_sel:[0,1,0]
    v_pk_fma_f32 v[62:63], v[190:191], v[162:163], v[62:63] op_sel:[0,1,0]
    v_cvt_pk_bf16_f32 v132, v56, v57
    v_cvt_pk_bf16_f32 v133, v58, v59
    v_cvt_pk_bf16_f32 v134, v60, v61
    v_cvt_pk_bf16_f32 v135, v62, v63
    s_nop 1
    v_permlane16_swap_b32 v132, v134
    v_permlane16_swap_b32 v133, v135
    buffer_store_dwordx4 v[132:135], v4, s[16:19], s6 offen offset:1024 sc1
    v_pk_mul_f32 v[80:81], v[80:81], v[164:165] op_sel_hi:[1,0]
    v_pk_mul_f32 v[82:83], v[82:83], v[164:165] op_sel_hi:[1,0]
    v_pk_mul_f32 v[84:85], v[84:85], v[164:165] op_sel_hi:[1,0]
    v_pk_mul_f32 v[86:87], v[86:87], v[164:165] op_sel_hi:[1,0]
    v_pk_fma_f32 v[80:81], v[184:185], v[164:165], v[80:81] op_sel:[0,1,0]
    v_pk_fma_f32 v[82:83], v[186:187], v[164:165], v[82:83] op_sel:[0,1,0]
    v_pk_fma_f32 v[84:85], v[188:189], v[164:165], v[84:85] op_sel:[0,1,0]
    v_pk_fma_f32 v[86:87], v[190:191], v[164:165], v[86:87] op_sel:[0,1,0]
    v_cvt_pk_bf16_f32 v136, v80, v81
    v_cvt_pk_bf16_f32 v137, v82, v83
    v_cvt_pk_bf16_f32 v138, v84, v85
    v_cvt_pk_bf16_f32 v139, v86, v87
    s_nop 1
    v_permlane16_swap_b32 v136, v138
    v_permlane16_swap_b32 v137, v139
    buffer_store_dwordx4 v[136:139], v4, s[16:19], s6 offen offset:2048 sc1
    v_pk_mul_f32 v[104:105], v[104:105], v[166:167] op_sel_hi:[1,0]
    v_pk_mul_f32 v[106:107], v[106:107], v[166:167] op_sel_hi:[1,0]
    v_pk_mul_f32 v[108:109], v[108:109], v[166:167] op_sel_hi:[1,0]
    v_pk_mul_f32 v[110:111], v[110:111], v[166:167] op_sel_hi:[1,0]
    v_pk_fma_f32 v[104:105], v[184:185], v[166:167], v[104:105] op_sel:[0,1,0]
    v_pk_fma_f32 v[106:107], v[186:187], v[166:167], v[106:107] op_sel:[0,1,0]
    v_pk_fma_f32 v[108:109], v[188:189], v[166:167], v[108:109] op_sel:[0,1,0]
    v_pk_fma_f32 v[110:111], v[190:191], v[166:167], v[110:111] op_sel:[0,1,0]
    v_cvt_pk_bf16_f32 v140, v104, v105
    v_cvt_pk_bf16_f32 v141, v106, v107
    v_cvt_pk_bf16_f32 v142, v108, v109
    v_cvt_pk_bf16_f32 v143, v110, v111
    s_nop 1
    v_permlane16_swap_b32 v140, v142
    v_permlane16_swap_b32 v141, v143
    buffer_store_dwordx4 v[140:143], v4, s[16:19], s6 offen offset:3072 sc1
    s_add_u32 s6, s6, 4194304
    v_pk_mul_f32 v[16:17], v[16:17], v[160:161] op_sel_hi:[1,0]
    v_pk_mul_f32 v[18:19], v[18:19], v[160:161] op_sel_hi:[1,0]
    v_pk_mul_f32 v[20:21], v[20:21], v[160:161] op_sel_hi:[1,0]
    v_pk_mul_f32 v[22:23], v[22:23], v[160:161] op_sel_hi:[1,0]
    v_pk_fma_f32 v[16:17], v[168:169], v[160:161], v[16:17] op_sel:[0,1,0]
    v_pk_fma_f32 v[18:19], v[170:171], v[160:161], v[18:19] op_sel:[0,1,0]
    v_pk_fma_f32 v[20:21], v[172:173], v[160:161], v[20:21] op_sel:[0,1,0]
    v_pk_fma_f32 v[22:23], v[174:175], v[160:161], v[22:23] op_sel:[0,1,0]
    v_cvt_pk_bf16_f32 v144, v16, v17
    v_cvt_pk_bf16_f32 v145, v18, v19
    v_cvt_pk_bf16_f32 v146, v20, v21
    v_cvt_pk_bf16_f32 v147, v22, v23
    s_nop 1
    v_permlane16_swap_b32 v144, v146
    v_permlane16_swap_b32 v145, v147
    ds_write_b128 v5, v[144:147] offset:0
    v_pk_mul_f32 v[40:41], v[40:41], v[162:163] op_sel_hi:[1,0]
    v_pk_mul_f32 v[42:43], v[42:43], v[162:163] op_sel_hi:[1,0]
    v_pk_mul_f32 v[44:45], v[44:45], v[162:163] op_sel_hi:[1,0]
    v_pk_mul_f32 v[46:47], v[46:47], v[162:163] op_sel_hi:[1,0]
    v_pk_fma_f32 v[40:41], v[168:169], v[162:163], v[40:41] op_sel:[0,1,0]
    v_pk_fma_f32 v[42:43], v[170:171], v[162:163], v[42:43] op_sel:[0,1,0]
    v_pk_fma_f32 v[44:45], v[172:173], v[162:163], v[44:45] op_sel:[0,1,0]
    v_pk_fma_f32 v[46:47], v[174:175], v[162:163], v[46:47] op_sel:[0,1,0]
    v_cvt_pk_bf16_f32 v148, v40, v41
    v_cvt_pk_bf16_f32 v149, v42, v43
    v_cvt_pk_bf16_f32 v150, v44, v45
    v_cvt_pk_bf16_f32 v151, v46, v47
    s_nop 1
    v_permlane16_swap_b32 v148, v150
    v_permlane16_swap_b32 v149, v151
    ds_write_b128 v5, v[148:151] offset:1024
    v_pk_mul_f32 v[64:65], v[64:65], v[164:165] op_sel_hi:[1,0]
    v_pk_mul_f32 v[66:67], v[66:67], v[164:165] op_sel_hi:[1,0]
    v_pk_mul_f32 v[68:69], v[68:69], v[164:165] op_sel_hi:[1,0]
    v_pk_mul_f32 v[70:71], v[70:71], v[164:165] op_sel_hi:[1,0]
    v_pk_fma_f32 v[64:65], v[168:169], v[164:165], v[64:65] op_sel:[0,1,0]
    v_pk_fma_f32 v[66:67], v[170:171], v[164:165], v[66:67] op_sel:[0,1,0]
    v_pk_fma_f32 v[68:69], v[172:173], v[164:165], v[68:69] op_sel:[0,1,0]
    v_pk_fma_f32 v[70:71], v[174:175], v[164:165], v[70:71] op_sel:[0,1,0]
    v_cvt_pk_bf16_f32 v152, v64, v65
    v_cvt_pk_bf16_f32 v153, v66, v67
    v_cvt_pk_bf16_f32 v154, v68, v69
    v_cvt_pk_bf16_f32 v155, v70, v71
    s_nop 1
    v_permlane16_swap_b32 v152, v154
    v_permlane16_swap_b32 v153, v155
    ds_write_b128 v5, v[152:155] offset:2048
    v_pk_mul_f32 v[88:89], v[88:89], v[166:167] op_sel_hi:[1,0]
    v_pk_mul_f32 v[90:91], v[90:91], v[166:167] op_sel_hi:[1,0]
    v_pk_mul_f32 v[92:93], v[92:93], v[166:167] op_sel_hi:[1,0]
    v_pk_mul_f32 v[94:95], v[94:95], v[166:167] op_sel_hi:[1,0]
    v_pk_fma_f32 v[88:89], v[168:169], v[166:167], v[88:89] op_sel:[0,1,0]
    v_pk_fma_f32 v[90:91], v[170:171], v[166:167], v[90:91] op_sel:[0,1,0]
    v_pk_fma_f32 v[92:93], v[172:173], v[166:167], v[92:93] op_sel:[0,1,0]
    v_pk_fma_f32 v[94:95], v[174:175], v[166:167], v[94:95] op_sel:[0,1,0]
    v_cvt_pk_bf16_f32 v156, v88, v89
    v_cvt_pk_bf16_f32 v157, v90, v91
    v_cvt_pk_bf16_f32 v158, v92, v93
    v_cvt_pk_bf16_f32 v159, v94, v95
    s_nop 1
    v_permlane16_swap_b32 v156, v158
    v_permlane16_swap_b32 v157, v159
    ds_write_b128 v5, v[156:159] offset:3072
    v_mov_b32 v3, 1
    s_waitcnt vmcnt(0)
    s_mov_b64 exec, 1
    ds_add_u32 v254, v3 offset:0
    s_mov_b64 exec, -1
L_attn:
    s_lshr_b32 s16, s3, 2
    s_and_b32 s17, s3, 3
    s_lshl_b32 s6, s5, 1
    s_add_u32 s18, s6, s16
    s_lshl_b32 s19, s18, 17
    s_lshl_b32 s26, s4, 2
    v_add_u32 v4, 2, v1
    v_subrev_u32 v4, s4, v4
    v_cmp_le_u32 s[56:57], 3, v4
    s_add_u32 s26, s26, s17
    v_and_b32 v1, 31, v0
    v_lshrrev_b32 v2, 5, v0
    s_add_u32 s12, s84, 8388608
    s_addc_u32 s13, s85, 0
    s_add_u32 s12, s12, s19
    s_addc_u32 s13, s13, 0
    s_mov_b32 s14, 131072
    s_mov_b32 s15, 0x20000
    s_add_u32 s20, s84, 12582912
    s_addc_u32 s21, s85, 0
    s_add_u32 s20, s20, s19
    s_addc_u32 s21, s21, 0
    s_mov_b32 s22, 131072
    s_mov_b32 s23, 0x20000
    s_add_u32 s40, s84, 16777216
    s_addc_u32 s41, s85, 0
    s_mov_b32 s42, 4194304
    s_mov_b32 s43, 0x20000
    s_mov_b32 s24, 0xf149f2ca
    v_mov_b32 v6, s24
    v_lshlrev_b32 v7, 2, v2
    v_sub_u32 v7, v1, v7
    s_cmp_lt_u32 s26, 8
    s_cselect_b32 s25, s24, 0
    v_mov_b32 v8, s25
    v_cmp_le_i32 vcc, 0, v7
    s_nop 1
    v_cndmask_b32 v160, v6, 0, vcc
    v_cndmask_b32 v32, v8, v6, vcc
    v_cmp_le_i32 vcc, 1, v7
    s_nop 1
    v_cndmask_b32 v161, v6, 0, vcc
    v_cndmask_b32 v33, v8, v6, vcc
    v_cmp_le_i32 vcc, 2, v7
    s_nop 1
    v_cndmask_b32 v162, v6, 0, vcc
    v_cndmask_b32 v34, v8, v6, vcc
    v_cmp_le_i32 vcc, 3, v7
    s_nop 1
    v_cndmask_b32 v163, v6, 0, vcc
    v_cndmask_b32 v35, v8, v6, vcc
    v_cmp_le_i32 vcc, 8, v7
    s_nop 1
    v_cndmask_b32 v164, v6, 0, vcc
    v_cndmask_b32 v36, v8, v6, vcc
    v_cmp_le_i32 vcc, 9, v7
    s_nop 1
    v_cndmask_b32 v165, v6, 0, vcc
    v_cndmask_b32 v37, v8, v6, vcc
    v_cmp_le_i32 vcc, 10, v7
    s_nop 1
    v_cndmask_b32 v166, v6, 0, vcc
    v_cndmask_b32 v38, v8, v6, vcc
    v_cmp_le_i32 vcc, 11, v7
    s_nop 1
    v_cndmask_b32 v167, v6, 0, vcc
    v_cndmask_b32 v39, v8, v6, vcc
    v_cmp_le_i32 vcc, 16, v7
    s_nop 1
    v_cndmask_b32 v168, v6, 0, vcc
    v_cndmask_b32 v40, v8, v6, vcc
    v_cmp_le_i32 vcc, 17, v7
    s_nop 1
    v_cndmask_b32 v169, v6, 0, vcc
    v_cndmask_b32 v41, v8, v6, vcc
    v_cmp_le_i32 vcc, 18, v7
    s_nop 1
    v_cndmask_b32 v170, v6, 0, vcc
    v_cndmask_b32 v42, v8, v6, vcc
    v_cmp_le_i32 vcc, 19, v7
    s_nop 1
    v_cndmask_b32 v171, v6, 0, vcc
    v_cndmask_b32 v43, v8, v6, vcc
    v_cmp_le_i32 vcc, 24, v7
    s_nop 1
    v_cndmask_b32 v172, v6, 0, vcc
    v_cndmask_b32 v44, v8, v6, vcc
    v_cmp_le_i32 vcc, 25, v7
    s_nop 1
    v_cndmask_b32 v173, v6, 0, vcc
    v_cndmask_b32 v45, v8, v6, vcc
    v_cmp_le_i32 vcc, 26, v7
    s_nop 1
    v_cndmask_b32 v174, v6, 0, vcc
    v_cndmask_b32 v46, v8, v6, vcc
    v_cmp_le_i32 vcc, 27, v7
    s_nop 1
    v_cndmask_b32 v175, v6, 0, vcc
    v_cndmask_b32 v47, v8, v6, vcc
    s_add_u32 s27, s26, 1
    s_cmp_lt_u32 s27, 8
    s_cselect_b32 s27, s24, 0
    v_mov_b32 v48, s27
    v_mov_b32 v49, s27
    v_mov_b32 v50, s27
    v_mov_b32 v51, s27
    v_mov_b32 v52, s27
    v_mov_b32 v53, s27
    v_mov_b32 v54, s27
    v_mov_b32 v55, s27
    v_mov_b32 v56, s27
    v_mov_b32 v57, s27
    v_mov_b32 v58, s27
    v_mov_b32 v59, s27
    v_mov_b32 v60, s27
    v_mov_b32 v61, s27
    v_mov_b32 v62, s27
    v_mov_b32 v63, s27
    s_add_u32 s27, s26, 2
    s_cmp_lt_u32 s27, 8
    s_cselect_b32 s27, s24, 0
    v_mov_b32 v64, s27
    v_mov_b32 v65, s27
    v_mov_b32 v66, s27
    v_mov_b32 v67, s27
    v_mov_b32 v68, s27
    v_mov_b32 v69, s27
    v_mov_b32 v70, s27
    v_mov_b32 v71, s27
    v_mov_b32 v72, s27
    v_mov_b32 v73, s27
    v_mov_b32 v74, s27
    v_mov_b32 v75, s27
    v_mov_b32 v76, s27
    v_mov_b32 v77, s27
    v_mov_b32 v78, s27
    v_mov_b32 v79, s27
    s_add_u32 s27, s26, 3
    s_cmp_lt_u32 s27, 8
    s_cselect_b32 s27, s24, 0
    v_mov_b32 v80, s27
    v_mov_b32 v81, s27
    v_mov_b32 v82, s27
    v_mov_b32 v83, s27
    v_mov_b32 v84, s27
    v_mov_b32 v85, s27
    v_mov_b32 v86, s27
    v_mov_b32 v87, s27
    v_mov_b32 v88, s27
    v_mov_b32 v89, s27
    v_mov_b32 v90, s27
    v_mov_b32 v91, s27
    v_mov_b32 v92, s27
    v_mov_b32 v93, s27
    v_mov_b32 v94, s27
    v_mov_b32 v95, s27
    s_add_u32 s27, s26, 4
    s_cmp_lt_u32 s27, 8
    s_cselect_b32 s27, s24, 0
    v_mov_b32 v96, s27
    v_mov_b32 v97, s27
    v_mov_b32 v98, s27
    v_mov_b32 v99, s27
    v_mov_b32 v100, s27
    v_mov_b32 v101, s27
    v_mov_b32 v102, s27
    v_mov_b32 v103, s27
    v_mov_b32 v104, s27
    v_mov_b32 v105, s27
    v_mov_b32 v106, s27
    v_mov_b32 v107, s27
    v_mov_b32 v108, s27
    v_mov_b32 v109, s27
    v_mov_b32 v110, s27
    v_mov_b32 v111, s27
    s_add_u32 s27, s26, 5
    s_cmp_lt_u32 s27, 8
    s_cselect_b32 s27, s24, 0
    v_mov_b32 v112, s27
    v_mov_b32 v113, s27
    v_mov_b32 v114, s27
    v_mov_b32 v115, s27
    v_mov_b32 v116, s27
    v_mov_b32 v117, s27
    v_mov_b32 v118, s27
    v_mov_b32 v119, s27
    v_mov_b32 v120, s27
    v_mov_b32 v121, s27
    v_mov_b32 v122, s27
    v_mov_b32 v123, s27
    v_mov_b32 v124, s27
    v_mov_b32 v125, s27
    v_mov_b32 v126, s27
    v_mov_b32 v127, s27
    s_add_u32 s27, s26, 6
    s_cmp_lt_u32 s27, 8
    s_cselect_b32 s27, s24, 0
    v_mov_b32 v128, s27
    v_mov_b32 v129, s27
    v_mov_b32 v130, s27
    v_mov_b32 v131, s27
    v_mov_b32 v132, s27
    v_mov_b32 v133, s27
    v_mov_b32 v134, s27
    v_mov_b32 v135, s27
    v_mov_b32 v136, s27
    v_mov_b32 v137, s27
    v_mov_b32 v138, s27
    v_mov_b32 v139, s27
    v_mov_b32 v140, s27
    v_mov_b32 v141, s27
    v_mov_b32 v142, s27
    v_mov_b32 v143, s27
    s_add_u32 s27, s26, 7
    s_cmp_lt_u32 s27, 8
    s_cselect_b32 s27, s24, 0
    v_mov_b32 v144, s27
    v_mov_b32 v145, s27
    v_mov_b32 v146, s27
    v_mov_b32 v147, s27
    v_mov_b32 v148, s27
    v_mov_b32 v149, s27
    v_mov_b32 v150, s27
    v_mov_b32 v151, s27
    v_mov_b32 v152, s27
    v_mov_b32 v153, s27
    v_mov_b32 v154, s27
    v_mov_b32 v155, s27
    v_mov_b32 v156, s27
    v_mov_b32 v157, s27
    v_mov_b32 v158, s27
    v_mov_b32 v159, s27
    v_mov_b32 v176, 0
    v_mov_b32 v177, 0
    v_mov_b32 v178, 0
    v_mov_b32 v179, 0
    v_mov_b32 v180, 0
    v_mov_b32 v181, 0
    v_mov_b32 v182, 0
    v_mov_b32 v183, 0
    v_mov_b32 v184, 0
    v_mov_b32 v185, 0
    v_mov_b32 v186, 0
    v_mov_b32 v187, 0
    v_mov_b32 v188, 0
    v_mov_b32 v189, 0
    v_mov_b32 v190, 0
    v_mov_b32 v191, 0
    v_mov_b32 v192, 0
    v_mov_b32 v193, 0
    v_mov_b32 v194, 0
    v_mov_b32 v195, 0
    v_mov_b32 v196, 0
    v_mov_b32 v197, 0
    v_mov_b32 v198, 0
    v_mov_b32 v199, 0
    v_mov_b32 v200, 0
    v_mov_b32 v201, 0
    v_mov_b32 v202, 0
    v_mov_b32 v203, 0
    v_mov_b32 v204, 0
    v_mov_b32 v205, 0
    v_mov_b32 v206, 0
    v_mov_b32 v207, 0
    v_mov_b32 v248, 0x3f803f80
    v_mov_b32 v249, 0x3f803f80
    v_mov_b32 v250, 0x3f803f80
    v_mov_b32 v251, 0x3f803f80
    v_lshrrev_b32 v9, 2, v1
    v_and_b32 v9, 3, v9
    v_xor_b32 v9, v9, v2
    v_lshlrev_b32 v9, 4, v9
    v_lshl_add_u32 v9, v1, 6, v9
    s_mul_i32 s27, s16, 24576
    s_lshl_b32 s6, s17, 11
    s_add_u32 s7, s6, s27
    v_add_u32 v9, s7, v9
    v_xor_b32 v10, 32, v9
    v_bfe_u32 v11, v0, 2, 2
    v_lshl_add_u32 v11, v2, 2, v11
    v_lshlrev_b32 v11, 6, v11
    v_bfe_u32 v12, v0, 4, 1
    v_lshl_add_u32 v11, v12, 5, v11
    v_and_b32 v12, 3, v0
    v_lshl_add_u32 v11, v12, 3, v11
    s_add_u32 s7, s7, 49152
    v_add_u32 v11, s7, v11
    v_lshlrev_b32 v12, 6, v1
    v_lshl_add_u32 v12, v2, 4, v12
    s_lshl_b32 s28, s3, 11
    s_add_u32 s28, s28, 98304
    v_add_u32 v12, s28, v12
    s_lshl_b32 s6, s17, 10
    s_add_u32 s27, s27, s6
    s_lshl_b32 s7, s4, 13
    s_add_u32 s6, s6, s7
    s_sub_u32 s6, s6, 16384
    v_lshlrev_b32 v4, 4, v0
    v_and_b32 v5, 48, v0
    v_xor_b32 v5, v4, v5
    v_add_u32 v4, s6, v4
    v_add_u32 v5, s6, v5
    s_cmp_lg_u32 s3, 4
    s_cbranch_scc1 L_oth2
    v_and_b32 v15, 15, v0
    v_lshlrev_b32 v15, 2, v15
L_spin4:
    ds_read_b32 v14, v254 offset:0
    s_sub_u32 s37, s37, 1
    s_cselect_b32 s37, 0, s37
    s_cbranch_scc1 L_spin4x
    s_waitcnt lgkmcnt(0)
    v_readfirstlane_b32 s6, v14
    s_cmp_ge_u32 s6, 4
    s_cbranch_scc1 L_spin4x
    s_sleep 1
    s_branch L_spin4
L_spin4x:
    s_waitcnt lgkmcnt(0)
    s_cmp_lg_u32 s3, 4
    s_cbranch_scc1 L_pub5
    s_lshl_b32 s6, s5, 7
    s_add_u32 s6, s6, s4
    s_lshl_b32 s6, s6, 2
    s_add_u32 s6, s6, 0
    v_mov_b32 v3, 1
    s_mov_b64 exec, 1
    buffer_store_dword v3, off, s[60:63], s6 sc1
    s_mov_b64 exec, -1
L_pub5:
    s_lshl_b32 s6, s5, 9
    s_add_u32 s6, s6, 0
L_poll3:
    buffer_load_dword v14, v15, s[60:63], s6 offen sc1
    s_sub_u32 s37, s37, 1
    s_cselect_b32 s37, 0, s37
    s_cbranch_scc1 L_poll3x
    s_waitcnt vmcnt(0)
    v_cmp_eq_u32 vcc, 1, v14
    s_or_b64 vcc, vcc, s[56:57]
    s_cmp_eq_u64 vcc, -1
    s_cbranch_scc1 L_poll3x
    s_sleep 1
    s_branch L_poll3
L_poll3x:
    ds_write_b32 v254, v254 offset:4
    s_branch L_oth2x
L_oth2:
L_spin6:
    ds_read_b32 v14, v254 offset:4
    s_sub_u32 s37, s37, 1
    s_cselect_b32 s37, 0, s37
    s_cbranch_scc1 L_spin6x
    s_waitcnt lgkmcnt(0)
    v_readfirstlane_b32 s6, v14
    s_cmp_ge_u32 s6, 1
    s_cbranch_scc1 L_spin6x
    s_sleep 1
    s_branch L_spin6
L_spin6x:
    s_waitcnt lgkmcnt(0)
L_oth2x:
    s_add_u32 m0, s27, 0
    s_nop 0
    buffer_load_dwordx4 v5, s[12:15], 0 offen sc1 lds
    v_add_u32 v5, 4096, v5
    s_add_u32 m0, s27, 4096
    s_nop 0
    buffer_load_dwordx4 v5, s[12:15], 0 offen sc1 lds
    v_add_u32 v5, 4096, v5
    s_add_u32 m0, s27, 8192
    s_nop 0
    buffer_load_dwordx4 v5, s[12:15], 0 offen sc1 lds
    v_add_u32 v5, 4096, v5
    s_add_u32 m0, s27, 12288
    s_nop 0
    buffer_load_dwordx4 v5, s[12:15], 0 offen sc1 lds
    v_add_u32 v5, 4096, v5
    s_add_u32 m0, s27, 16384
    s_nop 0
    buffer_load_dwordx4 v5, s[12:15], 0 offen sc1 lds
    v_add_u32 v5, 4096, v5
    s_add_u32 m0, s27, 20480
    s_nop 0
    buffer_load_dwordx4 v5, s[12:15], 0 offen sc1 lds
    v_add_u32 v5, 4096, v5
    s_add_u32 m0, s27, 49152
    s_nop 0
    buffer_load_dwordx4 v4, s[20:23], 0 offen sc1 lds
    v_add_u32 v4, 4096, v4
    s_add_u32 m0, s27, 53248
    s_nop 0
    buffer_load_dwordx4 v4, s[20:23], 0 offen sc1 lds
    v_add_u32 v4, 4096, v4
    s_add_u32 m0, s27, 57344
    s_nop 0
    buffer_load_dwordx4 v4, s[20:23], 0 offen sc1 lds
    v_add_u32 v4, 4096, v4
    s_add_u32 m0, s27, 61440
    s_nop 0
    buffer_load_dwordx4 v4, s[20:23], 0 offen sc1 lds
    v_add_u32 v4, 4096, v4
    s_add_u32 m0, s27, 65536
    s_nop 0
    buffer_load_dwordx4 v4, s[20:23], 0 offen sc1 lds
    v_add_u32 v4, 4096, v4
    s_add_u32 m0, s27, 69632
    s_nop 0
    buffer_load_dwordx4 v4, s[20:23], 0 offen sc1 lds
    v_add_u32 v4, 4096, v4
    s_waitcnt vmcnt(6)
    s_barrier
    ds_read_b128 v[208:211], v12
    ds_read_b128 v[212:215], v12 offset:32
    ds_read_b128 v[216:219], v9 offset:0
    ds_read_b128 v[220:223], v10 offset:0
    ds_read_b128 v[224:227], v9 offset:2048
    ds_read_b128 v[228:231], v10 offset:2048
    ds_read_b128 v[232:235], v9 offset:4096
    ds_read_b128 v[236:239], v10 offset:4096
    ds_read_b128 v[240:243], v9 offset:6144
    ds_read_b128 v[244:247], v10 offset:6144
    s_waitcnt lgkmcnt(6)
    v_mfma_f32_32x32x16_bf16 v[32:47], v[216:219], v[208:211], v[32:47]
    v_mfma_f32_32x32x16_bf16 v[32:47], v[220:223], v[212:215], v[32:47]
    ds_read_b128 v[216:219], v9 offset:8192
    ds_read_b128 v[220:223], v10 offset:8192
    s_waitcnt lgkmcnt(6)
    v_mfma_f32_32x32x16_bf16 v[48:63], v[224:227], v[208:211], v[48:63]
    v_mfma_f32_32x32x16_bf16 v[48:63], v[228:231], v[212:215], v[48:63]
    ds_read_b128 v[224:227], v9 offset:10240
    ds_read_b128 v[228:231], v10 offset:10240
    s_waitcnt lgkmcnt(6)
    v_mfma_f32_32x32x16_bf16 v[64:79], v[232:235], v[208:211], v[64:79]
    v_mfma_f32_32x32x16_bf16 v[64:79], v[236:239], v[212:215], v[64:79]
    s_nop 1
    v_max_f32 v13, v32, v33
    v_max3_f32 v13, v34, v35, v13
    v_max3_f32 v13, v36, v37, v13
    v_max3_f32 v13, v38, v39, v13
    v_max3_f32 v13, v40, v41, v13
    v_max3_f32 v13, v42, v43, v13
    v_max3_f32 v13, v44, v45, v13
    v_max3_f32 v13, v46, v47, v13
    ds_read_b128 v[232:235], v9 offset:12288
    ds_read_b128 v[236:239], v10 offset:12288
    s_waitcnt lgkmcnt(6)
    v_mfma_f32_32x32x16_bf16 v[80:95], v[240:243], v[208:211], v[80:95]
    v_mfma_f32_32x32x16_bf16 v[80:95], v[244:247], v[212:215], v[80:95]
    v_max3_f32 v13, v48, v49, v13
    v_max3_f32 v13, v50, v51, v13
    v_max3_f32 v13, v52, v53, v13
    v_max3_f32 v13, v54, v55, v13
    v_max3_f32 v13, v56, v57, v13
    v_max3_f32 v13, v58, v59, v13
    v_max3_f32 v13, v60, v61, v13
    v_max3_f32 v13, v62, v63, v13
    ds_read_b128 v[240:243], v9 offset:14336
    ds_read_b128 v[244:247], v10 offset:14336
    s_waitcnt lgkmcnt(6)
    v_mfma_f32_32x32x16_bf16 v[96:111], v[216:219], v[208:211], v[96:111]
    v_mfma_f32_32x32x16_bf16 v[96:111], v[220:223], v[212:215], v[96:111]
    v_max3_f32 v13, v64, v65, v13
    v_max3_f32 v13, v66, v67, v13
    v_max3_f32 v13, v68, v69, v13
    v_max3_f32 v13, v70, v71, v13
    v_max3_f32 v13, v72, v73, v13
    v_max3_f32 v13, v74, v75, v13
    v_max3_f32 v13, v76, v77, v13
    v_max3_f32 v13, v78, v79, v13
    ds_read_b128 v[216:219], v9 offset:16384
    ds_read_b128 v[220:223], v10 offset:16384
    s_waitcnt lgkmcnt(6)
    v_mfma_f32_32x32x16_bf16 v[112:127], v[224:227], v[208:211], v[112:127]
    v_mfma_f32_32x32x16_bf16 v[112:127], v[228:231], v[212:215], v[112:127]
    v_max3_f32 v13, v80, v81, v13
    v_max3_f32 v13, v82, v83, v13
    v_max3_f32 v13, v84, v85, v13
    v_max3_f32 v13, v86, v87, v13
    v_max3_f32 v13, v88, v89, v13
    v_max3_f32 v13, v90, v91, v13
    v_max3_f32 v13, v92, v93, v13
    v_max3_f32 v13, v94, v95, v13
    s_waitcnt lgkmcnt(4)
    v_mfma_f32_32x32x16_bf16 v[128:143], v[232:235], v[208:211], v[128:143]
    v_mfma_f32_32x32x16_bf16 v[128:143], v[236:239], v[212:215], v[128:143]
    v_max3_f32 v13, v96, v97, v13
    v_max3_f32 v13, v98, v99, v13
    v_max3_f32 v13, v100, v101, v13
    v_max3_f32 v13, v102, v103, v13
    v_max3_f32 v13, v104, v105, v13
    v_max3_f32 v13, v106, v107, v13
    v_max3_f32 v13, v108, v109, v13
    v_max3_f32 v13, v110, v111, v13
    s_waitcnt lgkmcnt(2)
    v_mfma_f32_32x32x16_bf16 v[144:159], v[240:243], v[208:211], v[144:159]
    v_mfma_f32_32x32x16_bf16 v[144:159], v[244:247], v[212:215], v[144:159]
    v_max3_f32 v13, v112, v113, v13
    v_max3_f32 v13, v114, v115, v13
    v_max3_f32 v13, v116, v117, v13
    v_max3_f32 v13, v118, v119, v13
    v_max3_f32 v13, v120, v121, v13
    v_max3_f32 v13, v122, v123, v13
    v_max3_f32 v13, v124, v125, v13
    v_max3_f32 v13, v126, v127, v13
    s_waitcnt lgkmcnt(0)
    v_mfma_f32_32x32x16_bf16 v[160:175], v[216:219], v[208:211], v[160:175]
    v_mfma_f32_32x32x16_bf16 v[160:175], v[220:223], v[212:215], v[160:175]
    v_max3_f32 v13, v128, v129, v13
    v_max3_f32 v13, v130, v131, v13
    v_max3_f32 v13, v132, v133, v13
    v_max3_f32 v13, v134, v135, v13
    v_max3_f32 v13, v136, v137, v13
    v_max3_f32 v13, v138, v139, v13
    v_max3_f32 v13, v140, v141, v13
    v_max3_f32 v13, v142, v143, v13
    s_waitcnt vmcnt(0)
    s_barrier
    s_cmp_lt_u32 s3, 4
    s_cbranch_scc1 L_nst
    s_add_u32 m0, s32, 122880
    s_nop 0
    buffer_load_dwordx4 v16, s[44:47], s33 offen lds
    s_add_u32 m0, s32, 126976
    s_nop 0
    buffer_load_dwordx4 v17, s[44:47], s33 offen lds
    s_add_u32 m0, s32, 131072
    s_nop 0
    buffer_load_dwordx4 v18, s[44:47], s33 offen lds
    s_add_u32 m0, s32, 135168
    s_nop 0
    buffer_load_dwordx4 v19, s[44:47], s33 offen lds
    s_add_u32 m0, s32, 139264
    s_nop 0
    buffer_load_dwordx4 v24, s[44:47], s33 offen lds
    s_add_u32 m0, s32, 143360
    s_nop 0
    buffer_load_dwordx4 v25, s[44:47], s33 offen lds
    s_add_u32 m0, s32, 147456
    s_nop 0
    buffer_load_dwordx4 v26, s[44:47], s33 offen lds
L_nst:
    ds_read_b64_tr_b16 v[216:217], v11 offset:0
    ds_read_b64_tr_b16 v[218:219], v11 offset:512
    ds_read_b64_tr_b16 v[220:221], v11 offset:1024
    ds_read_b64_tr_b16 v[222:223], v11 offset:1536
    ds_read_b64_tr_b16 v[224:225], v11 offset:2048
    ds_read_b64_tr_b16 v[226:227], v11 offset:2560
    ds_read_b64_tr_b16 v[228:229], v11 offset:3072
    ds_read_b64_tr_b16 v[230:231], v11 offset:3584
    s_nop 3
    v_max3_f32 v13, v144, v145, v13
    v_max3_f32 v13, v146, v147, v13
    v_max3_f32 v13, v148, v149, v13
    v_max3_f32 v13, v150, v151, v13
    v_max3_f32 v13, v152, v153, v13
    v_max3_f32 v13, v154, v155, v13
    v_max3_f32 v13, v156, v157, v13
    v_max3_f32 v13, v158, v159, v13
    v_max3_f32 v13, v160, v161, v13
    v_max3_f32 v13, v162, v163, v13
    v_max3_f32 v13, v164, v165, v13
    v_max3_f32 v13, v166, v167, v13
    v_max3_f32 v13, v168, v169, v13
    v_max3_f32 v13, v170, v171, v13
    v_max3_f32 v13, v172, v173, v13
    v_max3_f32 v13, v174, v175, v13
    v_mov_b32 v14, v13
    s_mov_b32 s24, 0x3e8293ee
    s_mov_b32 s25, s24
    v_permlane32_swap_b32 v14, v13
    v_max_f32 v13, v13, v14
    v_mul_f32_e64 v14, s24, -v13
    v_mov_b32 v15, v14
    ds_read_b64_tr_b16 v[232:233], v11 offset:4096
    ds_read_b64_tr_b16 v[234:235], v11 offset:4608
    ds_read_b64_tr_b16 v[236:237], v11 offset:5120
    ds_read_b64_tr_b16 v[238:239], v11 offset:5632
    v_pk_fma_f32 v[32:33], v[32:33], s[24:25], v[14:15]
    v_pk_fma_f32 v[34:35], v[34:35], s[24:25], v[14:15]
    v_pk_fma_f32 v[36:37], v[36:37], s[24:25], v[14:15]
    v_pk_fma_f32 v[38:39], v[38:39], s[24:25], v[14:15]
    v_pk_fma_f32 v[40:41], v[40:41], s[24:25], v[14:15]
    v_pk_fma_f32 v[42:43], v[42:43], s[24:25], v[14:15]
    v_pk_fma_f32 v[44:45], v[44:45], s[24:25], v[14:15]
    v_pk_fma_f32 v[46:47], v[46:47], s[24:25], v[14:15]
    v_exp_f32 v32, v32
    v_exp_f32 v33, v33
    v_exp_f32 v34, v34
    v_exp_f32 v35, v35
    v_exp_f32 v36, v36
    v_exp_f32 v37, v37
    v_exp_f32 v38, v38
    v_exp_f32 v39, v39
    v_exp_f32 v40, v40
    v_exp_f32 v41, v41
    v_exp_f32 v42, v42
    v_exp_f32 v43, v43
    v_exp_f32 v44, v44
    v_exp_f32 v45, v45
    v_exp_f32 v46, v46
    v_exp_f32 v47, v47
    v_cvt_pk_bf16_f32 v32, v32, v33
    v_cvt_pk_bf16_f32 v33, v34, v35
    v_cvt_pk_bf16_f32 v34, v36, v37
    v_cvt_pk_bf16_f32 v35, v38, v39
    v_cvt_pk_bf16_f32 v36, v40, v41
    v_cvt_pk_bf16_f32 v37, v42, v43
    v_cvt_pk_bf16_f32 v38, v44, v45
    v_cvt_pk_bf16_f32 v39, v46, v47
    s_waitcnt lgkmcnt(8)
    s_nop 0
    v_mfma_f32_32x32x16_bf16 v[176:191], v[216:219], v[32:35], v[176:191]
    v_mfma_f32_32x32x16_bf16 v[192:207], v[248:251], v[32:35], v[192:207]
    v_mfma_f32_32x32x16_bf16 v[176:191], v[220:223], v[36:39], v[176:191]
    v_mfma_f32_32x32x16_bf16 v[192:207], v[248:251], v[36:39], v[192:207]
    ds_read_b64_tr_b16 v[240:241], v11 offset:6144
    ds_read_b64_tr_b16 v[242:243], v11 offset:6656
    ds_read_b64_tr_b16 v[244:245], v11 offset:7168
    ds_read_b64_tr_b16 v[246:247], v11 offset:7680
    v_pk_fma_f32 v[48:49], v[48:49], s[24:25], v[14:15]
    v_pk_fma_f32 v[50:51], v[50:51], s[24:25], v[14:15]
    v_pk_fma_f32 v[52:53], v[52:53], s[24:25], v[14:15]
    v_pk_fma_f32 v[54:55], v[54:55], s[24:25], v[14:15]
    v_pk_fma_f32 v[56:57], v[56:57], s[24:25], v[14:15]
    v_pk_fma_f32 v[58:59], v[58:59], s[24:25], v[14:15]
    v_pk_fma_f32 v[60:61], v[60:61], s[24:25], v[14:15]
    v_pk_fma_f32 v[62:63], v[62:63], s[24:25], v[14:15]
    v_exp_f32 v48, v48
    v_exp_f32 v49, v49
    v_exp_f32 v50, v50
    v_exp_f32 v51, v51
    v_exp_f32 v52, v52
    v_exp_f32 v53, v53
    v_exp_f32 v54, v54
    v_exp_f32 v55, v55
    v_exp_f32 v56, v56
    v_exp_f32 v57, v57
    v_exp_f32 v58, v58
    v_exp_f32 v59, v59
    v_exp_f32 v60, v60
    v_exp_f32 v61, v61
    v_exp_f32 v62, v62
    v_exp_f32 v63, v63
    v_cvt_pk_bf16_f32 v48, v48, v49
    v_cvt_pk_bf16_f32 v49, v50, v51
    v_cvt_pk_bf16_f32 v50, v52, v53
    v_cvt_pk_bf16_f32 v51, v54, v55
    v_cvt_pk_bf16_f32 v52, v56, v57
    v_cvt_pk_bf16_f32 v53, v58, v59
    v_cvt_pk_bf16_f32 v54, v60, v61
    v_cvt_pk_bf16_f32 v55, v62, v63
    s_waitcnt lgkmcnt(8)
    s_nop 0
    v_mfma_f32_32x32x16_bf16 v[176:191], v[224:227], v[48:51], v[176:191]
    v_mfma_f32_32x32x16_bf16 v[192:207], v[248:251], v[48:51], v[192:207]
    v_mfma_f32_32x32x16_bf16 v[176:191], v[228:231], v[52:55], v[176:191]
    v_mfma_f32_32x32x16_bf16 v[192:207], v[248:251], v[52:55], v[192:207]
    ds_read_b64_tr_b16 v[216:217], v11 offset:8192
    ds_read_b64_tr_b16 v[218:219], v11 offset:8704
    ds_read_b64_tr_b16 v[220:221], v11 offset:9216
    ds_read_b64_tr_b16 v[222:223], v11 offset:9728
    v_pk_fma_f32 v[64:65], v[64:65], s[24:25], v[14:15]
    v_pk_fma_f32 v[66:67], v[66:67], s[24:25], v[14:15]
    v_pk_fma_f32 v[68:69], v[68:69], s[24:25], v[14:15]
    v_pk_fma_f32 v[70:71], v[70:71], s[24:25], v[14:15]
    v_pk_fma_f32 v[72:73], v[72:73], s[24:25], v[14:15]
    v_pk_fma_f32 v[74:75], v[74:75], s[24:25], v[14:15]
    v_pk_fma_f32 v[76:77], v[76:77], s[24:25], v[14:15]
    v_pk_fma_f32 v[78:79], v[78:79], s[24:25], v[14:15]
    v_exp_f32 v64, v64
    v_exp_f32 v65, v65
    v_exp_f32 v66, v66
    v_exp_f32 v67, v67
    v_exp_f32 v68, v68
    v_exp_f32 v69, v69
    v_exp_f32 v70, v70
    v_exp_f32 v71, v71
    v_exp_f32 v72, v72
    v_exp_f32 v73, v73
    v_exp_f32 v74, v74
    v_exp_f32 v75, v75
    v_exp_f32 v76, v76
    v_exp_f32 v77, v77
    v_exp_f32 v78, v78
    v_exp_f32 v79, v79
    v_cvt_pk_bf16_f32 v64, v64, v65
    v_cvt_pk_bf16_f32 v65, v66, v67
    v_cvt_pk_bf16_f32 v66, v68, v69
    v_cvt_pk_bf16_f32 v67, v70, v71
    v_cvt_pk_bf16_f32 v68, v72, v73
    v_cvt_pk_bf16_f32 v69, v74, v75
    v_cvt_pk_bf16_f32 v70, v76, v77
    v_cvt_pk_bf16_f32 v71, v78, v79
    s_waitcnt lgkmcnt(8)
    s_nop 0
    v_mfma_f32_32x32x16_bf16 v[176:191], v[232:235], v[64:67], v[176:191]
    v_mfma_f32_32x32x16_bf16 v[192:207], v[248:251], v[64:67], v[192:207]
    v_mfma_f32_32x32x16_bf16 v[176:191], v[236:239], v[68:71], v[176:191]
    v_mfma_f32_32x32x16_bf16 v[192:207], v[248:251], v[68:71], v[192:207]
    ds_read_b64_tr_b16 v[224:225], v11 offset:10240
    ds_read_b64_tr_b16 v[226:227], v11 offset:10752
    ds_read_b64_tr_b16 v[228:229], v11 offset:11264
    ds_read_b64_tr_b16 v[230:231], v11 offset:11776
    v_pk_fma_f32 v[80:81], v[80:81], s[24:25], v[14:15]
    v_pk_fma_f32 v[82:83], v[82:83], s[24:25], v[14:15]
    v_pk_fma_f32 v[84:85], v[84:85], s[24:25], v[14:15]
    v_pk_fma_f32 v[86:87], v[86:87], s[24:25], v[14:15]
    v_pk_fma_f32 v[88:89], v[88:89], s[24:25], v[14:15]
    v_pk_fma_f32 v[90:91], v[90:91], s[24:25], v[14:15]
    v_pk_fma_f32 v[92:93], v[92:93], s[24:25], v[14:15]
    v_pk_fma_f32 v[94:95], v[94:95], s[24:25], v[14:15]
    v_exp_f32 v80, v80
    v_exp_f32 v81, v81
    v_exp_f32 v82, v82
    v_exp_f32 v83, v83
    v_exp_f32 v84, v84
    v_exp_f32 v85, v85
    v_exp_f32 v86, v86
    v_exp_f32 v87, v87
    v_exp_f32 v88, v88
    v_exp_f32 v89, v89
    v_exp_f32 v90, v90
    v_exp_f32 v91, v91
    v_exp_f32 v92, v92
    v_exp_f32 v93, v93
    v_exp_f32 v94, v94
    v_exp_f32 v95, v95
    v_cvt_pk_bf16_f32 v80, v80, v81
    v_cvt_pk_bf16_f32 v81, v82, v83
    v_cvt_pk_bf16_f32 v82, v84, v85
    v_cvt_pk_bf16_f32 v83, v86, v87
    v_cvt_pk_bf16_f32 v84, v88, v89
    v_cvt_pk_bf16_f32 v85, v90, v91
    v_cvt_pk_bf16_f32 v86, v92, v93
    v_cvt_pk_bf16_f32 v87, v94, v95
    s_waitcnt lgkmcnt(8)
    s_nop 0
    v_mfma_f32_32x32x16_bf16 v[176:191], v[240:243], v[80:83], v[176:191]
    v_mfma_f32_32x32x16_bf16 v[192:207], v[248:251], v[80:83], v[192:207]
    v_mfma_f32_32x32x16_bf16 v[176:191], v[244:247], v[84:87], v[176:191]
    v_mfma_f32_32x32x16_bf16 v[192:207], v[248:251], v[84:87], v[192:207]
    ds_read_b64_tr_b16 v[232:233], v11 offset:12288
    ds_read_b64_tr_b16 v[234:235], v11 offset:12800
    ds_read_b64_tr_b16 v[236:237], v11 offset:13312
    ds_read_b64_tr_b16 v[238:239], v11 offset:13824
    v_pk_fma_f32 v[96:97], v[96:97], s[24:25], v[14:15]
    v_pk_fma_f32 v[98:99], v[98:99], s[24:25], v[14:15]
    v_pk_fma_f32 v[100:101], v[100:101], s[24:25], v[14:15]
    v_pk_fma_f32 v[102:103], v[102:103], s[24:25], v[14:15]
    v_pk_fma_f32 v[104:105], v[104:105], s[24:25], v[14:15]
    v_pk_fma_f32 v[106:107], v[106:107], s[24:25], v[14:15]
    v_pk_fma_f32 v[108:109], v[108:109], s[24:25], v[14:15]
    v_pk_fma_f32 v[110:111], v[110:111], s[24:25], v[14:15]
    v_exp_f32 v96, v96
    v_exp_f32 v97, v97
    v_exp_f32 v98, v98
    v_exp_f32 v99, v99
    v_exp_f32 v100, v100
    v_exp_f32 v101, v101
    v_exp_f32 v102, v102
    v_exp_f32 v103, v103
    v_exp_f32 v104, v104
    v_exp_f32 v105, v105
    v_exp_f32 v106, v106
    v_exp_f32 v107, v107
    v_exp_f32 v108, v108
    v_exp_f32 v109, v109
    v_exp_f32 v110, v110
    v_exp_f32 v111, v111
    v_cvt_pk_bf16_f32 v96, v96, v97
    v_cvt_pk_bf16_f32 v97, v98, v99
    v_cvt_pk_bf16_f32 v98, v100, v101
    v_cvt_pk_bf16_f32 v99, v102, v103
    v_cvt_pk_bf16_f32 v100, v104, v105
    v_cvt_pk_bf16_f32 v101, v106, v107
    v_cvt_pk_bf16_f32 v102, v108, v109
    v_cvt_pk_bf16_f32 v103, v110, v111
    s_waitcnt lgkmcnt(8)
    s_nop 0
    v_mfma_f32_32x32x16_bf16 v[176:191], v[216:219], v[96:99], v[176:191]
    v_mfma_f32_32x32x16_bf16 v[192:207], v[248:251], v[96:99], v[192:207]
    v_mfma_f32_32x32x16_bf16 v[176:191], v[220:223], v[100:103], v[176:191]
    v_mfma_f32_32x32x16_bf16 v[192:207], v[248:251], v[100:103], v[192:207]
    ds_read_b64_tr_b16 v[240:241], v11 offset:14336
    ds_read_b64_tr_b16 v[242:243], v11 offset:14848
    ds_read_b64_tr_b16 v[244:245], v11 offset:15360
    ds_read_b64_tr_b16 v[246:247], v11 offset:15872
    v_pk_fma_f32 v[112:113], v[112:113], s[24:25], v[14:15]
    v_pk_fma_f32 v[114:115], v[114:115], s[24:25], v[14:15]
    v_pk_fma_f32 v[116:117], v[116:117], s[24:25], v[14:15]
    v_pk_fma_f32 v[118:119], v[118:119], s[24:25], v[14:15]
    v_pk_fma_f32 v[120:121], v[120:121], s[24:25], v[14:15]
    v_pk_fma_f32 v[122:123], v[122:123], s[24:25], v[14:15]
    v_pk_fma_f32 v[124:125], v[124:125], s[24:25], v[14:15]
    v_pk_fma_f32 v[126:127], v[126:127], s[24:25], v[14:15]
    v_exp_f32 v112, v112
    v_exp_f32 v113, v113
    v_exp_f32 v114, v114
    v_exp_f32 v115, v115
    v_exp_f32 v116, v116
    v_exp_f32 v117, v117
    v_exp_f32 v118, v118
    v_exp_f32 v119, v119
    v_exp_f32 v120, v120
    v_exp_f32 v121, v121
    v_exp_f32 v122, v122
    v_exp_f32 v123, v123
    v_exp_f32 v124, v124
    v_exp_f32 v125, v125
    v_exp_f32 v126, v126
    v_exp_f32 v127, v127
    v_cvt_pk_bf16_f32 v112, v112, v113
    v_cvt_pk_bf16_f32 v113, v114, v115
    v_cvt_pk_bf16_f32 v114, v116, v117
    v_cvt_pk_bf16_f32 v115, v118, v119
    v_cvt_pk_bf16_f32 v116, v120, v121
    v_cvt_pk_bf16_f32 v117, v122, v123
    v_cvt_pk_bf16_f32 v118, v124, v125
    v_cvt_pk_bf16_f32 v119, v126, v127
    s_waitcnt lgkmcnt(8)
    s_nop 0
    v_mfma_f32_32x32x16_bf16 v[176:191], v[224:227], v[112:115], v[176:191]
    v_mfma_f32_32x32x16_bf16 v[192:207], v[248:251], v[112:115], v[192:207]
    v_mfma_f32_32x32x16_bf16 v[176:191], v[228:231], v[116:119], v[176:191]
    v_mfma_f32_32x32x16_bf16 v[192:207], v[248:251], v[116:119], v[192:207]
    ds_read_b64_tr_b16 v[216:217], v11 offset:16384
    ds_read_b64_tr_b16 v[218:219], v11 offset:16896
    ds_read_b64_tr_b16 v[220:221], v11 offset:17408
    ds_read_b64_tr_b16 v[222:223], v11 offset:17920
    v_pk_fma_f32 v[128:129], v[128:129], s[24:25], v[14:15]
    v_pk_fma_f32 v[130:131], v[130:131], s[24:25], v[14:15]
    v_pk_fma_f32 v[132:133], v[132:133], s[24:25], v[14:15]
    v_pk_fma_f32 v[134:135], v[134:135], s[24:25], v[14:15]
    v_pk_fma_f32 v[136:137], v[136:137], s[24:25], v[14:15]
    v_pk_fma_f32 v[138:139], v[138:139], s[24:25], v[14:15]
    v_pk_fma_f32 v[140:141], v[140:141], s[24:25], v[14:15]
    v_pk_fma_f32 v[142:143], v[142:143], s[24:25], v[14:15]
    v_exp_f32 v128, v128
    v_exp_f32 v129, v129
    v_exp_f32 v130, v130
    v_exp_f32 v131, v131
    v_exp_f32 v132, v132
    v_exp_f32 v133, v133
    v_exp_f32 v134, v134
    v_exp_f32 v135, v135
    v_exp_f32 v136, v136
    v_exp_f32 v137, v137
    v_exp_f32 v138, v138
    v_exp_f32 v139, v139
    v_exp_f32 v140, v140
    v_exp_f32 v141, v141
    v_exp_f32 v142, v142
    v_exp_f32 v143, v143
    v_cvt_pk_bf16_f32 v128, v128, v129
    v_cvt_pk_bf16_f32 v129, v130, v131
    v_cvt_pk_bf16_f32 v130, v132, v133
    v_cvt_pk_bf16_f32 v131, v134, v135
    v_cvt_pk_bf16_f32 v132, v136, v137
    v_cvt_pk_bf16_f32 v133, v138, v139
    v_cvt_pk_bf16_f32 v134, v140, v141
    v_cvt_pk_bf16_f32 v135, v142, v143
    s_waitcnt lgkmcnt(8)
    s_nop 0
    v_mfma_f32_32x32x16_bf16 v[176:191], v[232:235], v[128:131], v[176:191]
    v_mfma_f32_32x32x16_bf16 v[192:207], v[248:251], v[128:131], v[192:207]
    v_mfma_f32_32x32x16_bf16 v[176:191], v[236:239], v[132:135], v[176:191]
    v_mfma_f32_32x32x16_bf16 v[192:207], v[248:251], v[132:135], v[192:207]
    v_pk_fma_f32 v[144:145], v[144:145], s[24:25], v[14:15]
    v_pk_fma_f32 v[146:147], v[146:147], s[24:25], v[14:15]
    v_pk_fma_f32 v[148:149], v[148:149], s[24:25], v[14:15]
    v_pk_fma_f32 v[150:151], v[150:151], s[24:25], v[14:15]
    v_pk_fma_f32 v[152:153], v[152:153], s[24:25], v[14:15]
    v_pk_fma_f32 v[154:155], v[154:155], s[24:25], v[14:15]
    v_pk_fma_f32 v[156:157], v[156:157], s[24:25], v[14:15]
    v_pk_fma_f32 v[158:159], v[158:159], s[24:25], v[14:15]
    v_exp_f32 v144, v144
    v_exp_f32 v145, v145
    v_exp_f32 v146, v146
    v_exp_f32 v147, v147
    v_exp_f32 v148, v148
    v_exp_f32 v149, v149
    v_exp_f32 v150, v150
    v_exp_f32 v151, v151
    v_exp_f32 v152, v152
    v_exp_f32 v153, v153
    v_exp_f32 v154, v154
    v_exp_f32 v155, v155
    v_exp_f32 v156, v156
    v_exp_f32 v157, v157
    v_exp_f32 v158, v158
    v_exp_f32 v159, v159
    v_cvt_pk_bf16_f32 v144, v144, v145
    v_cvt_pk_bf16_f32 v145, v146, v147
    v_cvt_pk_bf16_f32 v146, v148, v149
    v_cvt_pk_bf16_f32 v147, v150, v151
    v_cvt_pk_bf16_f32 v148, v152, v153
    v_cvt_pk_bf16_f32 v149, v154, v155
    v_cvt_pk_bf16_f32 v150, v156, v157
    v_cvt_pk_bf16_f32 v151, v158, v159
    s_waitcnt lgkmcnt(4)
    s_nop 0
    v_mfma_f32_32x32x16_bf16 v[176:191], v[240:243], v[144:147], v[176:191]
    v_mfma_f32_32x32x16_bf16 v[192:207], v[248:251], v[144:147], v[192:207]
    v_mfma_f32_32x32x16_bf16 v[176:191], v[244:247], v[148:151], v[176:191]
    v_mfma_f32_32x32x16_bf16 v[192:207], v[248:251], v[148:151], v[192:207]
    v_pk_fma_f32 v[160:161], v[160:161], s[24:25], v[14:15]
    v_pk_fma_f32 v[162:163], v[162:163], s[24:25], v[14:15]
    v_pk_fma_f32 v[164:165], v[164:165], s[24:25], v[14:15]
    v_pk_fma_f32 v[166:167], v[166:167], s[24:25], v[14:15]
    v_pk_fma_f32 v[168:169], v[168:169], s[24:25], v[14:15]
    v_pk_fma_f32 v[170:171], v[170:171], s[24:25], v[14:15]
    v_pk_fma_f32 v[172:173], v[172:173], s[24:25], v[14:15]
    v_pk_fma_f32 v[174:175], v[174:175], s[24:25], v[14:15]
    v_exp_f32 v160, v160
    v_exp_f32 v161, v161
    v_exp_f32 v162, v162
    v_exp_f32 v163, v163
    v_exp_f32 v164, v164
    v_exp_f32 v165, v165
    v_exp_f32 v166, v166
    v_exp_f32 v167, v167
    v_exp_f32 v168, v168
    v_exp_f32 v169, v169
    v_exp_f32 v170, v170
    v_exp_f32 v171, v171
    v_exp_f32 v172, v172
    v_exp_f32 v173, v173
    v_exp_f32 v174, v174
    v_exp_f32 v175, v175
    v_cvt_pk_bf16_f32 v160, v160, v161
    v_cvt_pk_bf16_f32 v161, v162, v163
    v_cvt_pk_bf16_f32 v162, v164, v165
    v_cvt_pk_bf16_f32 v163, v166, v167
    v_cvt_pk_bf16_f32 v164, v168, v169
    v_cvt_pk_bf16_f32 v165, v170, v171
    v_cvt_pk_bf16_f32 v166, v172, v173
    v_cvt_pk_bf16_f32 v167, v174, v175
    s_waitcnt lgkmcnt(0)
    s_nop 0
    v_mfma_f32_32x32x16_bf16 v[176:191], v[216:219], v[160:163], v[176:191]
    v_mfma_f32_32x32x16_bf16 v[192:207], v[248:251], v[160:163], v[192:207]
    v_mfma_f32_32x32x16_bf16 v[176:191], v[220:223], v[164:167], v[176:191]
    v_mfma_f32_32x32x16_bf16 v[192:207], v[248:251], v[164:167], v[192:207]
    v_lshrrev_b32 v4, 4, v1
    v_lshl_add_u32 v4, v4, 2, v2
    v_and_b32 v1, 15, v0
    v_lshl_add_u32 v4, v4, 4, v1
    v_lshlrev_b32 v4, 4, v4
    s_lshl_b32 s6, s4, 18
    s_lshl_b32 s7, s18, 13
    s_add_u32 s6, s6, s7
    s_lshl_b32 s7, s17, 11
    s_add_u32 s6, s6, s7
    v_lshrrev_b32 v2, 4, v0
    s_nop 7
    v_rcp_f32 v13, v192
    s_nop 0
    v_mul_f32 v176, v176, v13
    v_mul_f32 v177, v177, v13
    v_mul_f32 v178, v178, v13
    v_mul_f32 v179, v179, v13
    v_mul_f32 v180, v180, v13
    v_mul_f32 v181, v181, v13
    v_mul_f32 v182, v182, v13
    v_mul_f32 v183, v183, v13
    v_mul_f32 v184, v184, v13
    v_mul_f32 v185, v185, v13
    v_mul_f32 v186, v186, v13
    v_mul_f32 v187, v187, v13
    v_mul_f32 v188, v188, v13
    v_mul_f32 v189, v189, v13
    v_mul_f32 v190, v190, v13
    v_mul_f32 v191, v191, v13
    v_cvt_pk_bf16_f32 v16, v176, v177
    v_cvt_pk_bf16_f32 v17, v178, v179
    v_cvt_pk_bf16_f32 v18, v180, v181
    v_cvt_pk_bf16_f32 v19, v182, v183
    v_cvt_pk_bf16_f32 v20, v184, v185
    v_cvt_pk_bf16_f32 v21, v186, v187
    v_cvt_pk_bf16_f32 v22, v188, v189
    v_cvt_pk_bf16_f32 v23, v190, v191
    s_nop 1
    v_permlane32_swap_b32 v16, v18
    v_permlane32_swap_b32 v17, v19
    v_permlane32_swap_b32 v20, v22
    v_permlane32_swap_b32 v21, v23
    buffer_store_dwordx4 v[16:19], v4, s[40:43], s6 offen sc1
    buffer_store_dwordx4 v[20:23], v4, s[40:43], s6 offen offset:512 sc1
    s_waitcnt vmcnt(2)
    s_barrier
    v_mov_b32 v3, 1
    s_waitcnt vmcnt(0)
    s_mov_b64 exec, 1
    ds_add_u32 v254, v3 offset:8
    s_mov_b64 exec, -1
    s_cmp_lt_u32 s3, 4
    s_cbranch_scc1 L_cc
    s_mul_i32 s6, s4, 262144
    s_add_u32 s8, s84, 16777216
    s_addc_u32 s9, s85, 0
    s_add_u32 s8, s8, s6
    s_addc_u32 s9, s9, 0
    s_mov_b32 s10, 262144
    s_mov_b32 s11, 0x20000
    s_mul_i32 s6, s5, 128
    s_add_u32 s12, s68, 0
    s_addc_u32 s13, s69, 0
    s_add_u32 s12, s12, s6
    s_addc_u32 s13, s13, 0
    s_mov_b32 s14, 2097152
    s_mov_b32 s15, 0x20000
    s_sub_u32 s14, s14, s6
    v_lshrrev_b32 v3, 3, v0
    s_lshl_b32 s6, s29, 3
    v_add_u32 v3, s6, v3
    v_lshrrev_b32 v4, 1, v3
    v_xor_b32 v4, v4, v0
    v_and_b32 v4, 7, v4
    v_lshlrev_b32 v4, 4, v4
    s_mov_b32 s6, 2048
    v_mad_u32_u24 v4, v3, s6, v4
    s_lshl_b32 s6, s29, 10
    v_lshl_add_u32 v4, v0, 4, s6
    v_add_u32 v5, 4096, v4
    v_add_u32 v6, 8192, v4
    v_add_u32 v7, 12288, v4
    s_lshl_b32 s6, s29, 6
    s_add_u32 s6, s6, 0
    v_add_u32 v3, s6, v0
    s_mov_b32 s6, 8192
    v_mul_u32_u24 v20, s6, v3
    v_lshrrev_b32 v20, 16, v20
    v_mul_u32_u24 v21, 8, v20
    v_sub_u32 v21, v3, v21
    v_bfe_u32 v22, v20, 3, 1
    v_bfe_u32 v23, v20, 1, 1
    v_lshl_add_u32 v22, v22, 1, v23
    v_lshlrev_b32 v22, 1, v22
    v_xor_b32 v21, v21, v22
    v_mov_b32 v22, 0
    v_lshl_add_u32 v21, v21, 4, v22
    s_mov_b32 s6, 2048
    v_mad_u32_u24 v8, v20, s6, v21
    s_lshl_b32 s6, s29, 6
    s_add_u32 s6, s6, 256
    v_add_u32 v3, s6, v0
    s_mov_b32 s6, 8192
    v_mul_u32_u24 v20, s6, v3
    v_lshrrev_b32 v20, 16, v20
    v_mul_u32_u24 v21, 8, v20
    v_sub_u32 v21, v3, v21
    v_bfe_u32 v22, v20, 3, 1
    v_bfe_u32 v23, v20, 1, 1
    v_lshl_add_u32 v22, v22, 1, v23
    v_lshlrev_b32 v22, 1, v22
    v_xor_b32 v21, v21, v22
    v_mov_b32 v22, 0
    v_lshl_add_u32 v21, v21, 4, v22
    s_mov_b32 s6, 2048
    v_mad_u32_u24 v9, v20, s6, v21
    s_lshl_b32 s32, s29, 10
    s_mov_b32 s33, 0
    s_mov_b32 s34, 0
    s_add_u32 s35, s32, 147456
L_clda:
    s_cmp_lg_u32 s3, 4
    s_cbranch_scc1 L_oth7
    v_and_b32 v17, 15, v0
    v_lshlrev_b32 v17, 2, v17
L_spin9:
    ds_read_b32 v16, v254 offset:8
    s_sub_u32 s37, s37, 1
    s_cselect_b32 s37, 0, s37
    s_cbranch_scc1 L_spin9x
    s_waitcnt lgkmcnt(0)
    v_readfirstlane_b32 s6, v16
    s_cmp_ge_u32 s6, 8
    s_cbranch_scc1 L_spin9x
    s_sleep 1
    s_branch L_spin9
L_spin9x:
    s_waitcnt lgkmcnt(0)
    s_cmp_lg_u32 s3, 4
    s_cbranch_scc1 L_pub10
    s_lshl_b32 s6, s4, 7
    s_add_u32 s6, s6, s5
    s_lshl_b32 s6, s6, 2
    s_add_u32 s6, s6, 8192
    v_mov_b32 v3, 1
    s_mov_b64 exec, 1
    buffer_store_dword v3, off, s[60:63], s6 sc1
    s_mov_b64 exec, -1
L_pub10:
    s_mov_b64 exec, 1
    ds_add_u32 v254, v3 offset:8
    s_mov_b64 exec, -1
    s_add_u32 s96, s68, 0
    s_addc_u32 s97, s69, 0
    s_mov_b32 s98, 2097152
    s_mov_b32 s99, 0x20000
    s_and_b32 s6, s5, 7
    s_lshl_b32 s6, s6, 2
    s_and_b32 s7, s4, 3
    s_add_u32 s6, s6, s7
    s_lshl_b32 s6, s6, 2
    s_add_u32 s6, s6, s29
    s_mul_i32 s6, s6, 16384
    s_and_b32 s7, s5, 8
    s_lshl_b32 s7, s7, 7
    s_add_u32 s6, s6, s7
    v_lshrrev_b32 v252, 1, v0
    v_lshlrev_b32 v252, 11, v252
    v_and_b32 v251, 1, v0
    v_lshl_add_u32 v252, v251, 6, v252
    s_bfm_b64 exec, 16, 0
    buffer_load_dword v253, v252, s[96:99], s6 offen offset:384
    s_mov_b64 exec, -1
    s_add_u32 m0, s32, 16384
    s_nop 0
    buffer_load_dwordx4 v8, s[12:15], s34 offen lds
    s_add_u32 m0, s32, 20480
    s_nop 0
    buffer_load_dwordx4 v9, s[12:15], s34 offen lds
    s_add_u32 s34, s34, 131072
    s_add_u32 m0, s32, 40960
    s_nop 0
    buffer_load_dwordx4 v8, s[12:15], s34 offen lds
    s_add_u32 m0, s32, 45056
    s_nop 0
    buffer_load_dwordx4 v9, s[12:15], s34 offen lds
    s_add_u32 s34, s34, 131072
    s_add_u32 m0, s32, 65536
    s_nop 0
    buffer_load_dwordx4 v8, s[12:15], s34 offen lds
    s_add_u32 m0, s32, 69632
    s_nop 0
    buffer_load_dwordx4 v9, s[12:15], s34 offen lds
    s_add_u32 s34, s34, 131072
    s_add_u32 m0, s32, 90112
    s_nop 0
    buffer_load_dwordx4 v8, s[12:15], s34 offen lds
    s_add_u32 m0, s32, 94208
    s_nop 0
    buffer_load_dwordx4 v9, s[12:15], s34 offen lds
    s_add_u32 s34, s34, 131072
    s_add_u32 m0, s32, 114688
    s_nop 0
    buffer_load_dwordx4 v8, s[12:15], s34 offen lds
    s_add_u32 m0, s32, 118784
    s_nop 0
    buffer_load_dwordx4 v9, s[12:15], s34 offen lds
    s_add_u32 s34, s34, 131072
    s_lshl_b32 s6, s4, 9
    s_add_u32 s6, s6, 8192
L_poll8:
    buffer_load_dword v16, v17, s[60:63], s6 offen sc1
    s_sub_u32 s37, s37, 1
    s_cselect_b32 s37, 0, s37
    s_cbranch_scc1 L_poll8x
    s_waitcnt vmcnt(0)
    v_cmp_eq_u32 vcc, 1, v16
    s_cmp_eq_u64 vcc, -1
    s_cbranch_scc1 L_poll8x
    s_sleep 1
    s_branch L_poll8
L_poll8x:
    ds_write_b32 v254, v254 offset:12
    s_branch L_oth7x
L_oth7:
L_spin11:
    ds_read_b32 v16, v254 offset:8
    s_sub_u32 s37, s37, 1
    s_cselect_b32 s37, 0, s37
    s_cbranch_scc1 L_spin11x
    s_waitcnt lgkmcnt(0)
    v_readfirstlane_b32 s6, v16
    s_cmp_ge_u32 s6, 9
    s_cbranch_scc1 L_spin11x
    s_sleep 1
    s_branch L_spin11
L_spin11x:
    s_waitcnt lgkmcnt(0)
    s_add_u32 s96, s68, 0
    s_addc_u32 s97, s69, 0
    s_mov_b32 s98, 2097152
    s_mov_b32 s99, 0x20000
    s_and_b32 s6, s5, 7
    s_lshl_b32 s6, s6, 2
    s_and_b32 s7, s4, 3
    s_add_u32 s6, s6, s7
    s_lshl_b32 s6, s6, 2
    s_add_u32 s6, s6, s29
    s_mul_i32 s6, s6, 16384
    s_and_b32 s7, s5, 8
    s_lshl_b32 s7, s7, 7
    s_add_u32 s6, s6, s7
    v_lshrrev_b32 v252, 1, v0
    v_lshlrev_b32 v252, 11, v252
    v_and_b32 v251, 1, v0
    v_lshl_add_u32 v252, v251, 6, v252
    s_bfm_b64 exec, 16, 0
    buffer_load_dword v253, v252, s[96:99], s6 offen offset:384
    s_mov_b64 exec, -1
    s_add_u32 m0, s32, 16384
    s_nop 0
    buffer_load_dwordx4 v8, s[12:15], s34 offen lds
    s_add_u32 m0, s32, 20480
    s_nop 0
    buffer_load_dwordx4 v9, s[12:15], s34 offen lds
    s_add_u32 s34, s34, 131072
    s_add_u32 m0, s32, 40960
    s_nop 0
    buffer_load_dwordx4 v8, s[12:15], s34 offen lds
    s_add_u32 m0, s32, 45056
    s_nop 0
    buffer_load_dwordx4 v9, s[12:15], s34 offen lds
    s_add_u32 s34, s34, 131072
    s_add_u32 m0, s32, 65536
    s_nop 0
    buffer_load_dwordx4 v8, s[12:15], s34 offen lds
    s_add_u32 m0, s32, 69632
    s_nop 0
    buffer_load_dwordx4 v9, s[12:15], s34 offen lds
    s_add_u32 s34, s34, 131072
    s_add_u32 m0, s32, 90112
    s_nop 0
    buffer_load_dwordx4 v8, s[12:15], s34 offen lds
    s_add_u32 m0, s32, 94208
    s_nop 0
    buffer_load_dwordx4 v9, s[12:15], s34 offen lds
    s_add_u32 s34, s34, 131072
    s_add_u32 m0, s32, 114688
    s_nop 0
    buffer_load_dwordx4 v8, s[12:15], s34 offen lds
    s_add_u32 m0, s32, 118784
    s_nop 0
    buffer_load_dwordx4 v9, s[12:15], s34 offen lds
    s_add_u32 s34, s34, 131072
L_spin12:
    ds_read_b32 v16, v254 offset:12
    s_sub_u32 s37, s37, 1
    s_cselect_b32 s37, 0, s37
    s_cbranch_scc1 L_spin12x
    s_waitcnt lgkmcnt(0)
    v_readfirstlane_b32 s6, v16
    s_cmp_ge_u32 s6, 1
    s_cbranch_scc1 L_spin12x
    s_sleep 1
    s_branch L_spin12
L_spin12x:
    s_waitcnt lgkmcnt(0)
L_oth7x:
    s_add_u32 m0, s32, 0
    s_nop 0
    buffer_load_dwordx4 v4, s[8:11], s33 offen sc1 lds
    s_add_u32 m0, s32, 4096
    s_nop 0
    buffer_load_dwordx4 v5, s[8:11], s33 offen sc1 lds
    s_add_u32 m0, s32, 8192
    s_nop 0
    buffer_load_dwordx4 v6, s[8:11], s33 offen sc1 lds
    s_add_u32 m0, s32, 12288
    s_nop 0
    buffer_load_dwordx4 v7, s[8:11], s33 offen sc1 lds
    s_add_u32 s33, s33, 16384
    s_add_u32 m0, s32, 24576
    s_nop 0
    buffer_load_dwordx4 v4, s[8:11], s33 offen sc1 lds
    s_add_u32 m0, s32, 28672
    s_nop 0
    buffer_load_dwordx4 v5, s[8:11], s33 offen sc1 lds
    s_add_u32 m0, s32, 32768
    s_nop 0
    buffer_load_dwordx4 v6, s[8:11], s33 offen sc1 lds
    s_add_u32 m0, s32, 36864
    s_nop 0
    buffer_load_dwordx4 v7, s[8:11], s33 offen sc1 lds
    s_add_u32 s33, s33, 16384
    s_add_u32 m0, s32, 49152
    s_nop 0
    buffer_load_dwordx4 v4, s[8:11], s33 offen sc1 lds
    s_add_u32 m0, s32, 53248
    s_nop 0
    buffer_load_dwordx4 v5, s[8:11], s33 offen sc1 lds
    s_add_u32 m0, s32, 57344
    s_nop 0
    buffer_load_dwordx4 v6, s[8:11], s33 offen sc1 lds
    s_add_u32 m0, s32, 61440
    s_nop 0
    buffer_load_dwordx4 v7, s[8:11], s33 offen sc1 lds
    s_add_u32 s33, s33, 16384
    s_add_u32 m0, s32, 73728
    s_nop 0
    buffer_load_dwordx4 v4, s[8:11], s33 offen sc1 lds
    s_add_u32 m0, s32, 77824
    s_nop 0
    buffer_load_dwordx4 v5, s[8:11], s33 offen sc1 lds
    s_add_u32 m0, s32, 81920
    s_nop 0
    buffer_load_dwordx4 v6, s[8:11], s33 offen sc1 lds
    s_add_u32 m0, s32, 86016
    s_nop 0
    buffer_load_dwordx4 v7, s[8:11], s33 offen sc1 lds
    s_add_u32 s33, s33, 16384
    s_add_u32 m0, s32, 98304
    s_nop 0
    buffer_load_dwordx4 v4, s[8:11], s33 offen sc1 lds
    s_add_u32 m0, s32, 102400
    s_nop 0
    buffer_load_dwordx4 v5, s[8:11], s33 offen sc1 lds
    s_add_u32 m0, s32, 106496
    s_nop 0
    buffer_load_dwordx4 v6, s[8:11], s33 offen sc1 lds
    s_add_u32 m0, s32, 110592
    s_nop 0
    buffer_load_dwordx4 v7, s[8:11], s33 offen sc1 lds
    s_add_u32 s33, s33, 16384
    s_add_u32 s32, s32, 122880
    s_waitcnt vmcnt(16)
    s_barrier
    s_add_u32 m0, s32, 0
    s_nop 0
    buffer_load_dwordx4 v4, s[8:11], s33 offen sc1 lds
    s_add_u32 m0, s32, 4096
    s_nop 0
    buffer_load_dwordx4 v5, s[8:11], s33 offen sc1 lds
    s_add_u32 m0, s32, 8192
    s_nop 0
    buffer_load_dwordx4 v6, s[8:11], s33 offen sc1 lds
    s_add_u32 m0, s32, 12288
    s_nop 0
    buffer_load_dwordx4 v7, s[8:11], s33 offen sc1 lds
    s_add_u32 s33, s33, 16384
    s_add_u32 m0, s32, 16384
    s_nop 0
    buffer_load_dwordx4 v8, s[12:15], s34 offen lds
    s_add_u32 m0, s32, 20480
    s_nop 0
    buffer_load_dwordx4 v9, s[12:15], s34 offen lds
    s_add_u32 s34, s34, 131072
    s_add_u32 s32, s32, 24576
    s_cmp_ge_u32 s32, s35
    s_cselect_b32 s6, 147456, 0
    s_sub_u32 s32, s32, s6
    s_waitcnt vmcnt(18)
    s_barrier
    s_add_u32 m0, s32, 0
    s_nop 0
    buffer_load_dwordx4 v4, s[8:11], s33 offen sc1 lds
    s_add_u32 m0, s32, 4096
    s_nop 0
    buffer_load_dwordx4 v5, s[8:11], s33 offen sc1 lds
    s_add_u32 m0, s32, 8192
    s_nop 0
    buffer_load_dwordx4 v6, s[8:11], s33 offen sc1 lds
    s_add_u32 m0, s32, 12288
    s_nop 0
    buffer_load_dwordx4 v7, s[8:11], s33 offen sc1 lds
    s_add_u32 s33, s33, 16384
    s_add_u32 m0, s32, 16384
    s_nop 0
    buffer_load_dwordx4 v8, s[12:15], s34 offen lds
    s_add_u32 m0, s32, 20480
    s_nop 0
    buffer_load_dwordx4 v9, s[12:15], s34 offen lds
    s_add_u32 s34, s34, 131072
    s_add_u32 s32, s32, 24576
    s_cmp_ge_u32 s32, s35
    s_cselect_b32 s6, 147456, 0
    s_sub_u32 s32, s32, s6
    s_waitcnt vmcnt(20)
    s_barrier
    s_add_u32 m0, s32, 0
    s_nop 0
    buffer_load_dwordx4 v4, s[8:11], s33 offen sc1 lds
    s_add_u32 m0, s32, 4096
    s_nop 0
    buffer_load_dwordx4 v5, s[8:11], s33 offen sc1 lds
    s_add_u32 m0, s32, 8192
    s_nop 0
    buffer_load_dwordx4 v6, s[8:11], s33 offen sc1 lds
    s_add_u32 m0, s32, 12288
    s_nop 0
    buffer_load_dwordx4 v7, s[8:11], s33 offen sc1 lds
    s_add_u32 s33, s33, 16384
    s_add_u32 m0, s32, 16384
    s_nop 0
    buffer_load_dwordx4 v8, s[12:15], s34 offen lds
    s_add_u32 m0, s32, 20480
    s_nop 0
    buffer_load_dwordx4 v9, s[12:15], s34 offen lds
    s_add_u32 s34, s34, 131072
    s_add_u32 s32, s32, 24576
    s_cmp_ge_u32 s32, s35
    s_cselect_b32 s6, 147456, 0
    s_sub_u32 s32, s32, s6
    s_waitcnt vmcnt(22)
    s_barrier
    s_add_u32 m0, s32, 0
    s_nop 0
    buffer_load_dwordx4 v4, s[8:11], s33 offen sc1 lds
    s_add_u32 m0, s32, 4096
    s_nop 0
    buffer_load_dwordx4 v5, s[8:11], s33 offen sc1 lds
    s_add_u32 m0, s32, 8192
    s_nop 0
    buffer_load_dwordx4 v6, s[8:11], s33 offen sc1 lds
    s_add_u32 m0, s32, 12288
    s_nop 0
    buffer_load_dwordx4 v7, s[8:11], s33 offen sc1 lds
    s_add_u32 s33, s33, 16384
    s_add_u32 m0, s32, 16384
    s_nop 0
    buffer_load_dwordx4 v8, s[12:15], s34 offen lds
    s_add_u32 m0, s32, 20480
    s_nop 0
    buffer_load_dwordx4 v9, s[12:15], s34 offen lds
    s_add_u32 s34, s34, 131072
    s_add_u32 s32, s32, 24576
    s_cmp_ge_u32 s32, s35
    s_cselect_b32 s6, 147456, 0
    s_sub_u32 s32, s32, s6
    s_mov_b32 s36, 7
L_clpa:
    s_waitcnt vmcnt(24)
    s_barrier
    s_add_u32 m0, s32, 0
    s_nop 0
    buffer_load_dwordx4 v4, s[8:11], s33 offen sc1 lds
    s_add_u32 m0, s32, 4096
    s_nop 0
    buffer_load_dwordx4 v5, s[8:11], s33 offen sc1 lds
    s_add_u32 m0, s32, 8192
    s_nop 0
    buffer_load_dwordx4 v6, s[8:11], s33 offen sc1 lds
    s_add_u32 m0, s32, 12288
    s_nop 0
    buffer_load_dwordx4 v7, s[8:11], s33 offen sc1 lds
    s_add_u32 s33, s33, 16384
    s_add_u32 m0, s32, 16384
    s_nop 0
    buffer_load_dwordx4 v8, s[12:15], s34 offen lds
    s_add_u32 m0, s32, 20480
    s_nop 0
    buffer_load_dwordx4 v9, s[12:15], s34 offen lds
    s_add_u32 s34, s34, 131072
    s_add_u32 s32, s32, 24576
    s_cmp_ge_u32 s32, s35
    s_cselect_b32 s6, 147456, 0
    s_sub_u32 s32, s32, s6
    s_sub_u32 s36, s36, 1
    s_cmp_lg_u32 s36, 0
    s_cbranch_scc1 L_clpa
    s_add_u32 s96, s74, 4194304
    s_addc_u32 s97, s75, 0
    s_mov_b32 s98, 4194304
    s_mov_b32 s99, 0x20000
    s_mul_i32 s6, s2, 4
    s_add_u32 s6, s6, s29
    s_mul_i32 s6, s6, 4096
    v_mul_u32_u24 v252, 64, v0
    buffer_load_dword v253, v252, s[96:99], s6 offen offset:0
    s_cmp_lg_u32 s3, 4
    s_cbranch_scc1 L_pub13
    s_lshl_b32 s6, s5, 7
    s_add_u32 s6, s6, s4
    s_lshl_b32 s6, s6, 2
    s_add_u32 s6, s6, 49152
    v_mov_b32 v3, 1
    s_mov_b64 exec, 1
    buffer_store_dword v3, off, s[60:63], s6 sc1
    s_mov_b64 exec, -1
L_pub13:
    s_waitcnt vmcnt(25)
    s_barrier
    s_waitcnt vmcnt(19)
    s_barrier
    s_waitcnt vmcnt(13)
    s_barrier
    s_waitcnt vmcnt(7)
    s_barrier
    s_waitcnt vmcnt(1)
    s_barrier
L_cldx:
    s_barrier
    s_mul_i32 s6, s4, 262144
    s_add_u32 s8, s84, 20971520
    s_addc_u32 s9, s85, 0
    s_add_u32 s8, s8, s6
    s_addc_u32 s9, s9, 0
    s_mov_b32 s10, 262144
    s_mov_b32 s11, 0x20000
    s_mul_i32 s6, s5, 458752
    s_add_u32 s12, s84, 25165824
    s_addc_u32 s13, s85, 0
    s_add_u32 s12, s12, s6
    s_addc_u32 s13, s13, 0
    s_mov_b32 s14, 458752
    s_mov_b32 s15, 0x20000
    v_lshrrev_b32 v3, 3, v0
    s_lshl_b32 s6, s29, 3
    v_add_u32 v3, s6, v3
    v_lshrrev_b32 v4, 1, v3
    v_xor_b32 v4, v4, v0
    v_and_b32 v4, 7, v4
    v_lshlrev_b32 v4, 4, v4
    s_mov_b32 s6, 2048
    v_mad_u32_u24 v4, v3, s6, v4
    s_lshl_b32 s6, s29, 10
    v_lshl_add_u32 v4, v0, 4, s6
    v_add_u32 v5, 4096, v4
    v_add_u32 v6, 8192, v4
    v_add_u32 v7, 12288, v4
    s_lshl_b32 s6, s29, 6
    s_add_u32 s6, s6, 0
    v_add_u32 v3, s6, v0
    v_lshlrev_b32 v8, 4, v3
    s_lshl_b32 s6, s29, 6
    s_add_u32 s6, s6, 256
    v_add_u32 v3, s6, v0
    v_lshlrev_b32 v9, 4, v3
    s_lshl_b32 s6, s29, 6
    s_add_u32 s6, s6, 512
    v_add_u32 v3, s6, v0
    v_lshlrev_b32 v10, 4, v3
    s_lshl_b32 s6, s29, 6
    s_add_u32 s6, s6, 768
    v_add_u32 v3, s6, v0
    v_lshlrev_b32 v11, 4, v3
    s_lshl_b32 s6, s29, 6
    s_add_u32 s6, s6, 1024
    v_add_u32 v3, s6, v0
    v_lshlrev_b32 v12, 4, v3
    s_lshl_b32 s6, s29, 6
    s_add_u32 s6, s6, 1280
    v_add_u32 v3, s6, v0
    v_lshlrev_b32 v13, 4, v3
    s_lshl_b32 s6, s29, 6
    s_add_u32 s6, s6, 1536
    v_add_u32 v3, s6, v0
    v_lshlrev_b32 v14, 4, v3
    s_lshl_b32 s32, s29, 10
    s_mov_b32 s33, 0
    s_mov_b32 s34, 0
    s_add_u32 s35, s32, 135168
    s_cmp_lg_u32 s3, 4
    s_cbranch_scc1 L_oth14
    v_and_b32 v17, 15, v0
    v_lshlrev_b32 v17, 2, v17
    s_lshl_b32 s6, s5, 9
    s_add_u32 s6, s6, 49152
L_poll15:
    buffer_load_dword v16, v17, s[60:63], s6 offen sc1
    s_sub_u32 s37, s37, 1
    s_cselect_b32 s37, 0, s37
    s_cbranch_scc1 L_poll15x
    s_waitcnt vmcnt(0)
    v_cmp_eq_u32 vcc, 1, v16
    s_cmp_eq_u64 vcc, -1
    s_cbranch_scc1 L_poll15x
    s_sleep 1
    s_branch L_poll15
L_poll15x:
    ds_write_b32 v254, v254 offset:52
    s_branch L_oth14x
L_oth14:
L_spin16:
    ds_read_b32 v16, v254 offset:52
    s_sub_u32 s37, s37, 1
    s_cselect_b32 s37, 0, s37
    s_cbranch_scc1 L_spin16x
    s_waitcnt lgkmcnt(0)
    v_readfirstlane_b32 s6, v16
    s_cmp_ge_u32 s6, 1
    s_cbranch_scc1 L_spin16x
    s_sleep 1
    s_branch L_spin16
L_spin16x:
    s_waitcnt lgkmcnt(0)
L_oth14x:
L_dlda:
    s_cmp_lg_u32 s3, 4
    s_cbranch_scc1 L_oth17
    v_and_b32 v17, 15, v0
    v_lshlrev_b32 v17, 2, v17
L_spin19:
    ds_read_b32 v16, v254 offset:16
    s_sub_u32 s37, s37, 1
    s_cselect_b32 s37, 0, s37
    s_cbranch_scc1 L_spin19x
    s_waitcnt lgkmcnt(0)
    v_readfirstlane_b32 s6, v16
    s_cmp_ge_u32 s6, 4
    s_cbranch_scc1 L_spin19x
    s_sleep 1
    s_branch L_spin19
L_spin19x:
    s_waitcnt lgkmcnt(0)
    s_cmp_lg_u32 s3, 4
    s_cbranch_scc1 L_pub20
    s_lshl_b32 s6, s4, 7
    s_add_u32 s6, s6, s5
    s_lshl_b32 s6, s6, 2
    s_add_u32 s6, s6, 16384
    v_mov_b32 v3, 1
    s_mov_b64 exec, 1
    buffer_store_dword v3, off, s[60:63], s6 sc1
    s_mov_b64 exec, -1
L_pub20:
    s_mov_b64 exec, 1
    ds_add_u32 v254, v3 offset:16
    s_mov_b64 exec, -1
    s_add_u32 m0, s32, 16384
    s_nop 0
    buffer_load_dwordx4 v8, s[12:15], s34 offen sc1 lds
    s_add_u32 m0, s32, 20480
    s_nop 0
    buffer_load_dwordx4 v9, s[12:15], s34 offen sc1 lds
    s_add_u32 m0, s32, 24576
    s_nop 0
    buffer_load_dwordx4 v10, s[12:15], s34 offen sc1 lds
    s_add_u32 m0, s32, 28672
    s_nop 0
    buffer_load_dwordx4 v11, s[12:15], s34 offen sc1 lds
    s_add_u32 m0, s32, 32768
    s_nop 0
    buffer_load_dwordx4 v12, s[12:15], s34 offen sc1 lds
    s_add_u32 m0, s32, 36864
    s_nop 0
    buffer_load_dwordx4 v13, s[12:15], s34 offen sc1 lds
    s_add_u32 m0, s32, 40960
    s_nop 0
    buffer_load_dwordx4 v14, s[12:15], s34 offen sc1 lds
    s_add_u32 s34, s34, 28672
    s_add_u32 m0, s32, 61440
    s_nop 0
    buffer_load_dwordx4 v8, s[12:15], s34 offen sc1 lds
    s_add_u32 m0, s32, 65536
    s_nop 0
    buffer_load_dwordx4 v9, s[12:15], s34 offen sc1 lds
    s_add_u32 m0, s32, 69632
    s_nop 0
    buffer_load_dwordx4 v10, s[12:15], s34 offen sc1 lds
    s_add_u32 m0, s32, 73728
    s_nop 0
    buffer_load_dwordx4 v11, s[12:15], s34 offen sc1 lds
    s_add_u32 m0, s32, 77824
    s_nop 0
    buffer_load_dwordx4 v12, s[12:15], s34 offen sc1 lds
    s_add_u32 m0, s32, 81920
    s_nop 0
    buffer_load_dwordx4 v13, s[12:15], s34 offen sc1 lds
    s_add_u32 m0, s32, 86016
    s_nop 0
    buffer_load_dwordx4 v14, s[12:15], s34 offen sc1 lds
    s_add_u32 s34, s34, 28672
    s_lshl_b32 s6, s4, 9
    s_add_u32 s6, s6, 16384
L_poll18:
    buffer_load_dword v16, v17, s[60:63], s6 offen sc1
    s_sub_u32 s37, s37, 1
    s_cselect_b32 s37, 0, s37
    s_cbranch_scc1 L_poll18x
    s_waitcnt vmcnt(0)
    v_cmp_eq_u32 vcc, 1, v16
    s_cmp_eq_u64 vcc, -1
    s_cbranch_scc1 L_poll18x
    s_sleep 1
    s_branch L_poll18
L_poll18x:
    ds_write_b32 v254, v254 offset:20
    s_branch L_oth17x
L_oth17:
L_spin21:
    ds_read_b32 v16, v254 offset:16
    s_sub_u32 s37, s37, 1
    s_cselect_b32 s37, 0, s37
    s_cbranch_scc1 L_spin21x
    s_waitcnt lgkmcnt(0)
    v_readfirstlane_b32 s6, v16
    s_cmp_ge_u32 s6, 5
    s_cbranch_scc1 L_spin21x
    s_sleep 1
    s_branch L_spin21
L_spin21x:
    s_waitcnt lgkmcnt(0)
    s_add_u32 m0, s32, 16384
    s_nop 0
    buffer_load_dwordx4 v8, s[12:15], s34 offen sc1 lds
    s_add_u32 m0, s32, 20480
    s_nop 0
    buffer_load_dwordx4 v9, s[12:15], s34 offen sc1 lds
    s_add_u32 m0, s32, 24576
    s_nop 0
    buffer_load_dwordx4 v10, s[12:15], s34 offen sc1 lds
    s_add_u32 m0, s32, 28672
    s_nop 0
    buffer_load_dwordx4 v11, s[12:15], s34 offen sc1 lds
    s_add_u32 m0, s32, 32768
    s_nop 0
    buffer_load_dwordx4 v12, s[12:15], s34 offen sc1 lds
    s_add_u32 m0, s32, 36864
    s_nop 0
    buffer_load_dwordx4 v13, s[12:15], s34 offen sc1 lds
    s_add_u32 m0, s32, 40960
    s_nop 0
    buffer_load_dwordx4 v14, s[12:15], s34 offen sc1 lds
    s_add_u32 s34, s34, 28672
    s_add_u32 m0, s32, 61440
    s_nop 0
    buffer_load_dwordx4 v8, s[12:15], s34 offen sc1 lds
    s_add_u32 m0, s32, 65536
    s_nop 0
    buffer_load_dwordx4 v9, s[12:15], s34 offen sc1 lds
    s_add_u32 m0, s32, 69632
    s_nop 0
    buffer_load_dwordx4 v10, s[12:15], s34 offen sc1 lds
    s_add_u32 m0, s32, 73728
    s_nop 0
    buffer_load_dwordx4 v11, s[12:15], s34 offen sc1 lds
    s_add_u32 m0, s32, 77824
    s_nop 0
    buffer_load_dwordx4 v12, s[12:15], s34 offen sc1 lds
    s_add_u32 m0, s32, 81920
    s_nop 0
    buffer_load_dwordx4 v13, s[12:15], s34 offen sc1 lds
    s_add_u32 m0, s32, 86016
    s_nop 0
    buffer_load_dwordx4 v14, s[12:15], s34 offen sc1 lds
    s_add_u32 s34, s34, 28672
L_spin22:
    ds_read_b32 v16, v254 offset:20
    s_sub_u32 s37, s37, 1
    s_cselect_b32 s37, 0, s37
    s_cbranch_scc1 L_spin22x
    s_waitcnt lgkmcnt(0)
    v_readfirstlane_b32 s6, v16
    s_cmp_ge_u32 s6, 1
    s_cbranch_scc1 L_spin22x
    s_sleep 1
    s_branch L_spin22
L_spin22x:
    s_waitcnt lgkmcnt(0)
L_oth17x:
    s_add_u32 s44, s84, 59768832
    s_addc_u32 s45, s85, 0
    s_mov_b32 s46, 32768
    s_mov_b32 s47, 0x20000
    s_add_u32 s40, s84, 59244544
    s_addc_u32 s41, s85, 0
    s_mov_b32 s42, 229376
    s_mov_b32 s43, 0x20000
    s_lshl_b32 s6, s29, 6
    v_add_u32 v24, s6, v0
    v_and_b32 v25, 127, v24
    v_lshlrev_b32 v23, 3, v25
    s_lshl_b32 s6, s4, 10
    buffer_load_dwordx2 v[26:27], v23, s[44:47], s6 offen sc1
    v_min_u32 v22, 223, v24
    v_lshlrev_b32 v22, 2, v22
    s_mul_i32 s6, s5, 896
    buffer_load_dword v28, v22, s[40:43], s6 offen sc1
    s_add_u32 s6, s6, 14336
    buffer_load_dword v29, v22, s[40:43], s6 offen sc1
    s_add_u32 s6, s6, 14336
    buffer_load_dword v30, v22, s[40:43], s6 offen sc1
    s_add_u32 s6, s6, 14336
    buffer_load_dword v31, v22, s[40:43], s6 offen sc1
    s_add_u32 s6, s6, 14336
    buffer_load_dword v32, v22, s[40:43], s6 offen sc1
    s_add_u32 s6, s6, 14336
    buffer_load_dword v33, v22, s[40:43], s6 offen sc1
    s_add_u32 s6, s6, 14336
    buffer_load_dword v34, v22, s[40:43], s6 offen sc1
    s_add_u32 s6, s6, 14336
    buffer_load_dword v35, v22, s[40:43], s6 offen sc1
    s_add_u32 s6, s6, 14336
    buffer_load_dword v36, v22, s[40:43], s6 offen sc1
    s_add_u32 s6, s6, 14336
    buffer_load_dword v37, v22, s[40:43], s6 offen sc1
    s_add_u32 s6, s6, 14336
    buffer_load_dword v38, v22, s[40:43], s6 offen sc1
    s_add_u32 s6, s6, 14336
    buffer_load_dword v39, v22, s[40:43], s6 offen sc1
    s_add_u32 s6, s6, 14336
    buffer_load_dword v40, v22, s[40:43], s6 offen sc1
    s_add_u32 s6, s6, 14336
    buffer_load_dword v41, v22, s[40:43], s6 offen sc1
    s_add_u32 s6, s6, 14336
    buffer_load_dword v42, v22, s[40:43], s6 offen sc1
    s_add_u32 s6, s6, 14336
    buffer_load_dword v43, v22, s[40:43], s6 offen sc1
    s_add_u32 s6, s6, 14336
    s_add_u32 m0, s32, 0
    s_nop 0
    buffer_load_dwordx4 v4, s[8:11], s33 offen sc1 lds
    s_add_u32 m0, s32, 4096
    s_nop 0
    buffer_load_dwordx4 v5, s[8:11], s33 offen sc1 lds
    s_add_u32 m0, s32, 8192
    s_nop 0
    buffer_load_dwordx4 v6, s[8:11], s33 offen sc1 lds
    s_add_u32 m0, s32, 12288
    s_nop 0
    buffer_load_dwordx4 v7, s[8:11], s33 offen sc1 lds
    s_add_u32 s33, s33, 16384
    s_add_u32 m0, s32, 45056
    s_nop 0
    buffer_load_dwordx4 v4, s[8:11], s33 offen sc1 lds
    s_add_u32 m0, s32, 49152
    s_nop 0
    buffer_load_dwordx4 v5, s[8:11], s33 offen sc1 lds
    s_add_u32 m0, s32, 53248
    s_nop 0
    buffer_load_dwordx4 v6, s[8:11], s33 offen sc1 lds
    s_add_u32 m0, s32, 57344
    s_nop 0
    buffer_load_dwordx4 v7, s[8:11], s33 offen sc1 lds
    s_add_u32 s33, s33, 16384
    s_add_u32 s32, s32, 90112
    s_waitcnt vmcnt(8)
    v_mul_f32 v3, 0x3a800000, v26
    v_mul_f32 v27, 0x3a800000, v27
    v_fma_f32 v27, -v3, v3, v27
    v_max_f32 v27, 0, v27
    v_add_f32 v27, 0x3727c5ac, v27
    v_rsq_f32 v26, v27
    s_nop 0
    v_mul_f32_e64 v27, -v3, v26
    v_add_f32 v28, v28, v29
    v_add_f32 v28, v28, v30
    v_add_f32 v28, v28, v31
    v_add_f32 v28, v28, v32
    v_add_f32 v28, v28, v33
    v_add_f32 v28, v28, v34
    v_add_f32 v28, v28, v35
    v_add_f32 v28, v28, v36
    v_add_f32 v28, v28, v37
    v_add_f32 v28, v28, v38
    v_add_f32 v28, v28, v39
    v_add_f32 v28, v28, v40
    v_add_f32 v28, v28, v41
    v_add_f32 v28, v28, v42
    v_add_f32 v28, v28, v43
    s_mov_b32 s6, 151552
    v_lshl_add_u32 v25, v25, 2, s6
    v_lshl_add_u32 v24, v24, 2, s6
    ds_write_b32 v25, v26
    ds_write_b32 v25, v27 offset:512
    ds_write_b32 v24, v28 offset:1024
    s_waitcnt lgkmcnt(0)
    s_waitcnt vmcnt(4)
    s_barrier
    s_add_u32 m0, s32, 0
    s_nop 0
    buffer_load_dwordx4 v4, s[8:11], s33 offen sc1 lds
    s_add_u32 m0, s32, 4096
    s_nop 0
    buffer_load_dwordx4 v5, s[8:11], s33 offen sc1 lds
    s_add_u32 m0, s32, 8192
    s_nop 0
    buffer_load_dwordx4 v6, s[8:11], s33 offen sc1 lds
    s_add_u32 m0, s32, 12288
    s_nop 0
    buffer_load_dwordx4 v7, s[8:11], s33 offen sc1 lds
    s_add_u32 s33, s33, 16384
    s_add_u32 m0, s32, 16384
    s_nop 0
    buffer_load_dwordx4 v8, s[12:15], s34 offen sc1 lds
    s_add_u32 m0, s32, 20480
    s_nop 0
    buffer_load_dwordx4 v9, s[12:15], s34 offen sc1 lds
    s_add_u32 m0, s32, 24576
    s_nop 0
    buffer_load_dwordx4 v10, s[12:15], s34 offen sc1 lds
    s_add_u32 m0, s32, 28672
    s_nop 0
    buffer_load_dwordx4 v11, s[12:15], s34 offen sc1 lds
    s_add_u32 m0, s32, 32768
    s_nop 0
    buffer_load_dwordx4 v12, s[12:15], s34 offen sc1 lds
    s_add_u32 m0, s32, 36864
    s_nop 0
    buffer_load_dwordx4 v13, s[12:15], s34 offen sc1 lds
    s_add_u32 m0, s32, 40960
    s_nop 0
    buffer_load_dwordx4 v14, s[12:15], s34 offen sc1 lds
    s_add_u32 s34, s34, 28672
    s_add_u32 s32, s32, 45056
    s_cmp_ge_u32 s32, s35
    s_cselect_b32 s6, 135168, 0
    s_sub_u32 s32, s32, s6
    s_mov_b32 s36, 13
L_dlpa:
    s_waitcnt vmcnt(11)
    s_barrier
    s_add_u32 m0, s32, 0
    s_nop 0
    buffer_load_dwordx4 v4, s[8:11], s33 offen sc1 lds
    s_add_u32 m0, s32, 4096
    s_nop 0
    buffer_load_dwordx4 v5, s[8:11], s33 offen sc1 lds
    s_add_u32 m0, s32, 8192
    s_nop 0
    buffer_load_dwordx4 v6, s[8:11], s33 offen sc1 lds
    s_add_u32 m0, s32, 12288
    s_nop 0
    buffer_load_dwordx4 v7, s[8:11], s33 offen sc1 lds
    s_add_u32 s33, s33, 16384
    s_add_u32 m0, s32, 16384
    s_nop 0
    buffer_load_dwordx4 v8, s[12:15], s34 offen sc1 lds
    s_add_u32 m0, s32, 20480
    s_nop 0
    buffer_load_dwordx4 v9, s[12:15], s34 offen sc1 lds
    s_add_u32 m0, s32, 24576
    s_nop 0
    buffer_load_dwordx4 v10, s[12:15], s34 offen sc1 lds
    s_add_u32 m0, s32, 28672
    s_nop 0
    buffer_load_dwordx4 v11, s[12:15], s34 offen sc1 lds
    s_add_u32 m0, s32, 32768
    s_nop 0
    buffer_load_dwordx4 v12, s[12:15], s34 offen sc1 lds
    s_add_u32 m0, s32, 36864
    s_nop 0
    buffer_load_dwordx4 v13, s[12:15], s34 offen sc1 lds
    s_add_u32 m0, s32, 40960
    s_nop 0
    buffer_load_dwordx4 v14, s[12:15], s34 offen sc1 lds
    s_add_u32 s34, s34, 28672
    s_add_u32 s32, s32, 45056
    s_cmp_ge_u32 s32, s35
    s_cselect_b32 s6, 135168, 0
    s_sub_u32 s32, s32, s6
    s_sub_u32 s36, s36, 1
    s_cmp_lg_u32 s36, 0
    s_cbranch_scc1 L_dlpa
    s_add_u32 s96, s74, 0
    s_addc_u32 s97, s75, 0
    s_mov_b32 s98, 8388608
    s_mov_b32 s99, 0x20000
    s_mul_i32 s6, s4, 524288
    s_mul_i32 s7, s29, 131072
    s_add_u32 s6, s6, s7
    v_lshrrev_b32 v252, 1, v0
    v_mul_u32_u24 v252, 4096, v252
    v_and_b32 v251, 1, v0
    v_lshl_add_u32 v252, v251, 6, v252
    buffer_load_dword v253, v252, s[96:99], s6 offen
    s_add_u32 s6, s6, 128
    buffer_load_dword v253, v252, s[96:99], s6 offen
    s_add_u32 s6, s6, 128
    buffer_load_dword v253, v252, s[96:99], s6 offen
    s_add_u32 s6, s6, 128
    s_add_u32 s96, s74, 0
    s_addc_u32 s97, s75, 0
    s_mov_b32 s98, 4194304
    s_mov_b32 s99, 0x20000
    s_mul_i32 s6, s2, 4
    s_add_u32 s6, s6, s29
    s_mul_i32 s6, s6, 4096
    v_mul_u32_u24 v252, 64, v0
    buffer_load_dword v253, v252, s[96:99], s6 offen offset:0
    s_add_u32 s96, s78, 0
    s_addc_u32 s97, s79, 0
    s_mov_b32 s98, 3670016
    s_mov_b32 s99, 0x20000
    s_mul_i32 s6, s2, 4
    s_add_u32 s6, s6, s29
    s_mul_i32 s6, s6, 3584
    v_mul_u32_u24 v252, 56, v0
    buffer_load_dword v253, v252, s[96:99], s6 offen offset:0
    s_waitcnt vmcnt(16)
    s_barrier
    s_waitcnt vmcnt(5)
    s_barrier
L_dldx:
    s_barrier
    s_mul_i32 s6, s4, 524288
    s_add_u32 s8, s74, 0
    s_addc_u32 s9, s75, 0
    s_add_u32 s8, s8, s6
    s_addc_u32 s9, s9, 0
    s_mov_b32 s10, 524288
    s_mov_b32 s11, 0x20000
    s_mul_i32 s6, s5, 458752
    s_add_u32 s12, s84, 33554432
    s_addc_u32 s13, s85, 0
    s_add_u32 s12, s12, s6
    s_addc_u32 s13, s13, 0
    s_mov_b32 s14, 458752
    s_mov_b32 s15, 0x20000
    v_lshrrev_b32 v3, 3, v0
    s_lshl_b32 s6, s29, 3
    v_add_u32 v3, s6, v3
    v_lshrrev_b32 v4, 1, v3
    v_xor_b32 v4, v4, v0
    v_and_b32 v4, 7, v4
    v_lshlrev_b32 v4, 4, v4
    s_mov_b32 s6, 4096
    v_mad_u32_u24 v4, v3, s6, v4
    v_add_u32 v5, 131072, v4
    v_add_u32 v6, 262144, v4
    v_add_u32 v7, 393216, v4
    s_lshl_b32 s6, s29, 6
    s_add_u32 s6, s6, 0
    v_add_u32 v3, s6, v0
    v_lshlrev_b32 v8, 4, v3
    s_lshl_b32 s6, s29, 6
    s_add_u32 s6, s6, 256
    v_add_u32 v3, s6, v0
    v_lshlrev_b32 v9, 4, v3
    s_lshl_b32 s6, s29, 6
    s_add_u32 s6, s6, 512
    v_add_u32 v3, s6, v0
    v_lshlrev_b32 v10, 4, v3
    s_lshl_b32 s6, s29, 6
    s_add_u32 s6, s6, 768
    v_add_u32 v3, s6, v0
    v_lshlrev_b32 v11, 4, v3
    s_lshl_b32 s32, s29, 10
    s_mov_b32 s33, 0
    s_mov_b32 s34, 0
    s_add_u32 s35, s32, 122880
    s_cmp_ge_u32 s29, 2
    s_cbranch_scc1 L_eldb
L_elda:
    s_cmp_lg_u32 s3, 4
    s_cbranch_scc1 L_oth23
    v_and_b32 v17, 15, v0
    v_lshlrev_b32 v17, 2, v17
L_spin25:
    ds_read_b32 v16, v254 offset:24
    s_sub_u32 s37, s37, 1
    s_cselect_b32 s37, 0, s37
    s_cbranch_scc1 L_spin25x
    s_waitcnt lgkmcnt(0)
    v_readfirstlane_b32 s6, v16
    s_cmp_ge_u32 s6, 4
    s_cbranch_scc1 L_spin25x
    s_sleep 1
    s_branch L_spin25
L_spin25x:
    s_waitcnt lgkmcnt(0)
    s_cmp_lg_u32 s3, 4
    s_cbranch_scc1 L_pub26
    s_lshl_b32 s6, s4, 7
    s_add_u32 s6, s6, s5
    s_lshl_b32 s6, s6, 2
    s_add_u32 s6, s6, 24576
    v_mov_b32 v3, 1
    s_mov_b64 exec, 1
    buffer_store_dword v3, off, s[60:63], s6 sc1
    s_mov_b64 exec, -1
L_pub26:
    s_lshl_b32 s6, s4, 9
    s_add_u32 s6, s6, 24576
L_poll24:
    buffer_load_dword v16, v17, s[60:63], s6 offen sc1
    s_sub_u32 s37, s37, 1
    s_cselect_b32 s37, 0, s37
    s_cbranch_scc1 L_poll24x
    s_waitcnt vmcnt(0)
    v_cmp_eq_u32 vcc, 1, v16
    s_cmp_eq_u64 vcc, -1
    s_cbranch_scc1 L_poll24x
    s_sleep 1
    s_branch L_poll24
L_poll24x:
    ds_write_b32 v254, v254 offset:28
L_spin28:
    ds_read_b32 v16, v254 offset:32
    s_sub_u32 s37, s37, 1
    s_cselect_b32 s37, 0, s37
    s_cbranch_scc1 L_spin28x
    s_waitcnt lgkmcnt(0)
    v_readfirstlane_b32 s6, v16
    s_cmp_ge_u32 s6, 4
    s_cbranch_scc1 L_spin28x
    s_sleep 1
    s_branch L_spin28
L_spin28x:
    s_waitcnt lgkmcnt(0)
    s_cmp_lg_u32 s3, 4
    s_cbranch_scc1 L_pub29
    s_lshl_b32 s6, s5, 7
    s_add_u32 s6, s6, s4
    s_lshl_b32 s6, s6, 2
    s_add_u32 s6, s6, 32768
    v_mov_b32 v3, 1
    s_mov_b64 exec, 1
    buffer_store_dword v3, off, s[60:63], s6 sc1
    s_mov_b64 exec, -1
L_pub29:
    s_mov_b64 exec, 1
    ds_add_u32 v254, v3 offset:32
    s_mov_b64 exec, -1
    s_add_u32 s96, s74, 0
    s_addc_u32 s97, s75, 0
    s_mov_b32 s98, 8388608
    s_mov_b32 s99, 0x20000
    s_and_b32 s6, s5, 7
    s_lshl_b32 s6, s6, 2
    s_and_b32 s7, s4, 3
    s_add_u32 s6, s6, s7
    s_lshl_b32 s6, s6, 2
    s_add_u32 s6, s6, s29
    s_mul_i32 s6, s6, 16384
    s_and_b32 s7, s4, 12
    s_mul_i32 s7, s7, 524288
    s_add_u32 s6, s6, s7
    v_lshrrev_b32 v252, 1, v0
    v_lshlrev_b32 v252, 10, v252
    v_and_b32 v251, 1, v0
    v_lshl_add_u32 v252, v251, 6, v252
    s_bfm_b64 exec, 32, 0
    buffer_load_dword v253, v252, s[96:99], s6 offen offset:384
    s_mov_b64 exec, -1
    s_add_u32 m0, s32, 0
    s_nop 0
    buffer_load_dwordx4 v4, s[8:11], s33 offen lds
    s_add_u32 m0, s32, 4096
    s_nop 0
    buffer_load_dwordx4 v5, s[8:11], s33 offen lds
    s_add_u32 m0, s32, 8192
    s_nop 0
    buffer_load_dwordx4 v6, s[8:11], s33 offen lds
    s_add_u32 m0, s32, 12288
    s_nop 0
    buffer_load_dwordx4 v7, s[8:11], s33 offen lds
    s_add_u32 s33, s33, 128
    s_add_u32 m0, s32, 30720
    s_nop 0
    buffer_load_dwordx4 v4, s[8:11], s33 offen lds
    s_add_u32 m0, s32, 34816
    s_nop 0
    buffer_load_dwordx4 v5, s[8:11], s33 offen lds
    s_add_u32 m0, s32, 38912
    s_nop 0
    buffer_load_dwordx4 v6, s[8:11], s33 offen lds
    s_add_u32 m0, s32, 43008
    s_nop 0
    buffer_load_dwordx4 v7, s[8:11], s33 offen lds
    s_add_u32 s33, s33, 128
    s_add_u32 m0, s32, 61440
    s_nop 0
    buffer_load_dwordx4 v4, s[8:11], s33 offen lds
    s_add_u32 m0, s32, 65536
    s_nop 0
    buffer_load_dwordx4 v5, s[8:11], s33 offen lds
    s_add_u32 m0, s32, 69632
    s_nop 0
    buffer_load_dwordx4 v6, s[8:11], s33 offen lds
    s_add_u32 m0, s32, 73728
    s_nop 0
    buffer_load_dwordx4 v7, s[8:11], s33 offen lds
    s_add_u32 s33, s33, 128
    s_lshl_b32 s6, s5, 9
    s_add_u32 s6, s6, 32768
L_poll27:
    buffer_load_dword v16, v17, s[60:63], s6 offen sc1
    s_sub_u32 s37, s37, 1
    s_cselect_b32 s37, 0, s37
    s_cbranch_scc1 L_poll27x
    s_waitcnt vmcnt(0)
    v_cmp_eq_u32 vcc, 1, v16
    s_cmp_eq_u64 vcc, -1
    s_cbranch_scc1 L_poll27x
    s_sleep 1
    s_branch L_poll27
L_poll27x:
    ds_write_b32 v254, v254 offset:36
    s_branch L_oth23x
L_oth23:
L_spin30:
    ds_read_b32 v16, v254 offset:32
    s_sub_u32 s37, s37, 1
    s_cselect_b32 s37, 0, s37
    s_cbranch_scc1 L_spin30x
    s_waitcnt lgkmcnt(0)
    v_readfirstlane_b32 s6, v16
    s_cmp_ge_u32 s6, 5
    s_cbranch_scc1 L_spin30x
    s_sleep 1
    s_branch L_spin30
L_spin30x:
    s_waitcnt lgkmcnt(0)
    s_add_u32 s96, s74, 0
    s_addc_u32 s97, s75, 0
    s_mov_b32 s98, 8388608
    s_mov_b32 s99, 0x20000
    s_and_b32 s6, s5, 7
    s_lshl_b32 s6, s6, 2
    s_and_b32 s7, s4, 3
    s_add_u32 s6, s6, s7
    s_lshl_b32 s6, s6, 2
    s_add_u32 s6, s6, s29
    s_mul_i32 s6, s6, 16384
    s_and_b32 s7, s4, 12
    s_mul_i32 s7, s7, 524288
    s_add_u32 s6, s6, s7
    v_lshrrev_b32 v252, 1, v0
    v_lshlrev_b32 v252, 10, v252
    v_and_b32 v251, 1, v0
    v_lshl_add_u32 v252, v251, 6, v252
    s_bfm_b64 exec, 32, 0
    buffer_load_dword v253, v252, s[96:99], s6 offen offset:384
    s_mov_b64 exec, -1
    s_add_u32 m0, s32, 0
    s_nop 0
    buffer_load_dwordx4 v4, s[8:11], s33 offen lds
    s_add_u32 m0, s32, 4096
    s_nop 0
    buffer_load_dwordx4 v5, s[8:11], s33 offen lds
    s_add_u32 m0, s32, 8192
    s_nop 0
    buffer_load_dwordx4 v6, s[8:11], s33 offen lds
    s_add_u32 m0, s32, 12288
    s_nop 0
    buffer_load_dwordx4 v7, s[8:11], s33 offen lds
    s_add_u32 s33, s33, 128
    s_add_u32 m0, s32, 30720
    s_nop 0
    buffer_load_dwordx4 v4, s[8:11], s33 offen lds
    s_add_u32 m0, s32, 34816
    s_nop 0
    buffer_load_dwordx4 v5, s[8:11], s33 offen lds
    s_add_u32 m0, s32, 38912
    s_nop 0
    buffer_load_dwordx4 v6, s[8:11], s33 offen lds
    s_add_u32 m0, s32, 43008
    s_nop 0
    buffer_load_dwordx4 v7, s[8:11], s33 offen lds
    s_add_u32 s33, s33, 128
    s_add_u32 m0, s32, 61440
    s_nop 0
    buffer_load_dwordx4 v4, s[8:11], s33 offen lds
    s_add_u32 m0, s32, 65536
    s_nop 0
    buffer_load_dwordx4 v5, s[8:11], s33 offen lds
    s_add_u32 m0, s32, 69632
    s_nop 0
    buffer_load_dwordx4 v6, s[8:11], s33 offen lds
    s_add_u32 m0, s32, 73728
    s_nop 0
    buffer_load_dwordx4 v7, s[8:11], s33 offen lds
    s_add_u32 s33, s33, 128
L_spin31:
    ds_read_b32 v16, v254 offset:36
    s_sub_u32 s37, s37, 1
    s_cselect_b32 s37, 0, s37
    s_cbranch_scc1 L_spin31x
    s_waitcnt lgkmcnt(0)
    v_readfirstlane_b32 s6, v16
    s_cmp_ge_u32 s6, 1
    s_cbranch_scc1 L_spin31x
    s_sleep 1
    s_branch L_spin31
L_spin31x:
    s_waitcnt lgkmcnt(0)
L_oth23x:
    s_add_u32 m0, s32, 16384
    s_nop 0
    buffer_load_dwordx4 v8, s[12:15], s34 offen sc1 lds
    s_add_u32 m0, s32, 20480
    s_nop 0
    buffer_load_dwordx4 v9, s[12:15], s34 offen sc1 lds
    s_add_u32 m0, s32, 24576
    s_nop 0
    buffer_load_dwordx4 v10, s[12:15], s34 offen sc1 lds
    s_add_u32 m0, s32, 28672
    s_nop 0
    buffer_load_dwordx4 v11, s[12:15], s34 offen sc1 lds
    s_add_u32 s34, s34, 14336
    s_add_u32 m0, s32, 47104
    s_nop 0
    buffer_load_dwordx4 v8, s[12:15], s34 offen sc1 lds
    s_add_u32 m0, s32, 51200
    s_nop 0
    buffer_load_dwordx4 v9, s[12:15], s34 offen sc1 lds
    s_add_u32 m0, s32, 55296
    s_nop 0
    buffer_load_dwordx4 v10, s[12:15], s34 offen sc1 lds
    s_add_u32 m0, s32, 59392
    s_nop 0
    buffer_load_dwordx4 v11, s[12:15], s34 offen sc1 lds
    s_add_u32 s34, s34, 14336
    s_add_u32 m0, s32, 77824
    s_nop 0
    buffer_load_dwordx4 v8, s[12:15], s34 offen sc1 lds
    s_add_u32 m0, s32, 81920
    s_nop 0
    buffer_load_dwordx4 v9, s[12:15], s34 offen sc1 lds
    s_add_u32 m0, s32, 86016
    s_nop 0
    buffer_load_dwordx4 v10, s[12:15], s34 offen sc1 lds
    s_add_u32 m0, s32, 90112
    s_nop 0
    buffer_load_dwordx4 v11, s[12:15], s34 offen sc1 lds
    s_add_u32 s34, s34, 14336
    s_add_u32 s32, s32, 92160
    s_waitcnt vmcnt(8)
    s_barrier
    s_add_u32 m0, s32, 0
    s_nop 0
    buffer_load_dwordx4 v4, s[8:11], s33 offen lds
    s_add_u32 m0, s32, 4096
    s_nop 0
    buffer_load_dwordx4 v5, s[8:11], s33 offen lds
    s_add_u32 m0, s32, 8192
    s_nop 0
    buffer_load_dwordx4 v6, s[8:11], s33 offen lds
    s_add_u32 m0, s32, 12288
    s_nop 0
    buffer_load_dwordx4 v7, s[8:11], s33 offen lds
    s_add_u32 s33, s33, 128
    s_add_u32 m0, s32, 16384
    s_nop 0
    buffer_load_dwordx4 v8, s[12:15], s34 offen sc1 lds
    s_add_u32 m0, s32, 20480
    s_nop 0
    buffer_load_dwordx4 v9, s[12:15], s34 offen sc1 lds
    s_add_u32 m0, s32, 24576
    s_nop 0
    buffer_load_dwordx4 v10, s[12:15], s34 offen sc1 lds
    s_add_u32 m0, s32, 28672
    s_nop 0
    buffer_load_dwordx4 v11, s[12:15], s34 offen sc1 lds
    s_add_u32 s34, s34, 14336
    s_add_u32 s32, s32, 30720
    s_cmp_ge_u32 s32, s35
    s_cselect_b32 s6, 122880, 0
    s_sub_u32 s32, s32, s6
    s_waitcnt vmcnt(12)
    s_barrier
    s_add_u32 m0, s32, 0
    s_nop 0
    buffer_load_dwordx4 v4, s[8:11], s33 offen lds
    s_add_u32 m0, s32, 4096
    s_nop 0
    buffer_load_dwordx4 v5, s[8:11], s33 offen lds
    s_add_u32 m0, s32, 8192
    s_nop 0
    buffer_load_dwordx4 v6, s[8:11], s33 offen lds
    s_add_u32 m0, s32, 12288
    s_nop 0
    buffer_load_dwordx4 v7, s[8:11], s33 offen lds
    s_add_u32 s33, s33, 128
    s_add_u32 m0, s32, 16384
    s_nop 0
    buffer_load_dwordx4 v8, s[12:15], s34 offen sc1 lds
    s_add_u32 m0, s32, 20480
    s_nop 0
    buffer_load_dwordx4 v9, s[12:15], s34 offen sc1 lds
    s_add_u32 m0, s32, 24576
    s_nop 0
    buffer_load_dwordx4 v10, s[12:15], s34 offen sc1 lds
    s_add_u32 m0, s32, 28672
    s_nop 0
    buffer_load_dwordx4 v11, s[12:15], s34 offen sc1 lds
    s_add_u32 s34, s34, 14336
    s_add_u32 s32, s32, 30720
    s_cmp_ge_u32 s32, s35
    s_cselect_b32 s6, 122880, 0
    s_sub_u32 s32, s32, s6
    s_mov_b32 s36, 27
L_elpa:
    s_waitcnt vmcnt(16)
    s_barrier
    s_add_u32 m0, s32, 0
    s_nop 0
    buffer_load_dwordx4 v4, s[8:11], s33 offen lds
    s_add_u32 m0, s32, 4096
    s_nop 0
    buffer_load_dwordx4 v5, s[8:11], s33 offen lds
    s_add_u32 m0, s32, 8192
    s_nop 0
    buffer_load_dwordx4 v6, s[8:11], s33 offen lds
    s_add_u32 m0, s32, 12288
    s_nop 0
    buffer_load_dwordx4 v7, s[8:11], s33 offen lds
    s_add_u32 s33, s33, 128
    s_add_u32 m0, s32, 16384
    s_nop 0
    buffer_load_dwordx4 v8, s[12:15], s34 offen sc1 lds
    s_add_u32 m0, s32, 20480
    s_nop 0
    buffer_load_dwordx4 v9, s[12:15], s34 offen sc1 lds
    s_add_u32 m0, s32, 24576
    s_nop 0
    buffer_load_dwordx4 v10, s[12:15], s34 offen sc1 lds
    s_add_u32 m0, s32, 28672
    s_nop 0
    buffer_load_dwordx4 v11, s[12:15], s34 offen sc1 lds
    s_add_u32 s34, s34, 14336
    s_add_u32 s32, s32, 30720
    s_cmp_ge_u32 s32, s35
    s_cselect_b32 s6, 122880, 0
    s_sub_u32 s32, s32, s6
    s_sub_u32 s36, s36, 1
    s_cmp_lg_u32 s36, 0
    s_cbranch_scc1 L_elpa
    s_add_u32 s96, s78, 0
    s_addc_u32 s97, s79, 0
    s_mov_b32 s98, 3670016
    s_mov_b32 s99, 0x20000
    s_mul_i32 s6, s5, 128
    s_mul_i32 s7, s29, 65536
    s_add_u32 s6, s6, s7
    v_lshrrev_b32 v252, 1, v0
    v_mul_u32_u24 v252, 2048, v252
    v_and_b32 v251, 1, v0
    v_lshl_add_u32 v252, v251, 6, v252
    buffer_load_dword v253, v252, s[96:99], s6 offen
    s_add_u32 s6, s6, 262144
    buffer_load_dword v253, v252, s[96:99], s6 offen
    s_add_u32 s6, s6, 262144
    buffer_load_dword v253, v252, s[96:99], s6 offen
    s_add_u32 s6, s6, 262144
    s_waitcnt vmcnt(19)
    s_barrier
    s_waitcnt vmcnt(11)
    s_barrier
    s_waitcnt vmcnt(3)
    s_barrier
    s_branch L_eldx
L_eldb:
    s_cmp_lg_u32 s3, 4
    s_cbranch_scc1 L_oth32
    v_and_b32 v17, 15, v0
    v_lshlrev_b32 v17, 2, v17
L_spin34:
    ds_read_b32 v16, v254 offset:24
    s_sub_u32 s37, s37, 1
    s_cselect_b32 s37, 0, s37
    s_cbranch_scc1 L_spin34x
    s_waitcnt lgkmcnt(0)
    v_readfirstlane_b32 s6, v16
    s_cmp_ge_u32 s6, 4
    s_cbranch_scc1 L_spin34x
    s_sleep 1
    s_branch L_spin34
L_spin34x:
    s_waitcnt lgkmcnt(0)
    s_cmp_lg_u32 s3, 4
    s_cbranch_scc1 L_pub35
    s_lshl_b32 s6, s4, 7
    s_add_u32 s6, s6, s5
    s_lshl_b32 s6, s6, 2
    s_add_u32 s6, s6, 24576
    v_mov_b32 v3, 1
    s_mov_b64 exec, 1
    buffer_store_dword v3, off, s[60:63], s6 sc1
    s_mov_b64 exec, -1
L_pub35:
    s_lshl_b32 s6, s4, 9
    s_add_u32 s6, s6, 24576
L_poll33:
    buffer_load_dword v16, v17, s[60:63], s6 offen sc1
    s_sub_u32 s37, s37, 1
    s_cselect_b32 s37, 0, s37
    s_cbranch_scc1 L_poll33x
    s_waitcnt vmcnt(0)
    v_cmp_eq_u32 vcc, 1, v16
    s_cmp_eq_u64 vcc, -1
    s_cbranch_scc1 L_poll33x
    s_sleep 1
    s_branch L_poll33
L_poll33x:
    ds_write_b32 v254, v254 offset:28
L_spin37:
    ds_read_b32 v16, v254 offset:32
    s_sub_u32 s37, s37, 1
    s_cselect_b32 s37, 0, s37
    s_cbranch_scc1 L_spin37x
    s_waitcnt lgkmcnt(0)
    v_readfirstlane_b32 s6, v16
    s_cmp_ge_u32 s6, 4
    s_cbranch_scc1 L_spin37x
    s_sleep 1
    s_branch L_spin37
L_spin37x:
    s_waitcnt lgkmcnt(0)
    s_cmp_lg_u32 s3, 4
    s_cbranch_scc1 L_pub38
    s_lshl_b32 s6, s5, 7
    s_add_u32 s6, s6, s4
    s_lshl_b32 s6, s6, 2
    s_add_u32 s6, s6, 32768
    v_mov_b32 v3, 1
    s_mov_b64 exec, 1
    buffer_store_dword v3, off, s[60:63], s6 sc1
    s_mov_b64 exec, -1
L_pub38:
    s_mov_b64 exec, 1
    ds_add_u32 v254, v3 offset:32
    s_mov_b64 exec, -1
    s_add_u32 s96, s74, 0
    s_addc_u32 s97, s75, 0
    s_mov_b32 s98, 8388608
    s_mov_b32 s99, 0x20000
    s_and_b32 s6, s5, 7
    s_lshl_b32 s6, s6, 2
    s_and_b32 s7, s4, 3
    s_add_u32 s6, s6, s7
    s_lshl_b32 s6, s6, 2
    s_add_u32 s6, s6, s29
    s_mul_i32 s6, s6, 16384
    s_and_b32 s7, s4, 12
    s_mul_i32 s7, s7, 524288
    s_add_u32 s6, s6, s7
    v_lshrrev_b32 v252, 1, v0
    v_lshlrev_b32 v252, 10, v252
    v_and_b32 v251, 1, v0
    v_lshl_add_u32 v252, v251, 6, v252
    s_bfm_b64 exec, 32, 0
    buffer_load_dword v253, v252, s[96:99], s6 offen offset:384
    s_mov_b64 exec, -1
    s_add_u32 m0, s32, 0
    s_nop 0
    buffer_load_dwordx4 v4, s[8:11], s33 offen lds
    s_add_u32 m0, s32, 4096
    s_nop 0
    buffer_load_dwordx4 v5, s[8:11], s33 offen lds
    s_add_u32 m0, s32, 8192
    s_nop 0
    buffer_load_dwordx4 v6, s[8:11], s33 offen lds
    s_add_u32 m0, s32, 12288
    s_nop 0
    buffer_load_dwordx4 v7, s[8:11], s33 offen lds
    s_add_u32 s33, s33, 128
    s_add_u32 m0, s32, 30720
    s_nop 0
    buffer_load_dwordx4 v4, s[8:11], s33 offen lds
    s_add_u32 m0, s32, 34816
    s_nop 0
    buffer_load_dwordx4 v5, s[8:11], s33 offen lds
    s_add_u32 m0, s32, 38912
    s_nop 0
    buffer_load_dwordx4 v6, s[8:11], s33 offen lds
    s_add_u32 m0, s32, 43008
    s_nop 0
    buffer_load_dwordx4 v7, s[8:11], s33 offen lds
    s_add_u32 s33, s33, 128
    s_add_u32 m0, s32, 61440
    s_nop 0
    buffer_load_dwordx4 v4, s[8:11], s33 offen lds
    s_add_u32 m0, s32, 65536
    s_nop 0
    buffer_load_dwordx4 v5, s[8:11], s33 offen lds
    s_add_u32 m0, s32, 69632
    s_nop 0
    buffer_load_dwordx4 v6, s[8:11], s33 offen lds
    s_add_u32 m0, s32, 73728
    s_nop 0
    buffer_load_dwordx4 v7, s[8:11], s33 offen lds
    s_add_u32 s33, s33, 128
    s_lshl_b32 s6, s5, 9
    s_add_u32 s6, s6, 32768
L_poll36:
    buffer_load_dword v16, v17, s[60:63], s6 offen sc1
    s_sub_u32 s37, s37, 1
    s_cselect_b32 s37, 0, s37
    s_cbranch_scc1 L_poll36x
    s_waitcnt vmcnt(0)
    v_cmp_eq_u32 vcc, 1, v16
    s_cmp_eq_u64 vcc, -1
    s_cbranch_scc1 L_poll36x
    s_sleep 1
    s_branch L_poll36
L_poll36x:
    ds_write_b32 v254, v254 offset:36
    s_branch L_oth32x
L_oth32:
L_spin39:
    ds_read_b32 v16, v254 offset:32
    s_sub_u32 s37, s37, 1
    s_cselect_b32 s37, 0, s37
    s_cbranch_scc1 L_spin39x
    s_waitcnt lgkmcnt(0)
    v_readfirstlane_b32 s6, v16
    s_cmp_ge_u32 s6, 5
    s_cbranch_scc1 L_spin39x
    s_sleep 1
    s_branch L_spin39
L_spin39x:
    s_waitcnt lgkmcnt(0)
    s_add_u32 s96, s74, 0
    s_addc_u32 s97, s75, 0
    s_mov_b32 s98, 8388608
    s_mov_b32 s99, 0x20000
    s_and_b32 s6, s5, 7
    s_lshl_b32 s6, s6, 2
    s_and_b32 s7, s4, 3
    s_add_u32 s6, s6, s7
    s_lshl_b32 s6, s6, 2
    s_add_u32 s6, s6, s29
    s_mul_i32 s6, s6, 16384
    s_and_b32 s7, s4, 12
    s_mul_i32 s7, s7, 524288
    s_add_u32 s6, s6, s7
    v_lshrrev_b32 v252, 1, v0
    v_lshlrev_b32 v252, 10, v252
    v_and_b32 v251, 1, v0
    v_lshl_add_u32 v252, v251, 6, v252
    s_bfm_b64 exec, 32, 0
    buffer_load_dword v253, v252, s[96:99], s6 offen offset:384
    s_mov_b64 exec, -1
    s_add_u32 m0, s32, 0
    s_nop 0
    buffer_load_dwordx4 v4, s[8:11], s33 offen lds
    s_add_u32 m0, s32, 4096
    s_nop 0
    buffer_load_dwordx4 v5, s[8:11], s33 offen lds
    s_add_u32 m0, s32, 8192
    s_nop 0
    buffer_load_dwordx4 v6, s[8:11], s33 offen lds
    s_add_u32 m0, s32, 12288
    s_nop 0
    buffer_load_dwordx4 v7, s[8:11], s33 offen lds
    s_add_u32 s33, s33, 128
    s_add_u32 m0, s32, 30720
    s_nop 0
    buffer_load_dwordx4 v4, s[8:11], s33 offen lds
    s_add_u32 m0, s32, 34816
    s_nop 0
    buffer_load_dwordx4 v5, s[8:11], s33 offen lds
    s_add_u32 m0, s32, 38912
    s_nop 0
    buffer_load_dwordx4 v6, s[8:11], s33 offen lds
    s_add_u32 m0, s32, 43008
    s_nop 0
    buffer_load_dwordx4 v7, s[8:11], s33 offen lds
    s_add_u32 s33, s33, 128
    s_add_u32 m0, s32, 61440
    s_nop 0
    buffer_load_dwordx4 v4, s[8:11], s33 offen lds
    s_add_u32 m0, s32, 65536
    s_nop 0
    buffer_load_dwordx4 v5, s[8:11], s33 offen lds
    s_add_u32 m0, s32, 69632
    s_nop 0
    buffer_load_dwordx4 v6, s[8:11], s33 offen lds
    s_add_u32 m0, s32, 73728
    s_nop 0
    buffer_load_dwordx4 v7, s[8:11], s33 offen lds
    s_add_u32 s33, s33, 128
L_spin40:
    ds_read_b32 v16, v254 offset:36
    s_sub_u32 s37, s37, 1
    s_cselect_b32 s37, 0, s37
    s_cbranch_scc1 L_spin40x
    s_waitcnt lgkmcnt(0)
    v_readfirstlane_b32 s6, v16
    s_cmp_ge_u32 s6, 1
    s_cbranch_scc1 L_spin40x
    s_sleep 1
    s_branch L_spin40
L_spin40x:
    s_waitcnt lgkmcnt(0)
L_oth32x:
    s_add_u32 m0, s32, 16384
    s_nop 0
    buffer_load_dwordx4 v8, s[12:15], s34 offen sc1 lds
    s_add_u32 m0, s32, 20480
    s_nop 0
    buffer_load_dwordx4 v9, s[12:15], s34 offen sc1 lds
    s_add_u32 m0, s32, 24576
    s_nop 0
    buffer_load_dwordx4 v10, s[12:15], s34 offen sc1 lds
    s_add_u32 s34, s34, 14336
    s_add_u32 m0, s32, 47104
    s_nop 0
    buffer_load_dwordx4 v8, s[12:15], s34 offen sc1 lds
    s_add_u32 m0, s32, 51200
    s_nop 0
    buffer_load_dwordx4 v9, s[12:15], s34 offen sc1 lds
    s_add_u32 m0, s32, 55296
    s_nop 0
    buffer_load_dwordx4 v10, s[12:15], s34 offen sc1 lds
    s_add_u32 s34, s34, 14336
    s_add_u32 m0, s32, 77824
    s_nop 0
    buffer_load_dwordx4 v8, s[12:15], s34 offen sc1 lds
    s_add_u32 m0, s32, 81920
    s_nop 0
    buffer_load_dwordx4 v9, s[12:15], s34 offen sc1 lds
    s_add_u32 m0, s32, 86016
    s_nop 0
    buffer_load_dwordx4 v10, s[12:15], s34 offen sc1 lds
    s_add_u32 s34, s34, 14336
    s_add_u32 s32, s32, 92160
    s_waitcnt vmcnt(6)
    s_barrier
    s_add_u32 m0, s32, 0
    s_nop 0
    buffer_load_dwordx4 v4, s[8:11], s33 offen lds
    s_add_u32 m0, s32, 4096
    s_nop 0
    buffer_load_dwordx4 v5, s[8:11], s33 offen lds
    s_add_u32 m0, s32, 8192
    s_nop 0
    buffer_load_dwordx4 v6, s[8:11], s33 offen lds
    s_add_u32 m0, s32, 12288
    s_nop 0
    buffer_load_dwordx4 v7, s[8:11], s33 offen lds
    s_add_u32 s33, s33, 128
    s_add_u32 m0, s32, 16384
    s_nop 0
    buffer_load_dwordx4 v8, s[12:15], s34 offen sc1 lds
    s_add_u32 m0, s32, 20480
    s_nop 0
    buffer_load_dwordx4 v9, s[12:15], s34 offen sc1 lds
    s_add_u32 m0, s32, 24576
    s_nop 0
    buffer_load_dwordx4 v10, s[12:15], s34 offen sc1 lds
    s_add_u32 s34, s34, 14336
    s_add_u32 s32, s32, 30720
    s_cmp_ge_u32 s32, s35
    s_cselect_b32 s6, 122880, 0
    s_sub_u32 s32, s32, s6
    s_waitcnt vmcnt(10)
    s_barrier
    s_add_u32 m0, s32, 0
    s_nop 0
    buffer_load_dwordx4 v4, s[8:11], s33 offen lds
    s_add_u32 m0, s32, 4096
    s_nop 0
    buffer_load_dwordx4 v5, s[8:11], s33 offen lds
    s_add_u32 m0, s32, 8192
    s_nop 0
    buffer_load_dwordx4 v6, s[8:11], s33 offen lds
    s_add_u32 m0, s32, 12288
    s_nop 0
    buffer_load_dwordx4 v7, s[8:11], s33 offen lds
    s_add_u32 s33, s33, 128
    s_add_u32 m0, s32, 16384
    s_nop 0
    buffer_load_dwordx4 v8, s[12:15], s34 offen sc1 lds
    s_add_u32 m0, s32, 20480
    s_nop 0
    buffer_load_dwordx4 v9, s[12:15], s34 offen sc1 lds
    s_add_u32 m0, s32, 24576
    s_nop 0
    buffer_load_dwordx4 v10, s[12:15], s34 offen sc1 lds
    s_add_u32 s34, s34, 14336
    s_add_u32 s32, s32, 30720
    s_cmp_ge_u32 s32, s35
    s_cselect_b32 s6, 122880, 0
    s_sub_u32 s32, s32, s6
    s_mov_b32 s36, 27
L_elpb:
    s_waitcnt vmcnt(14)
    s_barrier
    s_add_u32 m0, s32, 0
    s_nop 0
    buffer_load_dwordx4 v4, s[8:11], s33 offen lds
    s_add_u32 m0, s32, 4096
    s_nop 0
    buffer_load_dwordx4 v5, s[8:11], s33 offen lds
    s_add_u32 m0, s32, 8192
    s_nop 0
    buffer_load_dwordx4 v6, s[8:11], s33 offen lds
    s_add_u32 m0, s32, 12288
    s_nop 0
    buffer_load_dwordx4 v7, s[8:11], s33 offen lds
    s_add_u32 s33, s33, 128
    s_add_u32 m0, s32, 16384
    s_nop 0
    buffer_load_dwordx4 v8, s[12:15], s34 offen sc1 lds
    s_add_u32 m0, s32, 20480
    s_nop 0
    buffer_load_dwordx4 v9, s[12:15], s34 offen sc1 lds
    s_add_u32 m0, s32, 24576
    s_nop 0
    buffer_load_dwordx4 v10, s[12:15], s34 offen sc1 lds
    s_add_u32 s34, s34, 14336
    s_add_u32 s32, s32, 30720
    s_cmp_ge_u32 s32, s35
    s_cselect_b32 s6, 122880, 0
    s_sub_u32 s32, s32, s6
    s_sub_u32 s36, s36, 1
    s_cmp_lg_u32 s36, 0
    s_cbranch_scc1 L_elpb
    s_add_u32 s96, s78, 0
    s_addc_u32 s97, s79, 0
    s_mov_b32 s98, 3670016
    s_mov_b32 s99, 0x20000
    s_mul_i32 s6, s5, 128
    s_mul_i32 s7, s29, 65536
    s_add_u32 s6, s6, s7
    v_lshrrev_b32 v252, 1, v0
    v_mul_u32_u24 v252, 2048, v252
    v_and_b32 v251, 1, v0
    v_lshl_add_u32 v252, v251, 6, v252
    buffer_load_dword v253, v252, s[96:99], s6 offen
    s_add_u32 s6, s6, 262144
    buffer_load_dword v253, v252, s[96:99], s6 offen
    s_add_u32 s6, s6, 262144
    buffer_load_dword v253, v252, s[96:99], s6 offen
    s_add_u32 s6, s6, 262144
    s_waitcnt vmcnt(17)
    s_barrier
    s_waitcnt vmcnt(10)
    s_barrier
    s_waitcnt vmcnt(3)
    s_barrier
L_eldx:
    s_barrier
    s_mul_i32 s6, s4, 458752
    s_add_u32 s8, s84, 41943040
    s_addc_u32 s9, s85, 0
    s_add_u32 s8, s8, s6
    s_addc_u32 s9, s9, 0
    s_mov_b32 s10, 458752
    s_mov_b32 s11, 0x20000
    s_mul_i32 s6, s5, 128
    s_add_u32 s12, s78, 0
    s_addc_u32 s13, s79, 0
    s_add_u32 s12, s12, s6
    s_addc_u32 s13, s13, 0
    s_mov_b32 s14, 3670016
    s_mov_b32 s15, 0x20000
    s_sub_u32 s14, s14, s6
    v_lshrrev_b32 v3, 3, v0
    s_lshl_b32 s6, s29, 3
    v_add_u32 v3, s6, v3
    v_lshrrev_b32 v4, 1, v3
    v_xor_b32 v4, v4, v0
    v_and_b32 v4, 7, v4
    v_lshlrev_b32 v4, 4, v4
    s_mov_b32 s6, 3584
    v_mad_u32_u24 v4, v3, s6, v4
    s_lshl_b32 s6, s29, 10
    v_lshl_add_u32 v4, v0, 4, s6
    v_add_u32 v5, 4096, v4
    v_add_u32 v6, 8192, v4
    v_add_u32 v7, 12288, v4
    s_lshl_b32 s6, s29, 6
    s_add_u32 s6, s6, 0
    v_add_u32 v3, s6, v0
    s_mov_b32 s6, 8192
    v_mul_u32_u24 v20, s6, v3
    v_lshrrev_b32 v20, 16, v20
    v_mul_u32_u24 v21, 8, v20
    v_sub_u32 v21, v3, v21
    v_bfe_u32 v22, v20, 3, 1
    v_bfe_u32 v23, v20, 1, 1
    v_lshl_add_u32 v22, v22, 1, v23
    v_lshlrev_b32 v22, 1, v22
    v_xor_b32 v21, v21, v22
    v_mov_b32 v22, 0
    v_lshl_add_u32 v21, v21, 4, v22
    s_mov_b32 s6, 2048
    v_mad_u32_u24 v8, v20, s6, v21
    s_lshl_b32 s6, s29, 6
    s_add_u32 s6, s6, 256
    v_add_u32 v3, s6, v0
    s_mov_b32 s6, 8192
    v_mul_u32_u24 v20, s6, v3
    v_lshrrev_b32 v20, 16, v20
    v_mul_u32_u24 v21, 8, v20
    v_sub_u32 v21, v3, v21
    v_bfe_u32 v22, v20, 3, 1
    v_bfe_u32 v23, v20, 1, 1
    v_lshl_add_u32 v22, v22, 1, v23
    v_lshlrev_b32 v22, 1, v22
    v_xor_b32 v21, v21, v22
    v_mov_b32 v22, 0
    v_lshl_add_u32 v21, v21, 4, v22
    s_mov_b32 s6, 2048
    v_mad_u32_u24 v9, v20, s6, v21
    s_lshl_b32 s32, s29, 10
    s_mov_b32 s33, 0
    s_mov_b32 s34, 0
    s_add_u32 s35, s32, 147456
L_flda:
    s_cmp_lg_u32 s3, 4
    s_cbranch_scc1 L_oth41
    v_and_b32 v17, 15, v0
    v_lshlrev_b32 v17, 2, v17
L_spin43:
    ds_read_b32 v16, v254 offset:40
    s_sub_u32 s37, s37, 1
    s_cselect_b32 s37, 0, s37
    s_cbranch_scc1 L_spin43x
    s_waitcnt lgkmcnt(0)
    v_readfirstlane_b32 s6, v16
    s_cmp_ge_u32 s6, 4
    s_cbranch_scc1 L_spin43x
    s_sleep 1
    s_branch L_spin43
L_spin43x:
    s_waitcnt lgkmcnt(0)
    s_cmp_lg_u32 s3, 4
    s_cbranch_scc1 L_pub44
    s_lshl_b32 s6, s4, 7
    s_add_u32 s6, s6, s5
    s_lshl_b32 s6, s6, 2
    s_add_u32 s6, s6, 40960
    v_mov_b32 v3, 1
    s_mov_b64 exec, 1
    buffer_store_dword v3, off, s[60:63], s6 sc1
    s_mov_b64 exec, -1
L_pub44:
    s_mov_b64 exec, 1
    ds_add_u32 v254, v3 offset:40
    s_mov_b64 exec, -1
    s_add_u32 s96, s78, 0
    s_addc_u32 s97, s79, 0
    s_mov_b32 s98, 3670016
    s_mov_b32 s99, 0x20000
    s_and_b32 s6, s5, 7
    s_lshl_b32 s6, s6, 2
    s_and_b32 s7, s4, 3
    s_add_u32 s6, s6, s7
    s_lshl_b32 s6, s6, 2
    s_add_u32 s6, s6, s29
    s_mul_i32 s6, s6, 28672
    s_and_b32 s7, s5, 8
    s_lshl_b32 s7, s7, 7
    s_add_u32 s6, s6, s7
    v_lshrrev_b32 v252, 1, v0
    v_lshlrev_b32 v252, 11, v252
    v_and_b32 v251, 1, v0
    v_lshl_add_u32 v252, v251, 6, v252
    s_bfm_b64 exec, 28, 0
    buffer_load_dword v253, v252, s[96:99], s6 offen offset:384
    s_mov_b64 exec, -1
    s_add_u32 m0, s32, 16384
    s_nop 0
    buffer_load_dwordx4 v8, s[12:15], s34 offen lds
    s_add_u32 m0, s32, 20480
    s_nop 0
    buffer_load_dwordx4 v9, s[12:15], s34 offen lds
    s_add_u32 s34, s34, 131072
    s_add_u32 m0, s32, 40960
    s_nop 0
    buffer_load_dwordx4 v8, s[12:15], s34 offen lds
    s_add_u32 m0, s32, 45056
    s_nop 0
    buffer_load_dwordx4 v9, s[12:15], s34 offen lds
    s_add_u32 s34, s34, 131072
    s_add_u32 m0, s32, 65536
    s_nop 0
    buffer_load_dwordx4 v8, s[12:15], s34 offen lds
    s_add_u32 m0, s32, 69632
    s_nop 0
    buffer_load_dwordx4 v9, s[12:15], s34 offen lds
    s_add_u32 s34, s34, 131072
    s_add_u32 m0, s32, 90112
    s_nop 0
    buffer_load_dwordx4 v8, s[12:15], s34 offen lds
    s_add_u32 m0, s32, 94208
    s_nop 0
    buffer_load_dwordx4 v9, s[12:15], s34 offen lds
    s_add_u32 s34, s34, 131072
    s_add_u32 m0, s32, 114688
    s_nop 0
    buffer_load_dwordx4 v8, s[12:15], s34 offen lds
    s_add_u32 m0, s32, 118784
    s_nop 0
    buffer_load_dwordx4 v9, s[12:15], s34 offen lds
    s_add_u32 s34, s34, 131072
    s_lshl_b32 s6, s4, 9
    s_add_u32 s6, s6, 40960
L_poll42:
    buffer_load_dword v16, v17, s[60:63], s6 offen sc1
    s_sub_u32 s37, s37, 1
    s_cselect_b32 s37, 0, s37
    s_cbranch_scc1 L_poll42x
    s_waitcnt vmcnt(0)
    v_cmp_eq_u32 vcc, 1, v16
    s_cmp_eq_u64 vcc, -1
    s_cbranch_scc1 L_poll42x
    s_sleep 1
    s_branch L_poll42
L_poll42x:
    ds_write_b32 v254, v254 offset:44
    s_branch L_oth41x
L_oth41:
L_spin45:
    ds_read_b32 v16, v254 offset:40
    s_sub_u32 s37, s37, 1
    s_cselect_b32 s37, 0, s37
    s_cbranch_scc1 L_spin45x
    s_waitcnt lgkmcnt(0)
    v_readfirstlane_b32 s6, v16
    s_cmp_ge_u32 s6, 5
    s_cbranch_scc1 L_spin45x
    s_sleep 1
    s_branch L_spin45
L_spin45x:
    s_waitcnt lgkmcnt(0)
    s_add_u32 s96, s78, 0
    s_addc_u32 s97, s79, 0
    s_mov_b32 s98, 3670016
    s_mov_b32 s99, 0x20000
    s_and_b32 s6, s5, 7
    s_lshl_b32 s6, s6, 2
    s_and_b32 s7, s4, 3
    s_add_u32 s6, s6, s7
    s_lshl_b32 s6, s6, 2
    s_add_u32 s6, s6, s29
    s_mul_i32 s6, s6, 28672
    s_and_b32 s7, s5, 8
    s_lshl_b32 s7, s7, 7
    s_add_u32 s6, s6, s7
    v_lshrrev_b32 v252, 1, v0
    v_lshlrev_b32 v252, 11, v252
    v_and_b32 v251, 1, v0
    v_lshl_add_u32 v252, v251, 6, v252
    s_bfm_b64 exec, 28, 0
    buffer_load_dword v253, v252, s[96:99], s6 offen offset:384
    s_mov_b64 exec, -1
    s_add_u32 m0, s32, 16384
    s_nop 0
    buffer_load_dwordx4 v8, s[12:15], s34 offen lds
    s_add_u32 m0, s32, 20480
    s_nop 0
    buffer_load_dwordx4 v9, s[12:15], s34 offen lds
    s_add_u32 s34, s34, 131072
    s_add_u32 m0, s32, 40960
    s_nop 0
    buffer_load_dwordx4 v8, s[12:15], s34 offen lds
    s_add_u32 m0, s32, 45056
    s_nop 0
    buffer_load_dwordx4 v9, s[12:15], s34 offen lds
    s_add_u32 s34, s34, 131072
    s_add_u32 m0, s32, 65536
    s_nop 0
    buffer_load_dwordx4 v8, s[12:15], s34 offen lds
    s_add_u32 m0, s32, 69632
    s_nop 0
    buffer_load_dwordx4 v9, s[12:15], s34 offen lds
    s_add_u32 s34, s34, 131072
    s_add_u32 m0, s32, 90112
    s_nop 0
    buffer_load_dwordx4 v8, s[12:15], s34 offen lds
    s_add_u32 m0, s32, 94208
    s_nop 0
    buffer_load_dwordx4 v9, s[12:15], s34 offen lds
    s_add_u32 s34, s34, 131072
    s_add_u32 m0, s32, 114688
    s_nop 0
    buffer_load_dwordx4 v8, s[12:15], s34 offen lds
    s_add_u32 m0, s32, 118784
    s_nop 0
    buffer_load_dwordx4 v9, s[12:15], s34 offen lds
    s_add_u32 s34, s34, 131072
L_spin46:
    ds_read_b32 v16, v254 offset:44
    s_sub_u32 s37, s37, 1
    s_cselect_b32 s37, 0, s37
    s_cbranch_scc1 L_spin46x
    s_waitcnt lgkmcnt(0)
    v_readfirstlane_b32 s6, v16
    s_cmp_ge_u32 s6, 1
    s_cbranch_scc1 L_spin46x
    s_sleep 1
    s_branch L_spin46
L_spin46x:
    s_waitcnt lgkmcnt(0)
L_oth41x:
    s_add_u32 m0, s32, 0
    s_nop 0
    buffer_load_dwordx4 v4, s[8:11], s33 offen sc1 lds
    s_add_u32 m0, s32, 4096
    s_nop 0
    buffer_load_dwordx4 v5, s[8:11], s33 offen sc1 lds
    s_add_u32 m0, s32, 8192
    s_nop 0
    buffer_load_dwordx4 v6, s[8:11], s33 offen sc1 lds
    s_add_u32 m0, s32, 12288
    s_nop 0
    buffer_load_dwordx4 v7, s[8:11], s33 offen sc1 lds
    s_add_u32 s33, s33, 16384
    s_add_u32 m0, s32, 24576
    s_nop 0
    buffer_load_dwordx4 v4, s[8:11], s33 offen sc1 lds
    s_add_u32 m0, s32, 28672
    s_nop 0
    buffer_load_dwordx4 v5, s[8:11], s33 offen sc1 lds
    s_add_u32 m0, s32, 32768
    s_nop 0
    buffer_load_dwordx4 v6, s[8:11], s33 offen sc1 lds
    s_add_u32 m0, s32, 36864
    s_nop 0
    buffer_load_dwordx4 v7, s[8:11], s33 offen sc1 lds
    s_add_u32 s33, s33, 16384
    s_add_u32 m0, s32, 49152
    s_nop 0
    buffer_load_dwordx4 v4, s[8:11], s33 offen sc1 lds
    s_add_u32 m0, s32, 53248
    s_nop 0
    buffer_load_dwordx4 v5, s[8:11], s33 offen sc1 lds
    s_add_u32 m0, s32, 57344
    s_nop 0
    buffer_load_dwordx4 v6, s[8:11], s33 offen sc1 lds
    s_add_u32 m0, s32, 61440
    s_nop 0
    buffer_load_dwordx4 v7, s[8:11], s33 offen sc1 lds
    s_add_u32 s33, s33, 16384
    s_add_u32 m0, s32, 73728
    s_nop 0
    buffer_load_dwordx4 v4, s[8:11], s33 offen sc1 lds
    s_add_u32 m0, s32, 77824
    s_nop 0
    buffer_load_dwordx4 v5, s[8:11], s33 offen sc1 lds
    s_add_u32 m0, s32, 81920
    s_nop 0
    buffer_load_dwordx4 v6, s[8:11], s33 offen sc1 lds
    s_add_u32 m0, s32, 86016
    s_nop 0
    buffer_load_dwordx4 v7, s[8:11], s33 offen sc1 lds
    s_add_u32 s33, s33, 16384
    s_add_u32 m0, s32, 98304
    s_nop 0
    buffer_load_dwordx4 v4, s[8:11], s33 offen sc1 lds
    s_add_u32 m0, s32, 102400
    s_nop 0
    buffer_load_dwordx4 v5, s[8:11], s33 offen sc1 lds
    s_add_u32 m0, s32, 106496
    s_nop 0
    buffer_load_dwordx4 v6, s[8:11], s33 offen sc1 lds
    s_add_u32 m0, s32, 110592
    s_nop 0
    buffer_load_dwordx4 v7, s[8:11], s33 offen sc1 lds
    s_add_u32 s33, s33, 16384
    s_add_u32 s32, s32, 122880
    s_waitcnt vmcnt(16)
    s_barrier
    s_add_u32 m0, s32, 0
    s_nop 0
    buffer_load_dwordx4 v4, s[8:11], s33 offen sc1 lds
    s_add_u32 m0, s32, 4096
    s_nop 0
    buffer_load_dwordx4 v5, s[8:11], s33 offen sc1 lds
    s_add_u32 m0, s32, 8192
    s_nop 0
    buffer_load_dwordx4 v6, s[8:11], s33 offen sc1 lds
    s_add_u32 m0, s32, 12288
    s_nop 0
    buffer_load_dwordx4 v7, s[8:11], s33 offen sc1 lds
    s_add_u32 s33, s33, 16384
    s_add_u32 m0, s32, 16384
    s_nop 0
    buffer_load_dwordx4 v8, s[12:15], s34 offen lds
    s_add_u32 m0, s32, 20480
    s_nop 0
    buffer_load_dwordx4 v9, s[12:15], s34 offen lds
    s_add_u32 s34, s34, 131072
    s_add_u32 s32, s32, 24576
    s_cmp_ge_u32 s32, s35
    s_cselect_b32 s6, 147456, 0
    s_sub_u32 s32, s32, s6
    s_waitcnt vmcnt(18)
    s_barrier
    s_add_u32 m0, s32, 0
    s_nop 0
    buffer_load_dwordx4 v4, s[8:11], s33 offen sc1 lds
    s_add_u32 m0, s32, 4096
    s_nop 0
    buffer_load_dwordx4 v5, s[8:11], s33 offen sc1 lds
    s_add_u32 m0, s32, 8192
    s_nop 0
    buffer_load_dwordx4 v6, s[8:11], s33 offen sc1 lds
    s_add_u32 m0, s32, 12288
    s_nop 0
    buffer_load_dwordx4 v7, s[8:11], s33 offen sc1 lds
    s_add_u32 s33, s33, 16384
    s_add_u32 m0, s32, 16384
    s_nop 0
    buffer_load_dwordx4 v8, s[12:15], s34 offen lds
    s_add_u32 m0, s32, 20480
    s_nop 0
    buffer_load_dwordx4 v9, s[12:15], s34 offen lds
    s_add_u32 s34, s34, 131072
    s_add_u32 s32, s32, 24576
    s_cmp_ge_u32 s32, s35
    s_cselect_b32 s6, 147456, 0
    s_sub_u32 s32, s32, s6
    s_waitcnt vmcnt(20)
    s_barrier
    s_add_u32 m0, s32, 0
    s_nop 0
    buffer_load_dwordx4 v4, s[8:11], s33 offen sc1 lds
    s_add_u32 m0, s32, 4096
    s_nop 0
    buffer_load_dwordx4 v5, s[8:11], s33 offen sc1 lds
    s_add_u32 m0, s32, 8192
    s_nop 0
    buffer_load_dwordx4 v6, s[8:11], s33 offen sc1 lds
    s_add_u32 m0, s32, 12288
    s_nop 0
    buffer_load_dwordx4 v7, s[8:11], s33 offen sc1 lds
    s_add_u32 s33, s33, 16384
    s_add_u32 m0, s32, 16384
    s_nop 0
    buffer_load_dwordx4 v8, s[12:15], s34 offen lds
    s_add_u32 m0, s32, 20480
    s_nop 0
    buffer_load_dwordx4 v9, s[12:15], s34 offen lds
    s_add_u32 s34, s34, 131072
    s_add_u32 s32, s32, 24576
    s_cmp_ge_u32 s32, s35
    s_cselect_b32 s6, 147456, 0
    s_sub_u32 s32, s32, s6
    s_waitcnt vmcnt(22)
    s_barrier
    s_add_u32 m0, s32, 0
    s_nop 0
    buffer_load_dwordx4 v4, s[8:11], s33 offen sc1 lds
    s_add_u32 m0, s32, 4096
    s_nop 0
    buffer_load_dwordx4 v5, s[8:11], s33 offen sc1 lds
    s_add_u32 m0, s32, 8192
    s_nop 0
    buffer_load_dwordx4 v6, s[8:11], s33 offen sc1 lds
    s_add_u32 m0, s32, 12288
    s_nop 0
    buffer_load_dwordx4 v7, s[8:11], s33 offen sc1 lds
    s_add_u32 s33, s33, 16384
    s_add_u32 m0, s32, 16384
    s_nop 0
    buffer_load_dwordx4 v8, s[12:15], s34 offen lds
    s_add_u32 m0, s32, 20480
    s_nop 0
    buffer_load_dwordx4 v9, s[12:15], s34 offen lds
    s_add_u32 s34, s34, 131072
    s_add_u32 s32, s32, 24576
    s_cmp_ge_u32 s32, s35
    s_cselect_b32 s6, 147456, 0
    s_sub_u32 s32, s32, s6
    s_mov_b32 s36, 19
L_flpa:
    s_waitcnt vmcnt(24)
    s_barrier
    s_add_u32 m0, s32, 0
    s_nop 0
    buffer_load_dwordx4 v4, s[8:11], s33 offen sc1 lds
    s_add_u32 m0, s32, 4096
    s_nop 0
    buffer_load_dwordx4 v5, s[8:11], s33 offen sc1 lds
    s_add_u32 m0, s32, 8192
    s_nop 0
    buffer_load_dwordx4 v6, s[8:11], s33 offen sc1 lds
    s_add_u32 m0, s32, 12288
    s_nop 0
    buffer_load_dwordx4 v7, s[8:11], s33 offen sc1 lds
    s_add_u32 s33, s33, 16384
    s_add_u32 m0, s32, 16384
    s_nop 0
    buffer_load_dwordx4 v8, s[12:15], s34 offen lds
    s_add_u32 m0, s32, 20480
    s_nop 0
    buffer_load_dwordx4 v9, s[12:15], s34 offen lds
    s_add_u32 s34, s34, 131072
    s_add_u32 s32, s32, 24576
    s_cmp_ge_u32 s32, s35
    s_cselect_b32 s6, 147456, 0
    s_sub_u32 s32, s32, s6
    s_sub_u32 s36, s36, 1
    s_cmp_lg_u32 s36, 0
    s_cbranch_scc1 L_flpa
    s_waitcnt vmcnt(24)
    s_barrier
    s_waitcnt vmcnt(18)
    s_barrier
    s_waitcnt vmcnt(12)
    s_barrier
    s_waitcnt vmcnt(6)
    s_barrier
    s_waitcnt vmcnt(0)
    s_barrier
L_fldx:
    s_barrier
    s_endpgm
L_cc:
    s_add_u32 s8, s84, 25165824
    s_addc_u32 s9, s85, 0
    s_mov_b32 s10, 7340032
    s_mov_b32 s11, 0x20000
    s_add_u32 s12, s84, 59244544
    s_addc_u32 s13, s85, 0
    s_mov_b32 s14, 229376
    s_mov_b32 s15, 0x20000
    v_lshrrev_b32 v5, 2, v1
    v_lshl_add_u32 v5, v2, 3, v5
    v_mul_u32_u24 v5, 448, v5
    v_and_b32 v6, 3, v0
    v_lshl_add_u32 v5, v6, 3, v5
    v_and_b32 v6, 1, v2
    v_xor_b32 v6, s3, v6
    v_lshl_add_u32 v5, v6, 5, v5
    v_add_u32 v5, 122880, v5
    ds_read_b64_tr_b16 v[128:129], v5 offset:0
    ds_read_b64_tr_b16 v[130:131], v5 offset:1792
    ds_read_b64_tr_b16 v[132:133], v5 offset:14336
    ds_read_b64_tr_b16 v[134:135], v5 offset:16128
    ds_read_b64_tr_b16 v[136:137], v5 offset:128
    ds_read_b64_tr_b16 v[138:139], v5 offset:1920
    ds_read_b64_tr_b16 v[140:141], v5 offset:14464
    ds_read_b64_tr_b16 v[142:143], v5 offset:16256
    ds_read_b64_tr_b16 v[144:145], v5 offset:256
    ds_read_b64_tr_b16 v[146:147], v5 offset:2048
    ds_read_b64_tr_b16 v[148:149], v5 offset:14592
    ds_read_b64_tr_b16 v[150:151], v5 offset:16384
    ds_read_b64_tr_b16 v[152:153], v5 offset:384
    ds_read_b64_tr_b16 v[154:155], v5 offset:2176
    ds_read_b64_tr_b16 v[156:157], v5 offset:14720
    ds_read_b64_tr_b16 v[158:159], v5 offset:16512
    s_lshl_b32 s6, s5, 4
    s_add_u32 s6, s6, s4
    s_mul_i32 s6, s6, 28672
    s_lshl_b32 s7, s3, 10
    s_add_u32 s26, s6, s7
    s_lshl_b32 s7, s4, 4
    s_add_u32 s7, s7, s5
    s_mul_i32 s7, s7, 896
    s_lshl_b32 s27, s3, 6
    s_add_u32 s27, s7, s27
    v_lshlrev_b32 v176, 4, v0
    v_add_u32 v177, 14336, v176
    v_lshlrev_b32 v178, 2, v1
    s_waitcnt lgkmcnt(0)
    v_mfma_f32_16x16x32_bf16 v[160:163], v[248:251], v[128:131], 0
    v_mfma_f32_16x16x32_bf16 v[160:163], v[248:251], v[132:135], v[160:163]
    v_mfma_f32_16x16x32_bf16 v[164:167], v[248:251], v[136:139], 0
    v_mfma_f32_16x16x32_bf16 v[164:167], v[248:251], v[140:143], v[164:167]
    v_mfma_f32_16x16x32_bf16 v[168:171], v[248:251], v[144:147], 0
    v_mfma_f32_16x16x32_bf16 v[168:171], v[248:251], v[148:151], v[168:171]
    v_mfma_f32_16x16x32_bf16 v[172:175], v[248:251], v[152:155], 0
    v_mfma_f32_16x16x32_bf16 v[172:175], v[248:251], v[156:159], v[172:175]
    s_add_u32 s16, s64, 0
    s_addc_u32 s17, s65, 0
    s_mov_b32 s18, 4194304
    s_mov_b32 s19, 0x20000
    s_add_u32 s40, s84, 20971520
    s_addc_u32 s41, s85, 0
    s_mov_b32 s42, 4194304
    s_mov_b32 s43, 0x20000
    s_add_u32 s44, s84, 59768832
    s_addc_u32 s45, s85, 0
    s_mov_b32 s46, 32768
    s_mov_b32 s47, 0x20000
    v_and_b32 v13, 1, v2
    v_lshlrev_b32 v13, 5, v13
    v_lshrrev_b32 v3, 1, v2
    v_lshl_add_u32 v13, v3, 4, v13
    v_lshl_add_u32 v13, v1, 11, v13
    v_add_u32 v14, 32768, v13
    s_lshl_b32 s38, s4, 18
    s_lshl_b32 s6, s3, 16
    s_add_u32 s38, s38, s6
    s_lshl_b32 s6, s5, 7
    s_add_u32 s38, s38, s6
    s_lshl_b32 s50, s4, 18
    s_lshl_b32 s6, s5, 14
    s_add_u32 s50, s50, s6
    s_lshl_b32 s6, s3, 11
    s_add_u32 s50, s50, s6
    s_add_u32 s51, s50, 8192
    v_and_b32 v15, 1, v2
    v_lshlrev_b32 v15, 5, v15
    v_lshrrev_b32 v3, 1, v2
    v_lshl_add_u32 v15, v3, 4, v15
    v_lshlrev_b32 v15, 4, v15
    v_lshl_add_u32 v15, v1, 4, v15
    buffer_load_dwordx4 v[96:99], v13, s[16:19], s38 offen offset:0
    buffer_load_dwordx4 v[100:103], v13, s[16:19], s38 offen offset:64
    buffer_load_dwordx4 v[104:107], v14, s[16:19], s38 offen offset:0
    buffer_load_dwordx4 v[108:111], v14, s[16:19], s38 offen offset:64
    s_and_b32 s31, s3, 0
    s_lshr_b32 s30, s3, 0
    v_lshrrev_b32 v3, 1, v1
    v_xor_b32 v3, v3, v2
    v_lshlrev_b32 v3, 4, v3
    v_lshl_add_u32 v3, v1, 7, v3
    s_mul_i32 s6, s30, 4096
    v_add_u32 v4, s6, v3
    v_xor_b32 v5, 64, v4
    s_mul_i32 s6, s30, 2048
    v_lshl_add_u32 v4, v0, 4, s6
    v_add_u32 v5, 8192, v4
    v_lshrrev_b32 v10, 2, v1
    v_lshl_add_u32 v11, v2, 3, v10
    v_mul_u32_u24 v11, 128, v11
    v_and_b32 v12, 3, v0
    v_lshl_add_u32 v11, v12, 3, v11
    v_add_u32 v11, 16384, v11
    v_and_b32 v12, 1, v2
    v_lshrrev_b32 v10, 1, v10
    v_lshl_add_u32 v12, v12, 1, v10
    s_mul_i32 s6, s31, 4
    s_add_u32 s6, s6, 0
    v_xor_b32 v10, s6, v12
    v_lshl_add_u32 v6, v10, 5, v11
    s_mul_i32 s6, s31, 4
    s_add_u32 s6, s6, 1
    v_xor_b32 v10, s6, v12
    v_lshl_add_u32 v7, v10, 5, v11
    s_mul_i32 s6, s31, 4
    s_add_u32 s6, s6, 2
    v_xor_b32 v10, s6, v12
    v_lshl_add_u32 v8, v10, 5, v11
    s_mul_i32 s6, s31, 4
    s_add_u32 s6, s6, 3
    v_xor_b32 v10, s6, v12
    v_lshl_add_u32 v9, v10, 5, v11
    v_mov_b32 v16, 0
    v_mov_b32 v17, 0
    v_mov_b32 v18, 0
    v_mov_b32 v19, 0
    v_mov_b32 v20, 0
    v_mov_b32 v21, 0
    v_mov_b32 v22, 0
    v_mov_b32 v23, 0
    v_mov_b32 v24, 0
    v_mov_b32 v25, 0
    v_mov_b32 v26, 0
    v_mov_b32 v27, 0
    v_mov_b32 v28, 0
    v_mov_b32 v29, 0
    v_mov_b32 v30, 0
    v_mov_b32 v31, 0
    v_mov_b32 v32, 0
    v_mov_b32 v33, 0
    v_mov_b32 v34, 0
    v_mov_b32 v35, 0
    v_mov_b32 v36, 0
    v_mov_b32 v37, 0
    v_mov_b32 v38, 0
    v_mov_b32 v39, 0
    v_mov_b32 v40, 0
    v_mov_b32 v41, 0
    v_mov_b32 v42, 0
    v_mov_b32 v43, 0
    v_mov_b32 v44, 0
    v_mov_b32 v45, 0
    v_mov_b32 v46, 0
    v_mov_b32 v47, 0
    s_mov_b32 s32, 0
    s_nop 4
L_spin47:
    ds_read_b32 v179, v254 offset:8
    s_sub_u32 s37, s37, 1
    s_cselect_b32 s37, 0, s37
    s_cbranch_scc1 L_spin47x
    s_waitcnt lgkmcnt(0)
    v_readfirstlane_b32 s6, v179
    s_cmp_ge_u32 s6, 9
    s_cbranch_scc1 L_spin47x
    s_sleep 1
    s_branch L_spin47
L_spin47x:
    s_waitcnt lgkmcnt(0)
    buffer_store_dwordx4 v[128:131], v176, s[8:11], s26 offen sc1
    buffer_store_dwordx4 v[132:135], v177, s[8:11], s26 offen sc1
    s_add_u32 s26, s26, 4096
    s_mov_b64 exec, 0xffff
    buffer_store_dword v160, v178, s[12:15], s27 offen offset:0 sc1
    s_mov_b64 exec, -1
    buffer_store_dwordx4 v[136:139], v176, s[8:11], s26 offen sc1
    buffer_store_dwordx4 v[140:143], v177, s[8:11], s26 offen sc1
    s_add_u32 s26, s26, 4096
    s_mov_b64 exec, 0xffff
    buffer_store_dword v164, v178, s[12:15], s27 offen offset:256 sc1
    s_mov_b64 exec, -1
    buffer_store_dwordx4 v[144:147], v176, s[8:11], s26 offen sc1
    buffer_store_dwordx4 v[148:151], v177, s[8:11], s26 offen sc1
    s_add_u32 s26, s26, 4096
    s_mov_b64 exec, 0xffff
    buffer_store_dword v168, v178, s[12:15], s27 offen offset:512 sc1
    s_mov_b64 exec, -1
    s_cmp_ge_u32 s3, 2
    s_cbranch_scc1 L_rp
    buffer_store_dwordx4 v[152:155], v176, s[8:11], s26 offen sc1
    buffer_store_dwordx4 v[156:159], v177, s[8:11], s26 offen sc1
    s_add_u32 s26, s26, 4096
    s_mov_b64 exec, 0xffff
    buffer_store_dword v172, v178, s[12:15], s27 offen offset:768 sc1
    s_mov_b64 exec, -1
L_rp:
    s_barrier
    ds_read_b128 v[48:51], v4 offset:0
    ds_read_b128 v[52:55], v4 offset:1024
    ds_read_b64_tr_b16 v[56:57], v6 offset:0
    ds_read_b64_tr_b16 v[58:59], v6 offset:512
    ds_read_b64_tr_b16 v[60:61], v7 offset:0
    ds_read_b64_tr_b16 v[62:63], v7 offset:512
    ds_read_b64_tr_b16 v[64:65], v8 offset:0
    ds_read_b64_tr_b16 v[66:67], v8 offset:512
    ds_read_b64_tr_b16 v[68:69], v9 offset:0
    ds_read_b64_tr_b16 v[70:71], v9 offset:512
    s_mov_b32 s36, 16
    s_branch L_cmid
    .p2align 4
L_cloop:
    s_barrier
    v_mfma_f32_16x16x32_bf16 v[16:19], v[80:83], v[72:75], v[16:19]
    ds_read_b128 v[48:51], v4 offset:0
    ds_read_b128 v[52:55], v4 offset:1024
    ds_read_b64_tr_b16 v[56:57], v6 offset:0
    v_mfma_f32_16x16x32_bf16 v[32:35], v[80:83], v[76:79], v[32:35]
    ds_read_b64_tr_b16 v[58:59], v6 offset:512
    ds_read_b64_tr_b16 v[60:61], v7 offset:0
    ds_read_b64_tr_b16 v[62:63], v7 offset:512
    v_mfma_f32_16x16x32_bf16 v[20:23], v[84:87], v[72:75], v[20:23]
    ds_read_b64_tr_b16 v[64:65], v8 offset:0
    ds_read_b64_tr_b16 v[66:67], v8 offset:512
    ds_read_b64_tr_b16 v[68:69], v9 offset:0
    v_mfma_f32_16x16x32_bf16 v[36:39], v[84:87], v[76:79], v[36:39]
    ds_read_b64_tr_b16 v[70:71], v9 offset:512
    v_mfma_f32_16x16x32_bf16 v[24:27], v[88:91], v[72:75], v[24:27]
    s_cmp_lg_u32 s36, 9
    s_cbranch_scc1 L_nc
    s_waitcnt vmcnt(0)
L_nc:
    v_mfma_f32_16x16x32_bf16 v[40:43], v[88:91], v[76:79], v[40:43]
    v_mfma_f32_16x16x32_bf16 v[28:31], v[92:95], v[72:75], v[28:31]
    v_mfma_f32_16x16x32_bf16 v[44:47], v[92:95], v[76:79], v[44:47]
L_cmid:
    s_waitcnt lgkmcnt(0)
    v_mfma_f32_16x16x32_bf16 v[16:19], v[56:59], v[48:51], v[16:19]
    ds_read_b128 v[72:75], v5 offset:0
    ds_read_b128 v[76:79], v5 offset:1024
    ds_read_b64_tr_b16 v[80:81], v6 offset:4096
    v_mfma_f32_16x16x32_bf16 v[32:35], v[56:59], v[52:55], v[32:35]
    ds_read_b64_tr_b16 v[82:83], v6 offset:4608
    ds_read_b64_tr_b16 v[84:85], v7 offset:4096
    ds_read_b64_tr_b16 v[86:87], v7 offset:4608
    v_mfma_f32_16x16x32_bf16 v[20:23], v[60:63], v[48:51], v[20:23]
    ds_read_b64_tr_b16 v[88:89], v8 offset:4096
    ds_read_b64_tr_b16 v[90:91], v8 offset:4608
    ds_read_b64_tr_b16 v[92:93], v9 offset:4096
    v_mfma_f32_16x16x32_bf16 v[36:39], v[60:63], v[52:55], v[36:39]
    ds_read_b64_tr_b16 v[94:95], v9 offset:4608
    v_mfma_f32_16x16x32_bf16 v[24:27], v[64:67], v[48:51], v[24:27]
    s_add_u32 s32, s32, 1
    s_cmp_eq_u32 s32, 6
    v_mfma_f32_16x16x32_bf16 v[40:43], v[64:67], v[52:55], v[40:43]
    s_mov_b32 s6, 24576
    s_cselect_b32 s6, -122880, s6
    v_mfma_f32_16x16x32_bf16 v[28:31], v[68:71], v[48:51], v[28:31]
    s_cselect_b32 s32, 0, s32
    v_add_u32 v4, s6, v4
    v_mfma_f32_16x16x32_bf16 v[44:47], v[68:71], v[52:55], v[44:47]
    v_add_u32 v5, s6, v5
    v_add_u32 v6, s6, v6
    v_add_u32 v7, s6, v7
    v_add_u32 v8, s6, v8
    v_add_u32 v9, s6, v9
    s_sub_u32 s36, s36, 1
    s_cmp_lg_u32 s36, 0
    s_waitcnt lgkmcnt(0)
    s_cbranch_scc1 L_cloop
    s_barrier
    v_mfma_f32_16x16x32_bf16 v[16:19], v[80:83], v[72:75], v[16:19]
    v_mfma_f32_16x16x32_bf16 v[32:35], v[80:83], v[76:79], v[32:35]
    v_mfma_f32_16x16x32_bf16 v[20:23], v[84:87], v[72:75], v[20:23]
    v_mfma_f32_16x16x32_bf16 v[36:39], v[84:87], v[76:79], v[36:39]
    v_mfma_f32_16x16x32_bf16 v[24:27], v[88:91], v[72:75], v[24:27]
    v_mfma_f32_16x16x32_bf16 v[40:43], v[88:91], v[76:79], v[40:43]
    v_mfma_f32_16x16x32_bf16 v[28:31], v[92:95], v[72:75], v[28:31]
    v_mfma_f32_16x16x32_bf16 v[44:47], v[92:95], v[76:79], v[44:47]
    s_nop 7
    s_waitcnt vmcnt(0)
    v_permlane16_swap_b32 v96, v98
    v_permlane16_swap_b32 v97, v99
    v_lshlrev_b32 v48, 16, v96
    v_and_b32 v49, 0xffff0000, v96
    v_lshlrev_b32 v50, 16, v97
    v_and_b32 v51, 0xffff0000, v97
    v_lshlrev_b32 v52, 16, v98
    v_and_b32 v53, 0xffff0000, v98
    v_lshlrev_b32 v54, 16, v99
    v_and_b32 v55, 0xffff0000, v99
    v_pk_add_f32 v[16:17], v[16:17], v[48:49]
    v_pk_add_f32 v[18:19], v[18:19], v[50:51]
    v_pk_add_f32 v[20:21], v[20:21], v[52:53]
    v_pk_add_f32 v[22:23], v[22:23], v[54:55]
    v_cvt_pk_bf16_f32 v72, v16, v17
    v_cvt_pk_bf16_f32 v73, v18, v19
    v_cvt_pk_bf16_f32 v74, v20, v21
    v_cvt_pk_bf16_f32 v75, v22, v23
    s_nop 1
    v_permlane16_swap_b32 v72, v74
    v_permlane16_swap_b32 v73, v75
    buffer_store_dwordx4 v[72:75], v15, s[40:43], s50 offen offset:0 sc1
    v_permlane16_swap_b32 v100, v102
    v_permlane16_swap_b32 v101, v103
    v_lshlrev_b32 v48, 16, v100
    v_and_b32 v49, 0xffff0000, v100
    v_lshlrev_b32 v50, 16, v101
    v_and_b32 v51, 0xffff0000, v101
    v_lshlrev_b32 v52, 16, v102
    v_and_b32 v53, 0xffff0000, v102
    v_lshlrev_b32 v54, 16, v103
    v_and_b32 v55, 0xffff0000, v103
    v_pk_add_f32 v[24:25], v[24:25], v[48:49]
    v_pk_add_f32 v[26:27], v[26:27], v[50:51]
    v_pk_add_f32 v[28:29], v[28:29], v[52:53]
    v_pk_add_f32 v[30:31], v[30:31], v[54:55]
    v_cvt_pk_bf16_f32 v76, v24, v25
    v_cvt_pk_bf16_f32 v77, v26, v27
    v_cvt_pk_bf16_f32 v78, v28, v29
    v_cvt_pk_bf16_f32 v79, v30, v31
    s_nop 1
    v_permlane16_swap_b32 v76, v78
    v_permlane16_swap_b32 v77, v79
    buffer_store_dwordx4 v[76:79], v15, s[40:43], s51 offen offset:0 sc1
    v_permlane16_swap_b32 v104, v106
    v_permlane16_swap_b32 v105, v107
    v_lshlrev_b32 v48, 16, v104
    v_and_b32 v49, 0xffff0000, v104
    v_lshlrev_b32 v50, 16, v105
    v_and_b32 v51, 0xffff0000, v105
    v_lshlrev_b32 v52, 16, v106
    v_and_b32 v53, 0xffff0000, v106
    v_lshlrev_b32 v54, 16, v107
    v_and_b32 v55, 0xffff0000, v107
    v_pk_add_f32 v[32:33], v[32:33], v[48:49]
    v_pk_add_f32 v[34:35], v[34:35], v[50:51]
    v_pk_add_f32 v[36:37], v[36:37], v[52:53]
    v_pk_add_f32 v[38:39], v[38:39], v[54:55]
    v_cvt_pk_bf16_f32 v80, v32, v33
    v_cvt_pk_bf16_f32 v81, v34, v35
    v_cvt_pk_bf16_f32 v82, v36, v37
    v_cvt_pk_bf16_f32 v83, v38, v39
    s_nop 1
    v_permlane16_swap_b32 v80, v82
    v_permlane16_swap_b32 v81, v83
    buffer_store_dwordx4 v[80:83], v15, s[40:43], s50 offen offset:1024 sc1
    v_permlane16_swap_b32 v108, v110
    v_permlane16_swap_b32 v109, v111
    v_lshlrev_b32 v48, 16, v108
    v_and_b32 v49, 0xffff0000, v108
    v_lshlrev_b32 v50, 16, v109
    v_and_b32 v51, 0xffff0000, v109
    v_lshlrev_b32 v52, 16, v110
    v_and_b32 v53, 0xffff0000, v110
    v_lshlrev_b32 v54, 16, v111
    v_and_b32 v55, 0xffff0000, v111
    v_pk_add_f32 v[40:41], v[40:41], v[48:49]
    v_pk_add_f32 v[42:43], v[42:43], v[50:51]
    v_pk_add_f32 v[44:45], v[44:45], v[52:53]
    v_pk_add_f32 v[46:47], v[46:47], v[54:55]
    v_cvt_pk_bf16_f32 v84, v40, v41
    v_cvt_pk_bf16_f32 v85, v42, v43
    v_cvt_pk_bf16_f32 v86, v44, v45
    v_cvt_pk_bf16_f32 v87, v46, v47
    s_nop 1
    v_permlane16_swap_b32 v84, v86
    v_permlane16_swap_b32 v85, v87
    buffer_store_dwordx4 v[84:87], v15, s[40:43], s51 offen offset:1024 sc1
    v_lshlrev_b32 v48, 16, v72
    v_and_b32 v49, 0xffff0000, v72
    v_lshlrev_b32 v50, 16, v73
    v_and_b32 v51, 0xffff0000, v73
    v_lshlrev_b32 v52, 16, v74
    v_and_b32 v53, 0xffff0000, v74
    v_lshlrev_b32 v54, 16, v75
    v_and_b32 v55, 0xffff0000, v75
    v_lshlrev_b32 v56, 16, v76
    v_and_b32 v57, 0xffff0000, v76
    v_lshlrev_b32 v58, 16, v77
    v_and_b32 v59, 0xffff0000, v77
    v_lshlrev_b32 v60, 16, v78
    v_and_b32 v61, 0xffff0000, v78
    v_lshlrev_b32 v62, 16, v79
    v_and_b32 v63, 0xffff0000, v79
    v_pk_mul_f32 v[64:65], v[48:49], v[48:49]
    v_pk_fma_f32 v[64:65], v[50:51], v[50:51], v[64:65]
    v_pk_add_f32 v[48:49], v[48:49], v[50:51]
    v_pk_fma_f32 v[64:65], v[52:53], v[52:53], v[64:65]
    v_pk_add_f32 v[48:49], v[48:49], v[52:53]
    v_pk_fma_f32 v[64:65], v[54:55], v[54:55], v[64:65]
    v_pk_add_f32 v[48:49], v[48:49], v[54:55]
    v_pk_fma_f32 v[64:65], v[56:57], v[56:57], v[64:65]
    v_pk_add_f32 v[48:49], v[48:49], v[56:57]
    v_pk_fma_f32 v[64:65], v[58:59], v[58:59], v[64:65]
    v_pk_add_f32 v[48:49], v[48:49], v[58:59]
    v_pk_fma_f32 v[64:65], v[60:61], v[60:61], v[64:65]
    v_pk_add_f32 v[48:49], v[48:49], v[60:61]
    v_pk_fma_f32 v[64:65], v[62:63], v[62:63], v[64:65]
    v_pk_add_f32 v[48:49], v[48:49], v[62:63]
    v_add_f32 v4, v48, v49
    v_add_f32 v6, v64, v65
    v_lshlrev_b32 v48, 16, v80
    v_and_b32 v49, 0xffff0000, v80
    v_lshlrev_b32 v50, 16, v81
    v_and_b32 v51, 0xffff0000, v81
    v_lshlrev_b32 v52, 16, v82
    v_and_b32 v53, 0xffff0000, v82
    v_lshlrev_b32 v54, 16, v83
    v_and_b32 v55, 0xffff0000, v83
    v_lshlrev_b32 v56, 16, v84
    v_and_b32 v57, 0xffff0000, v84
    v_lshlrev_b32 v58, 16, v85
    v_and_b32 v59, 0xffff0000, v85
    v_lshlrev_b32 v60, 16, v86
    v_and_b32 v61, 0xffff0000, v86
    v_lshlrev_b32 v62, 16, v87
    v_and_b32 v63, 0xffff0000, v87
    v_pk_mul_f32 v[64:65], v[48:49], v[48:49]
    v_pk_fma_f32 v[64:65], v[50:51], v[50:51], v[64:65]
    v_pk_add_f32 v[48:49], v[48:49], v[50:51]
    v_pk_fma_f32 v[64:65], v[52:53], v[52:53], v[64:65]
    v_pk_add_f32 v[48:49], v[48:49], v[52:53]
    v_pk_fma_f32 v[64:65], v[54:55], v[54:55], v[64:65]
    v_pk_add_f32 v[48:49], v[48:49], v[54:55]
    v_pk_fma_f32 v[64:65], v[56:57], v[56:57], v[64:65]
    v_pk_add_f32 v[48:49], v[48:49], v[56:57]
    v_pk_fma_f32 v[64:65], v[58:59], v[58:59], v[64:65]
    v_pk_add_f32 v[48:49], v[48:49], v[58:59]
    v_pk_fma_f32 v[64:65], v[60:61], v[60:61], v[64:65]
    v_pk_add_f32 v[48:49], v[48:49], v[60:61]
    v_pk_fma_f32 v[64:65], v[62:63], v[62:63], v[64:65]
    v_pk_add_f32 v[48:49], v[48:49], v[62:63]
    v_add_f32 v5, v48, v49
    v_add_f32 v7, v64, v65
    v_lshrrev_b32 v8, 5, v0
    v_lshl_add_u32 v8, v8, 4, v1
    v_permlane32_swap_b32 v4, v5
    v_permlane32_swap_b32 v6, v7
    v_add_f32 v4, v4, v5
    v_add_f32 v6, v6, v7
    v_and_b32 v9, 1, v2
    v_lshlrev_b32 v9, 2, v9
    v_permlane16_swap_b32 v4, v6
    v_lshl_add_u32 v8, v8, 3, v9
    v_add_f32 v4, v4, v6
    s_lshl_b32 s6, s4, 10
    s_lshl_b32 s7, s3, 8
    s_add_u32 s6, s6, s7
    buffer_atomic_add_f32 v4, v8, s[44:47], s6 offen
    v_mov_b32 v3, 1
    s_waitcnt vmcnt(0)
    s_mov_b64 exec, 1
    ds_add_u32 v254, v3 offset:16
    s_mov_b64 exec, -1
    s_add_u32 s16, s84, 33554432
    s_addc_u32 s17, s85, 0
    s_mov_b32 s18, 8388608
    s_mov_b32 s19, 0x20000
    s_and_b32 s31, s3, 1
    s_lshr_b32 s30, s3, 1
    v_lshrrev_b32 v3, 1, v1
    v_xor_b32 v3, v3, v2
    v_lshlrev_b32 v3, 4, v3
    v_lshl_add_u32 v3, v1, 7, v3
    s_mul_i32 s6, s30, 8192
    v_add_u32 v4, s6, v3
    v_xor_b32 v5, 64, v4
    s_mul_i32 s6, s30, 4096
    v_lshl_add_u32 v4, v0, 4, s6
    v_add_u32 v5, 8192, v4
    v_lshlrev_b32 v6, 4, v0
    s_mul_i32 s6, s31, 7168
    s_add_u32 s6, s6, 16384
    v_add_u32 v6, s6, v6
    v_mov_b32 v16, 0
    v_mov_b32 v17, 0
    v_mov_b32 v18, 0
    v_mov_b32 v19, 0
    v_mov_b32 v20, 0
    v_mov_b32 v21, 0
    v_mov_b32 v22, 0
    v_mov_b32 v23, 0
    v_mov_b32 v24, 0
    v_mov_b32 v25, 0
    v_mov_b32 v26, 0
    v_mov_b32 v27, 0
    v_mov_b32 v28, 0
    v_mov_b32 v29, 0
    v_mov_b32 v30, 0
    v_mov_b32 v31, 0
    v_mov_b32 v32, 0
    v_mov_b32 v33, 0
    v_mov_b32 v34, 0
    v_mov_b32 v35, 0
    v_mov_b32 v36, 0
    v_mov_b32 v37, 0
    v_mov_b32 v38, 0
    v_mov_b32 v39, 0
    v_mov_b32 v40, 0
    v_mov_b32 v41, 0
    v_mov_b32 v42, 0
    v_mov_b32 v43, 0
    v_mov_b32 v44, 0
    v_mov_b32 v45, 0
    v_mov_b32 v46, 0
    v_mov_b32 v47, 0
    v_mov_b32 v48, 0
    v_mov_b32 v49, 0
    v_mov_b32 v50, 0
    v_mov_b32 v51, 0
    v_mov_b32 v52, 0
    v_mov_b32 v53, 0
    v_mov_b32 v54, 0
    v_mov_b32 v55, 0
    v_mov_b32 v56, 0
    v_mov_b32 v57, 0
    v_mov_b32 v58, 0
    v_mov_b32 v59, 0
    v_mov_b32 v60, 0
    v_mov_b32 v61, 0
    v_mov_b32 v62, 0
    v_mov_b32 v63, 0
    v_mov_b32 v64, 0
    v_mov_b32 v65, 0
    v_mov_b32 v66, 0
    v_mov_b32 v67, 0
    v_mov_b32 v68, 0
    v_mov_b32 v69, 0
    v_mov_b32 v70, 0
    v_mov_b32 v71, 0
    v_mov_b32 v72, 0
    v_mov_b32 v73, 0
    v_mov_b32 v74, 0
    v_mov_b32 v75, 0
    v_mov_b32 v76, 0
    v_mov_b32 v77, 0
    v_mov_b32 v78, 0
    v_mov_b32 v79, 0
    v_mov_b32 v80, 0
    v_mov_b32 v81, 0
    v_mov_b32 v82, 0
    v_mov_b32 v83, 0
    v_mov_b32 v84, 0
    v_mov_b32 v85, 0
    v_mov_b32 v86, 0
    v_mov_b32 v87, 0
    v_mov_b32 v88, 0
    v_mov_b32 v89, 0
    v_mov_b32 v90, 0
    v_mov_b32 v91, 0
    v_mov_b32 v92, 0
    v_mov_b32 v93, 0
    v_mov_b32 v94, 0
    v_mov_b32 v95, 0
    v_mov_b32 v96, 0
    v_mov_b32 v97, 0
    v_mov_b32 v98, 0
    v_mov_b32 v99, 0
    v_mov_b32 v100, 0
    v_mov_b32 v101, 0
    v_mov_b32 v102, 0
    v_mov_b32 v103, 0
    v_mov_b32 v104, 0
    v_mov_b32 v105, 0
    v_mov_b32 v106, 0
    v_mov_b32 v107, 0
    v_mov_b32 v108, 0
    v_mov_b32 v109, 0
    v_mov_b32 v110, 0
    v_mov_b32 v111, 0
    v_mov_b32 v112, 0
    v_mov_b32 v113, 0
    v_mov_b32 v114, 0
    v_mov_b32 v115, 0
    v_mov_b32 v116, 0
    v_mov_b32 v117, 0
    v_mov_b32 v118, 0
    v_mov_b32 v119, 0
    v_mov_b32 v120, 0
    v_mov_b32 v121, 0
    v_mov_b32 v122, 0
    v_mov_b32 v123, 0
    v_mov_b32 v124, 0
    v_mov_b32 v125, 0
    v_mov_b32 v126, 0
    v_mov_b32 v127, 0
    s_mov_b32 s32, 0
    s_mov_b32 s48, 0xbdd2d3e8
    s_mov_b32 s49, s48
    s_cmp_eq_u32 s31, 1
    s_cbranch_scc1 L_d1
    s_barrier
    ds_read_b128 v[128:131], v4 offset:0
    ds_read_b128 v[132:135], v4 offset:1024
    ds_read_b128 v[136:139], v4 offset:2048
    ds_read_b128 v[140:143], v4 offset:3072
    ds_read_b128 v[144:147], v6 offset:0
    ds_read_b128 v[148:151], v6 offset:1024
    ds_read_b128 v[152:155], v6 offset:2048
    ds_read_b128 v[156:159], v6 offset:3072
    ds_read_b128 v[160:163], v6 offset:4096
    ds_read_b128 v[164:167], v6 offset:5120
    ds_read_b128 v[168:171], v6 offset:6144
    s_mov_b32 s36, 16
    s_branch L_dmida
    .p2align 4
L_dloopa:
    s_barrier
    v_mfma_f32_16x16x32_bf16 v[16:19], v[172:175], v[188:191], v[16:19]
    ds_read_b128 v[128:131], v4 offset:0
    v_mfma_f32_16x16x32_bf16 v[44:47], v[176:179], v[188:191], v[44:47]
    ds_read_b128 v[132:135], v4 offset:1024
    v_mfma_f32_16x16x32_bf16 v[72:75], v[180:183], v[188:191], v[72:75]
    ds_read_b128 v[136:139], v4 offset:2048
    v_mfma_f32_16x16x32_bf16 v[100:103], v[184:187], v[188:191], v[100:103]
    ds_read_b128 v[140:143], v4 offset:3072
    v_mfma_f32_16x16x32_bf16 v[20:23], v[172:175], v[192:195], v[20:23]
    ds_read_b128 v[144:147], v6 offset:0
    v_mfma_f32_16x16x32_bf16 v[48:51], v[176:179], v[192:195], v[48:51]
    ds_read_b128 v[148:151], v6 offset:1024
    v_mfma_f32_16x16x32_bf16 v[76:79], v[180:183], v[192:195], v[76:79]
    ds_read_b128 v[152:155], v6 offset:2048
    v_mfma_f32_16x16x32_bf16 v[104:107], v[184:187], v[192:195], v[104:107]
    ds_read_b128 v[156:159], v6 offset:3072
    v_mfma_f32_16x16x32_bf16 v[24:27], v[172:175], v[196:199], v[24:27]
    ds_read_b128 v[160:163], v6 offset:4096
    v_mfma_f32_16x16x32_bf16 v[52:55], v[176:179], v[196:199], v[52:55]
    ds_read_b128 v[164:167], v6 offset:5120
    v_mfma_f32_16x16x32_bf16 v[80:83], v[180:183], v[196:199], v[80:83]
    ds_read_b128 v[168:171], v6 offset:6144
    v_mfma_f32_16x16x32_bf16 v[108:111], v[184:187], v[196:199], v[108:111]
    v_mfma_f32_16x16x32_bf16 v[28:31], v[172:175], v[200:203], v[28:31]
    v_mfma_f32_16x16x32_bf16 v[56:59], v[176:179], v[200:203], v[56:59]
    v_mfma_f32_16x16x32_bf16 v[84:87], v[180:183], v[200:203], v[84:87]
    v_mfma_f32_16x16x32_bf16 v[112:115], v[184:187], v[200:203], v[112:115]
    v_mfma_f32_16x16x32_bf16 v[32:35], v[204:207], v[172:175], v[32:35]
    v_mfma_f32_16x16x32_bf16 v[60:63], v[204:207], v[176:179], v[60:63]
    v_mfma_f32_16x16x32_bf16 v[88:91], v[204:207], v[180:183], v[88:91]
    v_mfma_f32_16x16x32_bf16 v[116:119], v[204:207], v[184:187], v[116:119]
    v_mfma_f32_16x16x32_bf16 v[36:39], v[208:211], v[172:175], v[36:39]
    v_mfma_f32_16x16x32_bf16 v[64:67], v[208:211], v[176:179], v[64:67]
    v_mfma_f32_16x16x32_bf16 v[92:95], v[208:211], v[180:183], v[92:95]
    v_mfma_f32_16x16x32_bf16 v[120:123], v[208:211], v[184:187], v[120:123]
    v_mfma_f32_16x16x32_bf16 v[40:43], v[212:215], v[172:175], v[40:43]
    v_mfma_f32_16x16x32_bf16 v[68:71], v[212:215], v[176:179], v[68:71]
    v_mfma_f32_16x16x32_bf16 v[96:99], v[212:215], v[180:183], v[96:99]
    v_mfma_f32_16x16x32_bf16 v[124:127], v[212:215], v[184:187], v[124:127]
L_dmida:
    s_waitcnt lgkmcnt(0)
    v_mfma_f32_16x16x32_bf16 v[16:19], v[128:131], v[144:147], v[16:19]
    ds_read_b128 v[172:175], v5 offset:0
    v_mfma_f32_16x16x32_bf16 v[44:47], v[132:135], v[144:147], v[44:47]
    ds_read_b128 v[176:179], v5 offset:1024
    v_mfma_f32_16x16x32_bf16 v[72:75], v[136:139], v[144:147], v[72:75]
    ds_read_b128 v[180:183], v5 offset:2048
    v_mfma_f32_16x16x32_bf16 v[100:103], v[140:143], v[144:147], v[100:103]
    ds_read_b128 v[184:187], v5 offset:3072
    v_mfma_f32_16x16x32_bf16 v[20:23], v[128:131], v[148:151], v[20:23]
    ds_read_b128 v[188:191], v6 offset:14336
    v_mfma_f32_16x16x32_bf16 v[48:51], v[132:135], v[148:151], v[48:51]
    ds_read_b128 v[192:195], v6 offset:15360
    v_mfma_f32_16x16x32_bf16 v[76:79], v[136:139], v[148:151], v[76:79]
    ds_read_b128 v[196:199], v6 offset:16384
    v_mfma_f32_16x16x32_bf16 v[104:107], v[140:143], v[148:151], v[104:107]
    ds_read_b128 v[200:203], v6 offset:17408
    v_mfma_f32_16x16x32_bf16 v[24:27], v[128:131], v[152:155], v[24:27]
    ds_read_b128 v[204:207], v6 offset:18432
    v_mfma_f32_16x16x32_bf16 v[52:55], v[132:135], v[152:155], v[52:55]
    ds_read_b128 v[208:211], v6 offset:19456
    v_mfma_f32_16x16x32_bf16 v[80:83], v[136:139], v[152:155], v[80:83]
    ds_read_b128 v[212:215], v6 offset:20480
    v_mfma_f32_16x16x32_bf16 v[108:111], v[140:143], v[152:155], v[108:111]
    s_add_u32 s32, s32, 1
    s_cmp_eq_u32 s32, 3
    v_mfma_f32_16x16x32_bf16 v[28:31], v[128:131], v[156:159], v[28:31]
    s_mov_b32 s6, 45056
    s_cselect_b32 s6, -90112, s6
    v_mfma_f32_16x16x32_bf16 v[56:59], v[132:135], v[156:159], v[56:59]
    s_cselect_b32 s32, 0, s32
    v_add_u32 v4, s6, v4
    v_mfma_f32_16x16x32_bf16 v[84:87], v[136:139], v[156:159], v[84:87]
    v_add_u32 v5, s6, v5
    v_add_u32 v6, s6, v6
    v_mfma_f32_16x16x32_bf16 v[112:115], v[140:143], v[156:159], v[112:115]
    s_sub_u32 s36, s36, 1
    s_cmp_lg_u32 s36, 0
    v_mfma_f32_16x16x32_bf16 v[32:35], v[160:163], v[128:131], v[32:35]
    v_mfma_f32_16x16x32_bf16 v[60:63], v[160:163], v[132:135], v[60:63]
    v_mfma_f32_16x16x32_bf16 v[88:91], v[160:163], v[136:139], v[88:91]
    v_mfma_f32_16x16x32_bf16 v[116:119], v[160:163], v[140:143], v[116:119]
    v_mfma_f32_16x16x32_bf16 v[36:39], v[164:167], v[128:131], v[36:39]
    v_mfma_f32_16x16x32_bf16 v[64:67], v[164:167], v[132:135], v[64:67]
    v_mfma_f32_16x16x32_bf16 v[92:95], v[164:167], v[136:139], v[92:95]
    v_mfma_f32_16x16x32_bf16 v[120:123], v[164:167], v[140:143], v[120:123]
    v_mfma_f32_16x16x32_bf16 v[40:43], v[168:171], v[128:131], v[40:43]
    v_mfma_f32_16x16x32_bf16 v[68:71], v[168:171], v[132:135], v[68:71]
    v_mfma_f32_16x16x32_bf16 v[96:99], v[168:171], v[136:139], v[96:99]
    v_mfma_f32_16x16x32_bf16 v[124:127], v[168:171], v[140:143], v[124:127]
    s_waitcnt lgkmcnt(0)
    s_cbranch_scc1 L_dloopa
    s_barrier
    v_mfma_f32_16x16x32_bf16 v[16:19], v[172:175], v[188:191], v[16:19]
    v_mfma_f32_16x16x32_bf16 v[44:47], v[176:179], v[188:191], v[44:47]
    v_mfma_f32_16x16x32_bf16 v[72:75], v[180:183], v[188:191], v[72:75]
    v_mfma_f32_16x16x32_bf16 v[100:103], v[184:187], v[188:191], v[100:103]
    v_mfma_f32_16x16x32_bf16 v[20:23], v[172:175], v[192:195], v[20:23]
    v_mfma_f32_16x16x32_bf16 v[48:51], v[176:179], v[192:195], v[48:51]
    v_mfma_f32_16x16x32_bf16 v[76:79], v[180:183], v[192:195], v[76:79]
    v_mfma_f32_16x16x32_bf16 v[104:107], v[184:187], v[192:195], v[104:107]
    v_mfma_f32_16x16x32_bf16 v[24:27], v[172:175], v[196:199], v[24:27]
    v_mfma_f32_16x16x32_bf16 v[52:55], v[176:179], v[196:199], v[52:55]
    v_mfma_f32_16x16x32_bf16 v[80:83], v[180:183], v[196:199], v[80:83]
    v_mfma_f32_16x16x32_bf16 v[108:111], v[184:187], v[196:199], v[108:111]
    v_mfma_f32_16x16x32_bf16 v[28:31], v[172:175], v[200:203], v[28:31]
    v_mfma_f32_16x16x32_bf16 v[56:59], v[176:179], v[200:203], v[56:59]
    v_mfma_f32_16x16x32_bf16 v[84:87], v[180:183], v[200:203], v[84:87]
    v_mfma_f32_16x16x32_bf16 v[112:115], v[184:187], v[200:203], v[112:115]
    v_mfma_f32_16x16x32_bf16 v[32:35], v[204:207], v[172:175], v[32:35]
    v_mfma_f32_16x16x32_bf16 v[60:63], v[204:207], v[176:179], v[60:63]
    v_mfma_f32_16x16x32_bf16 v[88:91], v[204:207], v[180:183], v[88:91]
    v_mfma_f32_16x16x32_bf16 v[116:119], v[204:207], v[184:187], v[116:119]
    v_mfma_f32_16x16x32_bf16 v[36:39], v[208:211], v[172:175], v[36:39]
    v_mfma_f32_16x16x32_bf16 v[64:67], v[208:211], v[176:179], v[64:67]
    v_mfma_f32_16x16x32_bf16 v[92:95], v[208:211], v[180:183], v[92:95]
    v_mfma_f32_16x16x32_bf16 v[120:123], v[208:211], v[184:187], v[120:123]
    v_mfma_f32_16x16x32_bf16 v[40:43], v[212:215], v[172:175], v[40:43]
    v_mfma_f32_16x16x32_bf16 v[68:71], v[212:215], v[176:179], v[68:71]
    v_mfma_f32_16x16x32_bf16 v[96:99], v[212:215], v[180:183], v[96:99]
    v_mfma_f32_16x16x32_bf16 v[124:127], v[212:215], v[184:187], v[124:127]
    s_nop 7
    s_lshl_b32 s6, s30, 8
    s_add_u32 s6, s6, 151552
    v_lshl_add_u32 v4, v2, 4, s6
    v_lshl_add_u32 v14, v1, 2, s6
    s_mov_b32 s6, 152576
    v_lshl_add_u32 v5, v1, 2, s6
    v_lshl_add_u32 v15, v2, 4, s6
    v_mov_b32 v10, 0xc0135761
    v_mov_b32 v11, v10
    ds_read_b128 v[128:131], v4 offset:0
    ds_read_b128 v[144:147], v4 offset:512
    ds_read_b128 v[132:135], v4 offset:64
    ds_read_b128 v[148:151], v4 offset:576
    ds_read_b128 v[136:139], v4 offset:128
    ds_read_b128 v[152:155], v4 offset:640
    ds_read_b128 v[140:143], v4 offset:192
    ds_read_b128 v[156:159], v4 offset:704
    ds_read_b32 v160, v5 offset:0
    ds_read_b32 v162, v5 offset:64
    ds_read_b32 v164, v5 offset:128
    ds_read_b32 v166, v5 offset:192
    s_waitcnt lgkmcnt(0)
    ds_read_b32 v204, v14 offset:0
    ds_read_b32 v205, v14 offset:512
    ds_read_b32 v206, v14 offset:64
    ds_read_b32 v207, v14 offset:576
    ds_read_b32 v208, v14 offset:128
    ds_read_b32 v209, v14 offset:640
    ds_read_b32 v210, v14 offset:192
    ds_read_b32 v211, v14 offset:704
    ds_read_b128 v[212:215], v15 offset:256
    ds_read_b128 v[216:219], v15 offset:320
    ds_read_b128 v[220:223], v15 offset:384
    v_pk_mul_f32 v[16:17], v[16:17], v[128:129]
    v_pk_mul_f32 v[18:19], v[18:19], v[130:131]
    v_pk_fma_f32 v[16:17], v[144:145], v[160:161], v[16:17] op_sel_hi:[1,0,1]
    v_pk_fma_f32 v[18:19], v[146:147], v[160:161], v[18:19] op_sel_hi:[1,0,1]
    v_pk_mul_f32 v[168:169], v[16:17], v[16:17]
    v_pk_mul_f32 v[170:171], v[18:19], v[18:19]
    v_pk_fma_f32 v[168:169], v[168:169], s[48:49], v[10:11]
    v_pk_fma_f32 v[170:171], v[170:171], s[48:49], v[10:11]
    v_pk_mul_f32 v[168:169], v[168:169], v[16:17]
    v_pk_mul_f32 v[170:171], v[170:171], v[18:19]
    v_exp_f32 v168, v168
    v_exp_f32 v169, v169
    v_exp_f32 v170, v170
    v_exp_f32 v171, v171
    s_nop 0
    v_pk_add_f32 v[168:169], v[168:169], 1.0 op_sel_hi:[1,0]
    v_pk_add_f32 v[170:171], v[170:171], 1.0 op_sel_hi:[1,0]
    v_rcp_f32 v168, v168
    v_rcp_f32 v169, v169
    v_rcp_f32 v170, v170
    v_rcp_f32 v171, v171
    s_nop 0
    v_pk_mul_f32 v[16:17], v[16:17], v[168:169]
    v_pk_mul_f32 v[18:19], v[18:19], v[170:171]
    v_mov_b32 v172, v16
    v_mov_b32 v173, v17
    v_pk_mul_f32 v[176:177], v[16:17], v[16:17]
    v_mov_b32 v174, v18
    v_mov_b32 v175, v19
    v_pk_mul_f32 v[178:179], v[18:19], v[18:19]
    v_pk_mul_f32 v[20:21], v[20:21], v[128:129]
    v_pk_mul_f32 v[22:23], v[22:23], v[130:131]
    v_pk_fma_f32 v[20:21], v[144:145], v[162:163], v[20:21] op_sel_hi:[1,0,1]
    v_pk_fma_f32 v[22:23], v[146:147], v[162:163], v[22:23] op_sel_hi:[1,0,1]
    v_pk_mul_f32 v[168:169], v[20:21], v[20:21]
    v_pk_mul_f32 v[170:171], v[22:23], v[22:23]
    v_pk_fma_f32 v[168:169], v[168:169], s[48:49], v[10:11]
    v_pk_fma_f32 v[170:171], v[170:171], s[48:49], v[10:11]
    v_pk_mul_f32 v[168:169], v[168:169], v[20:21]
    v_pk_mul_f32 v[170:171], v[170:171], v[22:23]
    v_exp_f32 v168, v168
    v_exp_f32 v169, v169
    v_exp_f32 v170, v170
    v_exp_f32 v171, v171
    s_nop 0
    v_pk_add_f32 v[168:169], v[168:169], 1.0 op_sel_hi:[1,0]
    v_pk_add_f32 v[170:171], v[170:171], 1.0 op_sel_hi:[1,0]
    v_rcp_f32 v168, v168
    v_rcp_f32 v169, v169
    v_rcp_f32 v170, v170
    v_rcp_f32 v171, v171
    s_nop 0
    v_pk_mul_f32 v[20:21], v[20:21], v[168:169]
    v_pk_mul_f32 v[22:23], v[22:23], v[170:171]
    v_pk_add_f32 v[172:173], v[172:173], v[20:21]
    v_pk_fma_f32 v[176:177], v[20:21], v[20:21], v[176:177]
    v_pk_add_f32 v[174:175], v[174:175], v[22:23]
    v_pk_fma_f32 v[178:179], v[22:23], v[22:23], v[178:179]
    v_pk_mul_f32 v[24:25], v[24:25], v[128:129]
    v_pk_mul_f32 v[26:27], v[26:27], v[130:131]
    v_pk_fma_f32 v[24:25], v[144:145], v[164:165], v[24:25] op_sel_hi:[1,0,1]
    v_pk_fma_f32 v[26:27], v[146:147], v[164:165], v[26:27] op_sel_hi:[1,0,1]
    v_pk_mul_f32 v[168:169], v[24:25], v[24:25]
    v_pk_mul_f32 v[170:171], v[26:27], v[26:27]
    v_pk_fma_f32 v[168:169], v[168:169], s[48:49], v[10:11]
    v_pk_fma_f32 v[170:171], v[170:171], s[48:49], v[10:11]
    v_pk_mul_f32 v[168:169], v[168:169], v[24:25]
    v_pk_mul_f32 v[170:171], v[170:171], v[26:27]
    v_exp_f32 v168, v168
    v_exp_f32 v169, v169
    v_exp_f32 v170, v170
    v_exp_f32 v171, v171
    s_nop 0
    v_pk_add_f32 v[168:169], v[168:169], 1.0 op_sel_hi:[1,0]
    v_pk_add_f32 v[170:171], v[170:171], 1.0 op_sel_hi:[1,0]
    v_rcp_f32 v168, v168
    v_rcp_f32 v169, v169
    v_rcp_f32 v170, v170
    v_rcp_f32 v171, v171
    s_nop 0
    v_pk_mul_f32 v[24:25], v[24:25], v[168:169]
    v_pk_mul_f32 v[26:27], v[26:27], v[170:171]
    v_pk_add_f32 v[172:173], v[172:173], v[24:25]
    v_pk_fma_f32 v[176:177], v[24:25], v[24:25], v[176:177]
    v_pk_add_f32 v[174:175], v[174:175], v[26:27]
    v_pk_fma_f32 v[178:179], v[26:27], v[26:27], v[178:179]
    v_pk_mul_f32 v[28:29], v[28:29], v[128:129]
    v_pk_mul_f32 v[30:31], v[30:31], v[130:131]
    v_pk_fma_f32 v[28:29], v[144:145], v[166:167], v[28:29] op_sel_hi:[1,0,1]
    v_pk_fma_f32 v[30:31], v[146:147], v[166:167], v[30:31] op_sel_hi:[1,0,1]
    v_pk_mul_f32 v[168:169], v[28:29], v[28:29]
    v_pk_mul_f32 v[170:171], v[30:31], v[30:31]
    v_pk_fma_f32 v[168:169], v[168:169], s[48:49], v[10:11]
    v_pk_fma_f32 v[170:171], v[170:171], s[48:49], v[10:11]
    v_pk_mul_f32 v[168:169], v[168:169], v[28:29]
    v_pk_mul_f32 v[170:171], v[170:171], v[30:31]
    v_exp_f32 v168, v168
    v_exp_f32 v169, v169
    v_exp_f32 v170, v170
    v_exp_f32 v171, v171
    s_nop 0
    v_pk_add_f32 v[168:169], v[168:169], 1.0 op_sel_hi:[1,0]
    v_pk_add_f32 v[170:171], v[170:171], 1.0 op_sel_hi:[1,0]
    v_rcp_f32 v168, v168
    v_rcp_f32 v169, v169
    v_rcp_f32 v170, v170
    v_rcp_f32 v171, v171
    s_nop 0
    v_pk_mul_f32 v[28:29], v[28:29], v[168:169]
    v_pk_mul_f32 v[30:31], v[30:31], v[170:171]
    v_pk_add_f32 v[172:173], v[172:173], v[28:29]
    v_pk_fma_f32 v[176:177], v[28:29], v[28:29], v[176:177]
    v_pk_add_f32 v[174:175], v[174:175], v[30:31]
    v_pk_fma_f32 v[178:179], v[30:31], v[30:31], v[178:179]
    v_pk_mul_f32 v[44:45], v[44:45], v[132:133]
    v_pk_mul_f32 v[46:47], v[46:47], v[134:135]
    v_pk_fma_f32 v[44:45], v[148:149], v[160:161], v[44:45] op_sel_hi:[1,0,1]
    v_pk_fma_f32 v[46:47], v[150:151], v[160:161], v[46:47] op_sel_hi:[1,0,1]
    v_pk_mul_f32 v[168:169], v[44:45], v[44:45]
    v_pk_mul_f32 v[170:171], v[46:47], v[46:47]
    v_pk_fma_f32 v[168:169], v[168:169], s[48:49], v[10:11]
    v_pk_fma_f32 v[170:171], v[170:171], s[48:49], v[10:11]
    v_pk_mul_f32 v[168:169], v[168:169], v[44:45]
    v_pk_mul_f32 v[170:171], v[170:171], v[46:47]
    v_exp_f32 v168, v168
    v_exp_f32 v169, v169
    v_exp_f32 v170, v170
    v_exp_f32 v171, v171
    s_nop 0
    v_pk_add_f32 v[168:169], v[168:169], 1.0 op_sel_hi:[1,0]
    v_pk_add_f32 v[170:171], v[170:171], 1.0 op_sel_hi:[1,0]
    v_rcp_f32 v168, v168
    v_rcp_f32 v169, v169
    v_rcp_f32 v170, v170
    v_rcp_f32 v171, v171
    s_nop 0
    v_pk_mul_f32 v[44:45], v[44:45], v[168:169]
    v_pk_mul_f32 v[46:47], v[46:47], v[170:171]
    v_mov_b32 v180, v44
    v_mov_b32 v181, v45
    v_pk_mul_f32 v[184:185], v[44:45], v[44:45]
    v_mov_b32 v182, v46
    v_mov_b32 v183, v47
    v_pk_mul_f32 v[186:187], v[46:47], v[46:47]
    v_pk_mul_f32 v[48:49], v[48:49], v[132:133]
    v_pk_mul_f32 v[50:51], v[50:51], v[134:135]
    v_pk_fma_f32 v[48:49], v[148:149], v[162:163], v[48:49] op_sel_hi:[1,0,1]
    v_pk_fma_f32 v[50:51], v[150:151], v[162:163], v[50:51] op_sel_hi:[1,0,1]
    v_pk_mul_f32 v[168:169], v[48:49], v[48:49]
    v_pk_mul_f32 v[170:171], v[50:51], v[50:51]
    v_pk_fma_f32 v[168:169], v[168:169], s[48:49], v[10:11]
    v_pk_fma_f32 v[170:171], v[170:171], s[48:49], v[10:11]
    v_pk_mul_f32 v[168:169], v[168:169], v[48:49]
    v_pk_mul_f32 v[170:171], v[170:171], v[50:51]
    v_exp_f32 v168, v168
    v_exp_f32 v169, v169
    v_exp_f32 v170, v170
    v_exp_f32 v171, v171
    s_nop 0
    v_pk_add_f32 v[168:169], v[168:169], 1.0 op_sel_hi:[1,0]
    v_pk_add_f32 v[170:171], v[170:171], 1.0 op_sel_hi:[1,0]
    v_rcp_f32 v168, v168
    v_rcp_f32 v169, v169
    v_rcp_f32 v170, v170
    v_rcp_f32 v171, v171
    s_nop 0
    v_pk_mul_f32 v[48:49], v[48:49], v[168:169]
    v_pk_mul_f32 v[50:51], v[50:51], v[170:171]
    v_pk_add_f32 v[180:181], v[180:181], v[48:49]
    v_pk_fma_f32 v[184:185], v[48:49], v[48:49], v[184:185]
    v_pk_add_f32 v[182:183], v[182:183], v[50:51]
    v_pk_fma_f32 v[186:187], v[50:51], v[50:51], v[186:187]
    v_pk_mul_f32 v[52:53], v[52:53], v[132:133]
    v_pk_mul_f32 v[54:55], v[54:55], v[134:135]
    v_pk_fma_f32 v[52:53], v[148:149], v[164:165], v[52:53] op_sel_hi:[1,0,1]
    v_pk_fma_f32 v[54:55], v[150:151], v[164:165], v[54:55] op_sel_hi:[1,0,1]
    v_pk_mul_f32 v[168:169], v[52:53], v[52:53]
    v_pk_mul_f32 v[170:171], v[54:55], v[54:55]
    v_pk_fma_f32 v[168:169], v[168:169], s[48:49], v[10:11]
    v_pk_fma_f32 v[170:171], v[170:171], s[48:49], v[10:11]
    v_pk_mul_f32 v[168:169], v[168:169], v[52:53]
    v_pk_mul_f32 v[170:171], v[170:171], v[54:55]
    v_exp_f32 v168, v168
    v_exp_f32 v169, v169
    v_exp_f32 v170, v170
    v_exp_f32 v171, v171
    s_nop 0
    v_pk_add_f32 v[168:169], v[168:169], 1.0 op_sel_hi:[1,0]
    v_pk_add_f32 v[170:171], v[170:171], 1.0 op_sel_hi:[1,0]
    v_rcp_f32 v168, v168
    v_rcp_f32 v169, v169
    v_rcp_f32 v170, v170
    v_rcp_f32 v171, v171
    s_nop 0
    v_pk_mul_f32 v[52:53], v[52:53], v[168:169]
    v_pk_mul_f32 v[54:55], v[54:55], v[170:171]
    v_pk_add_f32 v[180:181], v[180:181], v[52:53]
    v_pk_fma_f32 v[184:185], v[52:53], v[52:53], v[184:185]
    v_pk_add_f32 v[182:183], v[182:183], v[54:55]
    v_pk_fma_f32 v[186:187], v[54:55], v[54:55], v[186:187]
    v_pk_mul_f32 v[56:57], v[56:57], v[132:133]
    v_pk_mul_f32 v[58:59], v[58:59], v[134:135]
    v_pk_fma_f32 v[56:57], v[148:149], v[166:167], v[56:57] op_sel_hi:[1,0,1]
    v_pk_fma_f32 v[58:59], v[150:151], v[166:167], v[58:59] op_sel_hi:[1,0,1]
    v_pk_mul_f32 v[168:169], v[56:57], v[56:57]
    v_pk_mul_f32 v[170:171], v[58:59], v[58:59]
    v_pk_fma_f32 v[168:169], v[168:169], s[48:49], v[10:11]
    v_pk_fma_f32 v[170:171], v[170:171], s[48:49], v[10:11]
    v_pk_mul_f32 v[168:169], v[168:169], v[56:57]
    v_pk_mul_f32 v[170:171], v[170:171], v[58:59]
    v_exp_f32 v168, v168
    v_exp_f32 v169, v169
    v_exp_f32 v170, v170
    v_exp_f32 v171, v171
    s_nop 0
    v_pk_add_f32 v[168:169], v[168:169], 1.0 op_sel_hi:[1,0]
    v_pk_add_f32 v[170:171], v[170:171], 1.0 op_sel_hi:[1,0]
    v_rcp_f32 v168, v168
    v_rcp_f32 v169, v169
    v_rcp_f32 v170, v170
    v_rcp_f32 v171, v171
    s_nop 0
    v_pk_mul_f32 v[56:57], v[56:57], v[168:169]
    v_pk_mul_f32 v[58:59], v[58:59], v[170:171]
    v_pk_add_f32 v[180:181], v[180:181], v[56:57]
    v_pk_fma_f32 v[184:185], v[56:57], v[56:57], v[184:185]
    v_pk_add_f32 v[182:183], v[182:183], v[58:59]
    v_pk_fma_f32 v[186:187], v[58:59], v[58:59], v[186:187]
    v_pk_mul_f32 v[72:73], v[72:73], v[136:137]
    v_pk_mul_f32 v[74:75], v[74:75], v[138:139]
    v_pk_fma_f32 v[72:73], v[152:153], v[160:161], v[72:73] op_sel_hi:[1,0,1]
    v_pk_fma_f32 v[74:75], v[154:155], v[160:161], v[74:75] op_sel_hi:[1,0,1]
    v_pk_mul_f32 v[168:169], v[72:73], v[72:73]
    v_pk_mul_f32 v[170:171], v[74:75], v[74:75]
    v_pk_fma_f32 v[168:169], v[168:169], s[48:49], v[10:11]
    v_pk_fma_f32 v[170:171], v[170:171], s[48:49], v[10:11]
    v_pk_mul_f32 v[168:169], v[168:169], v[72:73]
    v_pk_mul_f32 v[170:171], v[170:171], v[74:75]
    v_exp_f32 v168, v168
    v_exp_f32 v169, v169
    v_exp_f32 v170, v170
    v_exp_f32 v171, v171
    s_nop 0
    v_pk_add_f32 v[168:169], v[168:169], 1.0 op_sel_hi:[1,0]
    v_pk_add_f32 v[170:171], v[170:171], 1.0 op_sel_hi:[1,0]
    v_rcp_f32 v168, v168
    v_rcp_f32 v169, v169
    v_rcp_f32 v170, v170
    v_rcp_f32 v171, v171
    s_nop 0
    v_pk_mul_f32 v[72:73], v[72:73], v[168:169]
    v_pk_mul_f32 v[74:75], v[74:75], v[170:171]
    v_mov_b32 v188, v72
    v_mov_b32 v189, v73
    v_pk_mul_f32 v[192:193], v[72:73], v[72:73]
    v_mov_b32 v190, v74
    v_mov_b32 v191, v75
    v_pk_mul_f32 v[194:195], v[74:75], v[74:75]
    v_pk_mul_f32 v[76:77], v[76:77], v[136:137]
    v_pk_mul_f32 v[78:79], v[78:79], v[138:139]
    v_pk_fma_f32 v[76:77], v[152:153], v[162:163], v[76:77] op_sel_hi:[1,0,1]
    v_pk_fma_f32 v[78:79], v[154:155], v[162:163], v[78:79] op_sel_hi:[1,0,1]
    v_pk_mul_f32 v[168:169], v[76:77], v[76:77]
    v_pk_mul_f32 v[170:171], v[78:79], v[78:79]
    v_pk_fma_f32 v[168:169], v[168:169], s[48:49], v[10:11]
    v_pk_fma_f32 v[170:171], v[170:171], s[48:49], v[10:11]
    v_pk_mul_f32 v[168:169], v[168:169], v[76:77]
    v_pk_mul_f32 v[170:171], v[170:171], v[78:79]
    v_exp_f32 v168, v168
    v_exp_f32 v169, v169
    v_exp_f32 v170, v170
    v_exp_f32 v171, v171
    s_nop 0
    v_pk_add_f32 v[168:169], v[168:169], 1.0 op_sel_hi:[1,0]
    v_pk_add_f32 v[170:171], v[170:171], 1.0 op_sel_hi:[1,0]
    v_rcp_f32 v168, v168
    v_rcp_f32 v169, v169
    v_rcp_f32 v170, v170
    v_rcp_f32 v171, v171
    s_nop 0
    v_pk_mul_f32 v[76:77], v[76:77], v[168:169]
    v_pk_mul_f32 v[78:79], v[78:79], v[170:171]
    v_pk_add_f32 v[188:189], v[188:189], v[76:77]
    v_pk_fma_f32 v[192:193], v[76:77], v[76:77], v[192:193]
    v_pk_add_f32 v[190:191], v[190:191], v[78:79]
    v_pk_fma_f32 v[194:195], v[78:79], v[78:79], v[194:195]
    v_pk_mul_f32 v[80:81], v[80:81], v[136:137]
    v_pk_mul_f32 v[82:83], v[82:83], v[138:139]
    v_pk_fma_f32 v[80:81], v[152:153], v[164:165], v[80:81] op_sel_hi:[1,0,1]
    v_pk_fma_f32 v[82:83], v[154:155], v[164:165], v[82:83] op_sel_hi:[1,0,1]
    v_pk_mul_f32 v[168:169], v[80:81], v[80:81]
    v_pk_mul_f32 v[170:171], v[82:83], v[82:83]
    v_pk_fma_f32 v[168:169], v[168:169], s[48:49], v[10:11]
    v_pk_fma_f32 v[170:171], v[170:171], s[48:49], v[10:11]
    v_pk_mul_f32 v[168:169], v[168:169], v[80:81]
    v_pk_mul_f32 v[170:171], v[170:171], v[82:83]
    v_exp_f32 v168, v168
    v_exp_f32 v169, v169
    v_exp_f32 v170, v170
    v_exp_f32 v171, v171
    s_nop 0
    v_pk_add_f32 v[168:169], v[168:169], 1.0 op_sel_hi:[1,0]
    v_pk_add_f32 v[170:171], v[170:171], 1.0 op_sel_hi:[1,0]
    v_rcp_f32 v168, v168
    v_rcp_f32 v169, v169
    v_rcp_f32 v170, v170
    v_rcp_f32 v171, v171
    s_nop 0
    v_pk_mul_f32 v[80:81], v[80:81], v[168:169]
    v_pk_mul_f32 v[82:83], v[82:83], v[170:171]
    v_pk_add_f32 v[188:189], v[188:189], v[80:81]
    v_pk_fma_f32 v[192:193], v[80:81], v[80:81], v[192:193]
    v_pk_add_f32 v[190:191], v[190:191], v[82:83]
    v_pk_fma_f32 v[194:195], v[82:83], v[82:83], v[194:195]
    v_pk_mul_f32 v[84:85], v[84:85], v[136:137]
    v_pk_mul_f32 v[86:87], v[86:87], v[138:139]
    v_pk_fma_f32 v[84:85], v[152:153], v[166:167], v[84:85] op_sel_hi:[1,0,1]
    v_pk_fma_f32 v[86:87], v[154:155], v[166:167], v[86:87] op_sel_hi:[1,0,1]
    v_pk_mul_f32 v[168:169], v[84:85], v[84:85]
    v_pk_mul_f32 v[170:171], v[86:87], v[86:87]
    v_pk_fma_f32 v[168:169], v[168:169], s[48:49], v[10:11]
    v_pk_fma_f32 v[170:171], v[170:171], s[48:49], v[10:11]
    v_pk_mul_f32 v[168:169], v[168:169], v[84:85]
    v_pk_mul_f32 v[170:171], v[170:171], v[86:87]
    v_exp_f32 v168, v168
    v_exp_f32 v169, v169
    v_exp_f32 v170, v170
    v_exp_f32 v171, v171
    s_nop 0
    v_pk_add_f32 v[168:169], v[168:169], 1.0 op_sel_hi:[1,0]
    v_pk_add_f32 v[170:171], v[170:171], 1.0 op_sel_hi:[1,0]
    v_rcp_f32 v168, v168
    v_rcp_f32 v169, v169
    v_rcp_f32 v170, v170
    v_rcp_f32 v171, v171
    s_nop 0
    v_pk_mul_f32 v[84:85], v[84:85], v[168:169]
    v_pk_mul_f32 v[86:87], v[86:87], v[170:171]
    v_pk_add_f32 v[188:189], v[188:189], v[84:85]
    v_pk_fma_f32 v[192:193], v[84:85], v[84:85], v[192:193]
    v_pk_add_f32 v[190:191], v[190:191], v[86:87]
    v_pk_fma_f32 v[194:195], v[86:87], v[86:87], v[194:195]
    v_pk_mul_f32 v[100:101], v[100:101], v[140:141]
    v_pk_mul_f32 v[102:103], v[102:103], v[142:143]
    v_pk_fma_f32 v[100:101], v[156:157], v[160:161], v[100:101] op_sel_hi:[1,0,1]
    v_pk_fma_f32 v[102:103], v[158:159], v[160:161], v[102:103] op_sel_hi:[1,0,1]
    v_pk_mul_f32 v[168:169], v[100:101], v[100:101]
    v_pk_mul_f32 v[170:171], v[102:103], v[102:103]
    v_pk_fma_f32 v[168:169], v[168:169], s[48:49], v[10:11]
    v_pk_fma_f32 v[170:171], v[170:171], s[48:49], v[10:11]
    v_pk_mul_f32 v[168:169], v[168:169], v[100:101]
    v_pk_mul_f32 v[170:171], v[170:171], v[102:103]
    v_exp_f32 v168, v168
    v_exp_f32 v169, v169
    v_exp_f32 v170, v170
    v_exp_f32 v171, v171
    s_nop 0
    v_pk_add_f32 v[168:169], v[168:169], 1.0 op_sel_hi:[1,0]
    v_pk_add_f32 v[170:171], v[170:171], 1.0 op_sel_hi:[1,0]
    v_rcp_f32 v168, v168
    v_rcp_f32 v169, v169
    v_rcp_f32 v170, v170
    v_rcp_f32 v171, v171
    s_nop 0
    v_pk_mul_f32 v[100:101], v[100:101], v[168:169]
    v_pk_mul_f32 v[102:103], v[102:103], v[170:171]
    v_mov_b32 v196, v100
    v_mov_b32 v197, v101
    v_pk_mul_f32 v[200:201], v[100:101], v[100:101]
    v_mov_b32 v198, v102
    v_mov_b32 v199, v103
    v_pk_mul_f32 v[202:203], v[102:103], v[102:103]
    v_pk_mul_f32 v[104:105], v[104:105], v[140:141]
    v_pk_mul_f32 v[106:107], v[106:107], v[142:143]
    v_pk_fma_f32 v[104:105], v[156:157], v[162:163], v[104:105] op_sel_hi:[1,0,1]
    v_pk_fma_f32 v[106:107], v[158:159], v[162:163], v[106:107] op_sel_hi:[1,0,1]
    v_pk_mul_f32 v[168:169], v[104:105], v[104:105]
    v_pk_mul_f32 v[170:171], v[106:107], v[106:107]
    v_pk_fma_f32 v[168:169], v[168:169], s[48:49], v[10:11]
    v_pk_fma_f32 v[170:171], v[170:171], s[48:49], v[10:11]
    v_pk_mul_f32 v[168:169], v[168:169], v[104:105]
    v_pk_mul_f32 v[170:171], v[170:171], v[106:107]
    v_exp_f32 v168, v168
    v_exp_f32 v169, v169
    v_exp_f32 v170, v170
    v_exp_f32 v171, v171
    s_nop 0
    v_pk_add_f32 v[168:169], v[168:169], 1.0 op_sel_hi:[1,0]
    v_pk_add_f32 v[170:171], v[170:171], 1.0 op_sel_hi:[1,0]
    v_rcp_f32 v168, v168
    v_rcp_f32 v169, v169
    v_rcp_f32 v170, v170
    v_rcp_f32 v171, v171
    s_nop 0
    v_pk_mul_f32 v[104:105], v[104:105], v[168:169]
    v_pk_mul_f32 v[106:107], v[106:107], v[170:171]
    v_pk_add_f32 v[196:197], v[196:197], v[104:105]
    v_pk_fma_f32 v[200:201], v[104:105], v[104:105], v[200:201]
    v_pk_add_f32 v[198:199], v[198:199], v[106:107]
    v_pk_fma_f32 v[202:203], v[106:107], v[106:107], v[202:203]
    v_pk_mul_f32 v[108:109], v[108:109], v[140:141]
    v_pk_mul_f32 v[110:111], v[110:111], v[142:143]
    v_pk_fma_f32 v[108:109], v[156:157], v[164:165], v[108:109] op_sel_hi:[1,0,1]
    v_pk_fma_f32 v[110:111], v[158:159], v[164:165], v[110:111] op_sel_hi:[1,0,1]
    v_pk_mul_f32 v[168:169], v[108:109], v[108:109]
    v_pk_mul_f32 v[170:171], v[110:111], v[110:111]
    v_pk_fma_f32 v[168:169], v[168:169], s[48:49], v[10:11]
    v_pk_fma_f32 v[170:171], v[170:171], s[48:49], v[10:11]
    v_pk_mul_f32 v[168:169], v[168:169], v[108:109]
    v_pk_mul_f32 v[170:171], v[170:171], v[110:111]
    v_exp_f32 v168, v168
    v_exp_f32 v169, v169
    v_exp_f32 v170, v170
    v_exp_f32 v171, v171
    s_nop 0
    v_pk_add_f32 v[168:169], v[168:169], 1.0 op_sel_hi:[1,0]
    v_pk_add_f32 v[170:171], v[170:171], 1.0 op_sel_hi:[1,0]
    v_rcp_f32 v168, v168
    v_rcp_f32 v169, v169
    v_rcp_f32 v170, v170
    v_rcp_f32 v171, v171
    s_nop 0
    v_pk_mul_f32 v[108:109], v[108:109], v[168:169]
    v_pk_mul_f32 v[110:111], v[110:111], v[170:171]
    v_pk_add_f32 v[196:197], v[196:197], v[108:109]
    v_pk_fma_f32 v[200:201], v[108:109], v[108:109], v[200:201]
    v_pk_add_f32 v[198:199], v[198:199], v[110:111]
    v_pk_fma_f32 v[202:203], v[110:111], v[110:111], v[202:203]
    v_pk_mul_f32 v[112:113], v[112:113], v[140:141]
    v_pk_mul_f32 v[114:115], v[114:115], v[142:143]
    v_pk_fma_f32 v[112:113], v[156:157], v[166:167], v[112:113] op_sel_hi:[1,0,1]
    v_pk_fma_f32 v[114:115], v[158:159], v[166:167], v[114:115] op_sel_hi:[1,0,1]
    v_pk_mul_f32 v[168:169], v[112:113], v[112:113]
    v_pk_mul_f32 v[170:171], v[114:115], v[114:115]
    v_pk_fma_f32 v[168:169], v[168:169], s[48:49], v[10:11]
    v_pk_fma_f32 v[170:171], v[170:171], s[48:49], v[10:11]
    v_pk_mul_f32 v[168:169], v[168:169], v[112:113]
    v_pk_mul_f32 v[170:171], v[170:171], v[114:115]
    v_exp_f32 v168, v168
    v_exp_f32 v169, v169
    v_exp_f32 v170, v170
    v_exp_f32 v171, v171
    s_nop 0
    v_pk_add_f32 v[168:169], v[168:169], 1.0 op_sel_hi:[1,0]
    v_pk_add_f32 v[170:171], v[170:171], 1.0 op_sel_hi:[1,0]
    v_rcp_f32 v168, v168
    v_rcp_f32 v169, v169
    v_rcp_f32 v170, v170
    v_rcp_f32 v171, v171
    s_nop 0
    v_pk_mul_f32 v[112:113], v[112:113], v[168:169]
    v_pk_mul_f32 v[114:115], v[114:115], v[170:171]
    v_pk_add_f32 v[196:197], v[196:197], v[112:113]
    v_pk_fma_f32 v[200:201], v[112:113], v[112:113], v[200:201]
    v_pk_add_f32 v[198:199], v[198:199], v[114:115]
    v_pk_fma_f32 v[202:203], v[114:115], v[114:115], v[202:203]
    v_bfe_u32 v6, v0, 3, 1
    v_lshlrev_b32 v6, 2, v6
    v_add_u32 v6, v6, v2
    v_lshlrev_b32 v6, 1, v6
    v_bfe_u32 v7, v0, 2, 1
    v_add_u32 v6, v6, v7
    v_lshlrev_b32 v6, 2, v6
    v_and_b32 v7, 3, v0
    v_add_lshl_u32 v6, v6, v7, 2
    s_mov_b32 s56, 0xaaaaaaaa
    s_mov_b32 s57, s56
    s_mov_b32 s58, 0xcccccccc
    s_mov_b32 s59, s58
    s_lshl_b32 s38, s4, 10
    s_lshl_b32 s7, s30, 9
    s_add_u32 s38, s38, s7
    s_add_u32 s38, s38, 16384
    v_add_f32_dpp v172, v172, v172 row_ror:8 row_mask:0xf bank_mask:0x3
    v_add_f32_dpp v173, v173, v173 row_ror:8 row_mask:0xf bank_mask:0x3
    v_add_f32_dpp v174, v174, v174 row_ror:8 row_mask:0xf bank_mask:0x3
    v_add_f32_dpp v175, v175, v175 row_ror:8 row_mask:0xf bank_mask:0x3
    v_add_f32_dpp v176, v176, v176 row_ror:8 row_mask:0xf bank_mask:0x3
    v_add_f32_dpp v177, v177, v177 row_ror:8 row_mask:0xf bank_mask:0x3
    v_add_f32_dpp v178, v178, v178 row_ror:8 row_mask:0xf bank_mask:0x3
    v_add_f32_dpp v179, v179, v179 row_ror:8 row_mask:0xf bank_mask:0x3
    v_add_f32_dpp v172, v180, v180 row_ror:8 row_mask:0xf bank_mask:0xc
    v_add_f32_dpp v173, v181, v181 row_ror:8 row_mask:0xf bank_mask:0xc
    v_add_f32_dpp v174, v182, v182 row_ror:8 row_mask:0xf bank_mask:0xc
    v_add_f32_dpp v175, v183, v183 row_ror:8 row_mask:0xf bank_mask:0xc
    v_add_f32_dpp v176, v184, v184 row_ror:8 row_mask:0xf bank_mask:0xc
    v_add_f32_dpp v177, v185, v185 row_ror:8 row_mask:0xf bank_mask:0xc
    v_add_f32_dpp v178, v186, v186 row_ror:8 row_mask:0xf bank_mask:0xc
    v_add_f32_dpp v179, v187, v187 row_ror:8 row_mask:0xf bank_mask:0xc
    v_add_f32_dpp v172, v172, v172 row_shl:4 row_mask:0xf bank_mask:0x5
    v_add_f32_dpp v173, v173, v173 row_shl:4 row_mask:0xf bank_mask:0x5
    v_add_f32_dpp v176, v176, v176 row_shl:4 row_mask:0xf bank_mask:0x5
    v_add_f32_dpp v177, v177, v177 row_shl:4 row_mask:0xf bank_mask:0x5
    v_add_f32_dpp v172, v174, v174 row_shr:4 row_mask:0xf bank_mask:0xa
    v_add_f32_dpp v173, v175, v175 row_shr:4 row_mask:0xf bank_mask:0xa
    v_add_f32_dpp v176, v178, v178 row_shr:4 row_mask:0xf bank_mask:0xa
    v_add_f32_dpp v177, v179, v179 row_shr:4 row_mask:0xf bank_mask:0xa
    v_add_f32_dpp v172, v172, v172 quad_perm:[2,3,0,1] row_mask:0xf bank_mask:0xf
    v_add_f32_dpp v173, v173, v173 quad_perm:[2,3,0,1] row_mask:0xf bank_mask:0xf
    v_add_f32_dpp v176, v176, v176 quad_perm:[2,3,0,1] row_mask:0xf bank_mask:0xf
    v_add_f32_dpp v177, v177, v177 quad_perm:[2,3,0,1] row_mask:0xf bank_mask:0xf
    v_add_f32_dpp v172, v172, v172 quad_perm:[1,0,3,2] row_mask:0xf bank_mask:0xf
    v_add_f32_dpp v173, v173, v173 quad_perm:[1,0,3,2] row_mask:0xf bank_mask:0xf
    v_add_f32_dpp v176, v176, v176 quad_perm:[1,0,3,2] row_mask:0xf bank_mask:0xf
    v_add_f32_dpp v177, v177, v177 quad_perm:[1,0,3,2] row_mask:0xf bank_mask:0xf
    v_cndmask_b32 v172, v172, v176, s[56:57]
    v_cndmask_b32 v173, v173, v177, s[56:57]
    v_cndmask_b32 v172, v172, v173, s[58:59]
    buffer_atomic_add_f32 v172, v6, s[44:47], s38 offen offset:0
    v_add_f32_dpp v188, v188, v188 row_ror:8 row_mask:0xf bank_mask:0x3
    v_add_f32_dpp v189, v189, v189 row_ror:8 row_mask:0xf bank_mask:0x3
    v_add_f32_dpp v190, v190, v190 row_ror:8 row_mask:0xf bank_mask:0x3
    v_add_f32_dpp v191, v191, v191 row_ror:8 row_mask:0xf bank_mask:0x3
    v_add_f32_dpp v192, v192, v192 row_ror:8 row_mask:0xf bank_mask:0x3
    v_add_f32_dpp v193, v193, v193 row_ror:8 row_mask:0xf bank_mask:0x3
    v_add_f32_dpp v194, v194, v194 row_ror:8 row_mask:0xf bank_mask:0x3
    v_add_f32_dpp v195, v195, v195 row_ror:8 row_mask:0xf bank_mask:0x3
    v_add_f32_dpp v188, v196, v196 row_ror:8 row_mask:0xf bank_mask:0xc
    v_add_f32_dpp v189, v197, v197 row_ror:8 row_mask:0xf bank_mask:0xc
    v_add_f32_dpp v190, v198, v198 row_ror:8 row_mask:0xf bank_mask:0xc
    v_add_f32_dpp v191, v199, v199 row_ror:8 row_mask:0xf bank_mask:0xc
    v_add_f32_dpp v192, v200, v200 row_ror:8 row_mask:0xf bank_mask:0xc
    v_add_f32_dpp v193, v201, v201 row_ror:8 row_mask:0xf bank_mask:0xc
    v_add_f32_dpp v194, v202, v202 row_ror:8 row_mask:0xf bank_mask:0xc
    v_add_f32_dpp v195, v203, v203 row_ror:8 row_mask:0xf bank_mask:0xc
    v_add_f32_dpp v188, v188, v188 row_shl:4 row_mask:0xf bank_mask:0x5
    v_add_f32_dpp v189, v189, v189 row_shl:4 row_mask:0xf bank_mask:0x5
    v_add_f32_dpp v192, v192, v192 row_shl:4 row_mask:0xf bank_mask:0x5
    v_add_f32_dpp v193, v193, v193 row_shl:4 row_mask:0xf bank_mask:0x5
    v_add_f32_dpp v188, v190, v190 row_shr:4 row_mask:0xf bank_mask:0xa
    v_add_f32_dpp v189, v191, v191 row_shr:4 row_mask:0xf bank_mask:0xa
    v_add_f32_dpp v192, v194, v194 row_shr:4 row_mask:0xf bank_mask:0xa
    v_add_f32_dpp v193, v195, v195 row_shr:4 row_mask:0xf bank_mask:0xa
    v_add_f32_dpp v188, v188, v188 quad_perm:[2,3,0,1] row_mask:0xf bank_mask:0xf
    v_add_f32_dpp v189, v189, v189 quad_perm:[2,3,0,1] row_mask:0xf bank_mask:0xf
    v_add_f32_dpp v192, v192, v192 quad_perm:[2,3,0,1] row_mask:0xf bank_mask:0xf
    v_add_f32_dpp v193, v193, v193 quad_perm:[2,3,0,1] row_mask:0xf bank_mask:0xf
    v_add_f32_dpp v188, v188, v188 quad_perm:[1,0,3,2] row_mask:0xf bank_mask:0xf
    v_add_f32_dpp v189, v189, v189 quad_perm:[1,0,3,2] row_mask:0xf bank_mask:0xf
    v_add_f32_dpp v192, v192, v192 quad_perm:[1,0,3,2] row_mask:0xf bank_mask:0xf
    v_add_f32_dpp v193, v193, v193 quad_perm:[1,0,3,2] row_mask:0xf bank_mask:0xf
    v_cndmask_b32 v188, v188, v192, s[56:57]
    v_cndmask_b32 v189, v189, v193, s[56:57]
    v_cndmask_b32 v188, v188, v189, s[58:59]
    buffer_atomic_add_f32 v188, v6, s[44:47], s38 offen offset:256
    s_mul_i32 s6, s30, 14336
    s_add_u32 s6, s6, 122880
    v_lshl_add_u32 v14, v0, 3, s6
    s_waitcnt lgkmcnt(0)
    v_mov_b32 v3, 1
    s_waitcnt vmcnt(0)
    s_mov_b64 exec, 1
    ds_add_u32 v254, v3 offset:24
    s_mov_b64 exec, -1
    v_pk_mul_f32 v[32:33], v[32:33], v[204:205] op_sel_hi:[1,0]
    v_pk_mul_f32 v[34:35], v[34:35], v[204:205] op_sel_hi:[1,0]
    v_pk_fma_f32 v[32:33], v[212:213], v[204:205], v[32:33] op_sel:[0,1,0]
    v_pk_fma_f32 v[34:35], v[214:215], v[204:205], v[34:35] op_sel:[0,1,0]
    v_pk_mul_f32 v[168:169], v[32:33], v[32:33]
    v_pk_mul_f32 v[170:171], v[34:35], v[34:35]
    v_pk_fma_f32 v[168:169], v[168:169], s[48:49], v[10:11]
    v_pk_fma_f32 v[170:171], v[170:171], s[48:49], v[10:11]
    v_pk_mul_f32 v[168:169], v[168:169], v[32:33]
    v_pk_mul_f32 v[170:171], v[170:171], v[34:35]
    v_exp_f32 v168, v168
    v_exp_f32 v169, v169
    v_exp_f32 v170, v170
    v_exp_f32 v171, v171
    s_nop 0
    v_pk_add_f32 v[168:169], v[168:169], 1.0 op_sel_hi:[1,0]
    v_pk_add_f32 v[170:171], v[170:171], 1.0 op_sel_hi:[1,0]
    v_rcp_f32 v168, v168
    v_rcp_f32 v169, v169
    v_rcp_f32 v170, v170
    v_rcp_f32 v171, v171
    s_nop 0
    v_pk_mul_f32 v[32:33], v[32:33], v[168:169]
    v_pk_mul_f32 v[34:35], v[34:35], v[170:171]
    v_cvt_pk_bf16_f32 v32, v32, v33
    v_cvt_pk_bf16_f32 v33, v34, v35
    ds_write_b64 v14, v[32:33] offset:0
    v_pk_mul_f32 v[36:37], v[36:37], v[204:205] op_sel_hi:[1,0]
    v_pk_mul_f32 v[38:39], v[38:39], v[204:205] op_sel_hi:[1,0]
    v_pk_fma_f32 v[36:37], v[216:217], v[204:205], v[36:37] op_sel:[0,1,0]
    v_pk_fma_f32 v[38:39], v[218:219], v[204:205], v[38:39] op_sel:[0,1,0]
    v_pk_mul_f32 v[168:169], v[36:37], v[36:37]
    v_pk_mul_f32 v[170:171], v[38:39], v[38:39]
    v_pk_fma_f32 v[168:169], v[168:169], s[48:49], v[10:11]
    v_pk_fma_f32 v[170:171], v[170:171], s[48:49], v[10:11]
    v_pk_mul_f32 v[168:169], v[168:169], v[36:37]
    v_pk_mul_f32 v[170:171], v[170:171], v[38:39]
    v_exp_f32 v168, v168
    v_exp_f32 v169, v169
    v_exp_f32 v170, v170
    v_exp_f32 v171, v171
    s_nop 0
    v_pk_add_f32 v[168:169], v[168:169], 1.0 op_sel_hi:[1,0]
    v_pk_add_f32 v[170:171], v[170:171], 1.0 op_sel_hi:[1,0]
    v_rcp_f32 v168, v168
    v_rcp_f32 v169, v169
    v_rcp_f32 v170, v170
    v_rcp_f32 v171, v171
    s_nop 0
    v_pk_mul_f32 v[36:37], v[36:37], v[168:169]
    v_pk_mul_f32 v[38:39], v[38:39], v[170:171]
    v_cvt_pk_bf16_f32 v36, v36, v37
    v_cvt_pk_bf16_f32 v37, v38, v39
    ds_write_b64 v14, v[36:37] offset:512
    v_pk_mul_f32 v[40:41], v[40:41], v[204:205] op_sel_hi:[1,0]
    v_pk_mul_f32 v[42:43], v[42:43], v[204:205] op_sel_hi:[1,0]
    v_pk_fma_f32 v[40:41], v[220:221], v[204:205], v[40:41] op_sel:[0,1,0]
    v_pk_fma_f32 v[42:43], v[222:223], v[204:205], v[42:43] op_sel:[0,1,0]
    v_pk_mul_f32 v[168:169], v[40:41], v[40:41]
    v_pk_mul_f32 v[170:171], v[42:43], v[42:43]
    v_pk_fma_f32 v[168:169], v[168:169], s[48:49], v[10:11]
    v_pk_fma_f32 v[170:171], v[170:171], s[48:49], v[10:11]
    v_pk_mul_f32 v[168:169], v[168:169], v[40:41]
    v_pk_mul_f32 v[170:171], v[170:171], v[42:43]
    v_exp_f32 v168, v168
    v_exp_f32 v169, v169
    v_exp_f32 v170, v170
    v_exp_f32 v171, v171
    s_nop 0
    v_pk_add_f32 v[168:169], v[168:169], 1.0 op_sel_hi:[1,0]
    v_pk_add_f32 v[170:171], v[170:171], 1.0 op_sel_hi:[1,0]
    v_rcp_f32 v168, v168
    v_rcp_f32 v169, v169
    v_rcp_f32 v170, v170
    v_rcp_f32 v171, v171
    s_nop 0
    v_pk_mul_f32 v[40:41], v[40:41], v[168:169]
    v_pk_mul_f32 v[42:43], v[42:43], v[170:171]
    v_cvt_pk_bf16_f32 v40, v40, v41
    v_cvt_pk_bf16_f32 v41, v42, v43
    ds_write_b64 v14, v[40:41] offset:1024
    v_pk_mul_f32 v[60:61], v[60:61], v[206:207] op_sel_hi:[1,0]
    v_pk_mul_f32 v[62:63], v[62:63], v[206:207] op_sel_hi:[1,0]
    v_pk_fma_f32 v[60:61], v[212:213], v[206:207], v[60:61] op_sel:[0,1,0]
    v_pk_fma_f32 v[62:63], v[214:215], v[206:207], v[62:63] op_sel:[0,1,0]
    v_pk_mul_f32 v[168:169], v[60:61], v[60:61]
    v_pk_mul_f32 v[170:171], v[62:63], v[62:63]
    v_pk_fma_f32 v[168:169], v[168:169], s[48:49], v[10:11]
    v_pk_fma_f32 v[170:171], v[170:171], s[48:49], v[10:11]
    v_pk_mul_f32 v[168:169], v[168:169], v[60:61]
    v_pk_mul_f32 v[170:171], v[170:171], v[62:63]
    v_exp_f32 v168, v168
    v_exp_f32 v169, v169
    v_exp_f32 v170, v170
    v_exp_f32 v171, v171
    s_nop 0
    v_pk_add_f32 v[168:169], v[168:169], 1.0 op_sel_hi:[1,0]
    v_pk_add_f32 v[170:171], v[170:171], 1.0 op_sel_hi:[1,0]
    v_rcp_f32 v168, v168
    v_rcp_f32 v169, v169
    v_rcp_f32 v170, v170
    v_rcp_f32 v171, v171
    s_nop 0
    v_pk_mul_f32 v[60:61], v[60:61], v[168:169]
    v_pk_mul_f32 v[62:63], v[62:63], v[170:171]
    v_cvt_pk_bf16_f32 v60, v60, v61
    v_cvt_pk_bf16_f32 v61, v62, v63
    ds_write_b64 v14, v[60:61] offset:3584
    v_pk_mul_f32 v[64:65], v[64:65], v[206:207] op_sel_hi:[1,0]
    v_pk_mul_f32 v[66:67], v[66:67], v[206:207] op_sel_hi:[1,0]
    v_pk_fma_f32 v[64:65], v[216:217], v[206:207], v[64:65] op_sel:[0,1,0]
    v_pk_fma_f32 v[66:67], v[218:219], v[206:207], v[66:67] op_sel:[0,1,0]
    v_pk_mul_f32 v[168:169], v[64:65], v[64:65]
    v_pk_mul_f32 v[170:171], v[66:67], v[66:67]
    v_pk_fma_f32 v[168:169], v[168:169], s[48:49], v[10:11]
    v_pk_fma_f32 v[170:171], v[170:171], s[48:49], v[10:11]
    v_pk_mul_f32 v[168:169], v[168:169], v[64:65]
    v_pk_mul_f32 v[170:171], v[170:171], v[66:67]
    v_exp_f32 v168, v168
    v_exp_f32 v169, v169
    v_exp_f32 v170, v170
    v_exp_f32 v171, v171
    s_nop 0
    v_pk_add_f32 v[168:169], v[168:169], 1.0 op_sel_hi:[1,0]
    v_pk_add_f32 v[170:171], v[170:171], 1.0 op_sel_hi:[1,0]
    v_rcp_f32 v168, v168
    v_rcp_f32 v169, v169
    v_rcp_f32 v170, v170
    v_rcp_f32 v171, v171
    s_nop 0
    v_pk_mul_f32 v[64:65], v[64:65], v[168:169]
    v_pk_mul_f32 v[66:67], v[66:67], v[170:171]
    v_cvt_pk_bf16_f32 v64, v64, v65
    v_cvt_pk_bf16_f32 v65, v66, v67
    ds_write_b64 v14, v[64:65] offset:4096
    v_pk_mul_f32 v[68:69], v[68:69], v[206:207] op_sel_hi:[1,0]
    v_pk_mul_f32 v[70:71], v[70:71], v[206:207] op_sel_hi:[1,0]
    v_pk_fma_f32 v[68:69], v[220:221], v[206:207], v[68:69] op_sel:[0,1,0]
    v_pk_fma_f32 v[70:71], v[222:223], v[206:207], v[70:71] op_sel:[0,1,0]
    v_pk_mul_f32 v[168:169], v[68:69], v[68:69]
    v_pk_mul_f32 v[170:171], v[70:71], v[70:71]
    v_pk_fma_f32 v[168:169], v[168:169], s[48:49], v[10:11]
    v_pk_fma_f32 v[170:171], v[170:171], s[48:49], v[10:11]
    v_pk_mul_f32 v[168:169], v[168:169], v[68:69]
    v_pk_mul_f32 v[170:171], v[170:171], v[70:71]
    v_exp_f32 v168, v168
    v_exp_f32 v169, v169
    v_exp_f32 v170, v170
    v_exp_f32 v171, v171
    s_nop 0
    v_pk_add_f32 v[168:169], v[168:169], 1.0 op_sel_hi:[1,0]
    v_pk_add_f32 v[170:171], v[170:171], 1.0 op_sel_hi:[1,0]
    v_rcp_f32 v168, v168
    v_rcp_f32 v169, v169
    v_rcp_f32 v170, v170
    v_rcp_f32 v171, v171
    s_nop 0
    v_pk_mul_f32 v[68:69], v[68:69], v[168:169]
    v_pk_mul_f32 v[70:71], v[70:71], v[170:171]
    v_cvt_pk_bf16_f32 v68, v68, v69
    v_cvt_pk_bf16_f32 v69, v70, v71
    ds_write_b64 v14, v[68:69] offset:4608
    v_pk_mul_f32 v[88:89], v[88:89], v[208:209] op_sel_hi:[1,0]
    v_pk_mul_f32 v[90:91], v[90:91], v[208:209] op_sel_hi:[1,0]
    v_pk_fma_f32 v[88:89], v[212:213], v[208:209], v[88:89] op_sel:[0,1,0]
    v_pk_fma_f32 v[90:91], v[214:215], v[208:209], v[90:91] op_sel:[0,1,0]
    v_pk_mul_f32 v[168:169], v[88:89], v[88:89]
    v_pk_mul_f32 v[170:171], v[90:91], v[90:91]
    v_pk_fma_f32 v[168:169], v[168:169], s[48:49], v[10:11]
    v_pk_fma_f32 v[170:171], v[170:171], s[48:49], v[10:11]
    v_pk_mul_f32 v[168:169], v[168:169], v[88:89]
    v_pk_mul_f32 v[170:171], v[170:171], v[90:91]
    v_exp_f32 v168, v168
    v_exp_f32 v169, v169
    v_exp_f32 v170, v170
    v_exp_f32 v171, v171
    s_nop 0
    v_pk_add_f32 v[168:169], v[168:169], 1.0 op_sel_hi:[1,0]
    v_pk_add_f32 v[170:171], v[170:171], 1.0 op_sel_hi:[1,0]
    v_rcp_f32 v168, v168
    v_rcp_f32 v169, v169
    v_rcp_f32 v170, v170
    v_rcp_f32 v171, v171
    s_nop 0
    v_pk_mul_f32 v[88:89], v[88:89], v[168:169]
    v_pk_mul_f32 v[90:91], v[90:91], v[170:171]
    v_cvt_pk_bf16_f32 v88, v88, v89
    v_cvt_pk_bf16_f32 v89, v90, v91
    ds_write_b64 v14, v[88:89] offset:7168
    v_pk_mul_f32 v[92:93], v[92:93], v[208:209] op_sel_hi:[1,0]
    v_pk_mul_f32 v[94:95], v[94:95], v[208:209] op_sel_hi:[1,0]
    v_pk_fma_f32 v[92:93], v[216:217], v[208:209], v[92:93] op_sel:[0,1,0]
    v_pk_fma_f32 v[94:95], v[218:219], v[208:209], v[94:95] op_sel:[0,1,0]
    v_pk_mul_f32 v[168:169], v[92:93], v[92:93]
    v_pk_mul_f32 v[170:171], v[94:95], v[94:95]
    v_pk_fma_f32 v[168:169], v[168:169], s[48:49], v[10:11]
    v_pk_fma_f32 v[170:171], v[170:171], s[48:49], v[10:11]
    v_pk_mul_f32 v[168:169], v[168:169], v[92:93]
    v_pk_mul_f32 v[170:171], v[170:171], v[94:95]
    v_exp_f32 v168, v168
    v_exp_f32 v169, v169
    v_exp_f32 v170, v170
    v_exp_f32 v171, v171
    s_nop 0
    v_pk_add_f32 v[168:169], v[168:169], 1.0 op_sel_hi:[1,0]
    v_pk_add_f32 v[170:171], v[170:171], 1.0 op_sel_hi:[1,0]
    v_rcp_f32 v168, v168
    v_rcp_f32 v169, v169
    v_rcp_f32 v170, v170
    v_rcp_f32 v171, v171
    s_nop 0
    v_pk_mul_f32 v[92:93], v[92:93], v[168:169]
    v_pk_mul_f32 v[94:95], v[94:95], v[170:171]
    v_cvt_pk_bf16_f32 v92, v92, v93
    v_cvt_pk_bf16_f32 v93, v94, v95
    ds_write_b64 v14, v[92:93] offset:7680
    v_pk_mul_f32 v[96:97], v[96:97], v[208:209] op_sel_hi:[1,0]
    v_pk_mul_f32 v[98:99], v[98:99], v[208:209] op_sel_hi:[1,0]
    v_pk_fma_f32 v[96:97], v[220:221], v[208:209], v[96:97] op_sel:[0,1,0]
    v_pk_fma_f32 v[98:99], v[222:223], v[208:209], v[98:99] op_sel:[0,1,0]
    v_pk_mul_f32 v[168:169], v[96:97], v[96:97]
    v_pk_mul_f32 v[170:171], v[98:99], v[98:99]
    v_pk_fma_f32 v[168:169], v[168:169], s[48:49], v[10:11]
    v_pk_fma_f32 v[170:171], v[170:171], s[48:49], v[10:11]
    v_pk_mul_f32 v[168:169], v[168:169], v[96:97]
    v_pk_mul_f32 v[170:171], v[170:171], v[98:99]
    v_exp_f32 v168, v168
    v_exp_f32 v169, v169
    v_exp_f32 v170, v170
    v_exp_f32 v171, v171
    s_nop 0
    v_pk_add_f32 v[168:169], v[168:169], 1.0 op_sel_hi:[1,0]
    v_pk_add_f32 v[170:171], v[170:171], 1.0 op_sel_hi:[1,0]
    v_rcp_f32 v168, v168
    v_rcp_f32 v169, v169
    v_rcp_f32 v170, v170
    v_rcp_f32 v171, v171
    s_nop 0
    v_pk_mul_f32 v[96:97], v[96:97], v[168:169]
    v_pk_mul_f32 v[98:99], v[98:99], v[170:171]
    v_cvt_pk_bf16_f32 v96, v96, v97
    v_cvt_pk_bf16_f32 v97, v98, v99
    ds_write_b64 v14, v[96:97] offset:8192
L_spin48:
    ds_read_b32 v6, v254 offset:28
    s_sub_u32 s37, s37, 1
    s_cselect_b32 s37, 0, s37
    s_cbranch_scc1 L_spin48x
    s_waitcnt lgkmcnt(0)
    v_readfirstlane_b32 s6, v6
    s_cmp_ge_u32 s6, 1
    s_cbranch_scc1 L_spin48x
    s_sleep 1
    s_branch L_spin48
L_spin48x:
    s_waitcnt lgkmcnt(0)
    v_lshlrev_b32 v7, 3, v0
    buffer_load_dwordx2 v[8:9], v7, s[44:47], s38 offen sc1
    s_lshl_b32 s7, s3, 9
    s_add_u32 s7, s7, 153600
    v_lshl_add_u32 v6, v0, 2, s7
    v_lshl_add_u32 v4, v2, 4, s7
    v_and_b32 v12, 1, v2
    v_lshlrev_b32 v12, 5, v12
    v_lshrrev_b32 v3, 1, v2
    v_lshl_add_u32 v12, v3, 4, v12
    v_lshlrev_b32 v12, 4, v12
    v_lshl_add_u32 v12, v1, 4, v12
    s_lshl_b32 s39, s5, 6
    s_lshl_b32 s7, s4, 2
    s_add_u32 s39, s39, s7
    s_lshl_b32 s7, s30, 1
    s_add_u32 s39, s39, s7
    s_mul_i32 s39, s39, 7168
    s_add_u32 s39, s39, 0
    v_pk_mul_f32 v[116:117], v[116:117], v[210:211] op_sel_hi:[1,0]
    v_pk_mul_f32 v[118:119], v[118:119], v[210:211] op_sel_hi:[1,0]
    v_pk_fma_f32 v[116:117], v[212:213], v[210:211], v[116:117] op_sel:[0,1,0]
    v_pk_fma_f32 v[118:119], v[214:215], v[210:211], v[118:119] op_sel:[0,1,0]
    v_pk_mul_f32 v[168:169], v[116:117], v[116:117]
    v_pk_mul_f32 v[170:171], v[118:119], v[118:119]
    v_pk_fma_f32 v[168:169], v[168:169], s[48:49], v[10:11]
    v_pk_fma_f32 v[170:171], v[170:171], s[48:49], v[10:11]
    v_pk_mul_f32 v[168:169], v[168:169], v[116:117]
    v_pk_mul_f32 v[170:171], v[170:171], v[118:119]
    v_exp_f32 v168, v168
    v_exp_f32 v169, v169
    v_exp_f32 v170, v170
    v_exp_f32 v171, v171
    s_nop 0
    v_pk_add_f32 v[168:169], v[168:169], 1.0 op_sel_hi:[1,0]
    v_pk_add_f32 v[170:171], v[170:171], 1.0 op_sel_hi:[1,0]
    v_rcp_f32 v168, v168
    v_rcp_f32 v169, v169
    v_rcp_f32 v170, v170
    v_rcp_f32 v171, v171
    s_nop 0
    v_pk_mul_f32 v[116:117], v[116:117], v[168:169]
    v_pk_mul_f32 v[118:119], v[118:119], v[170:171]
    v_cvt_pk_bf16_f32 v116, v116, v117
    v_cvt_pk_bf16_f32 v117, v118, v119
    ds_write_b64 v14, v[116:117] offset:10752
    v_pk_mul_f32 v[120:121], v[120:121], v[210:211] op_sel_hi:[1,0]
    v_pk_mul_f32 v[122:123], v[122:123], v[210:211] op_sel_hi:[1,0]
    v_pk_fma_f32 v[120:121], v[216:217], v[210:211], v[120:121] op_sel:[0,1,0]
    v_pk_fma_f32 v[122:123], v[218:219], v[210:211], v[122:123] op_sel:[0,1,0]
    v_pk_mul_f32 v[168:169], v[120:121], v[120:121]
    v_pk_mul_f32 v[170:171], v[122:123], v[122:123]
    v_pk_fma_f32 v[168:169], v[168:169], s[48:49], v[10:11]
    v_pk_fma_f32 v[170:171], v[170:171], s[48:49], v[10:11]
    v_pk_mul_f32 v[168:169], v[168:169], v[120:121]
    v_pk_mul_f32 v[170:171], v[170:171], v[122:123]
    v_exp_f32 v168, v168
    v_exp_f32 v169, v169
    v_exp_f32 v170, v170
    v_exp_f32 v171, v171
    s_nop 0
    v_pk_add_f32 v[168:169], v[168:169], 1.0 op_sel_hi:[1,0]
    v_pk_add_f32 v[170:171], v[170:171], 1.0 op_sel_hi:[1,0]
    v_rcp_f32 v168, v168
    v_rcp_f32 v169, v169
    v_rcp_f32 v170, v170
    v_rcp_f32 v171, v171
    s_nop 0
    v_pk_mul_f32 v[120:121], v[120:121], v[168:169]
    v_pk_mul_f32 v[122:123], v[122:123], v[170:171]
    v_cvt_pk_bf16_f32 v120, v120, v121
    v_cvt_pk_bf16_f32 v121, v122, v123
    ds_write_b64 v14, v[120:121] offset:11264
    v_pk_mul_f32 v[124:125], v[124:125], v[210:211] op_sel_hi:[1,0]
    v_pk_mul_f32 v[126:127], v[126:127], v[210:211] op_sel_hi:[1,0]
    v_pk_fma_f32 v[124:125], v[220:221], v[210:211], v[124:125] op_sel:[0,1,0]
    v_pk_fma_f32 v[126:127], v[222:223], v[210:211], v[126:127] op_sel:[0,1,0]
    v_pk_mul_f32 v[168:169], v[124:125], v[124:125]
    v_pk_mul_f32 v[170:171], v[126:127], v[126:127]
    v_pk_fma_f32 v[168:169], v[168:169], s[48:49], v[10:11]
    v_pk_fma_f32 v[170:171], v[170:171], s[48:49], v[10:11]
    v_pk_mul_f32 v[168:169], v[168:169], v[124:125]
    v_pk_mul_f32 v[170:171], v[170:171], v[126:127]
    v_exp_f32 v168, v168
    v_exp_f32 v169, v169
    v_exp_f32 v170, v170
    v_exp_f32 v171, v171
    s_nop 0
    v_pk_add_f32 v[168:169], v[168:169], 1.0 op_sel_hi:[1,0]
    v_pk_add_f32 v[170:171], v[170:171], 1.0 op_sel_hi:[1,0]
    v_rcp_f32 v168, v168
    v_rcp_f32 v169, v169
    v_rcp_f32 v170, v170
    v_rcp_f32 v171, v171
    s_nop 0
    v_pk_mul_f32 v[124:125], v[124:125], v[168:169]
    v_pk_mul_f32 v[126:127], v[126:127], v[170:171]
    v_cvt_pk_bf16_f32 v124, v124, v125
    v_cvt_pk_bf16_f32 v125, v126, v127
    ds_write_b64 v14, v[124:125] offset:11776
    s_waitcnt vmcnt(0)
    v_mul_f32 v3, 0x3a124925, v8
    v_mul_f32 v9, 0x3a124925, v9
    v_fma_f32 v9, -v3, v3, v9
    v_max_f32 v9, 0, v9
    v_add_f32 v9, 0x3727c5ac, v9
    v_rsq_f32 v8, v9
    s_nop 0
    v_mul_f32_e64 v9, -v3, v8
    ds_write_b32 v6, v8
    ds_write_b32 v6, v9 offset:256
    s_waitcnt lgkmcnt(0)
    ds_read_b128 v[128:131], v4 offset:0
    ds_read_b128 v[144:147], v4 offset:256
    ds_read_b128 v[132:135], v4 offset:64
    ds_read_b128 v[148:151], v4 offset:320
    ds_read_b128 v[136:139], v4 offset:128
    ds_read_b128 v[152:155], v4 offset:384
    ds_read_b128 v[140:143], v4 offset:192
    ds_read_b128 v[156:159], v4 offset:448
    s_waitcnt lgkmcnt(0)
    v_pk_fma_f32 v[16:17], v[16:17], v[128:129], v[144:145]
    v_pk_fma_f32 v[18:19], v[18:19], v[130:131], v[146:147]
    v_pk_fma_f32 v[44:45], v[44:45], v[132:133], v[148:149]
    v_pk_fma_f32 v[46:47], v[46:47], v[134:135], v[150:151]
    v_cvt_pk_bf16_f32 v172, v16, v17
    v_cvt_pk_bf16_f32 v173, v18, v19
    v_cvt_pk_bf16_f32 v174, v44, v45
    v_cvt_pk_bf16_f32 v175, v46, v47
    s_nop 1
    v_permlane16_swap_b32 v172, v174
    v_permlane16_swap_b32 v173, v175
    buffer_store_dwordx4 v[172:175], v12, s[16:19], s39 offen offset:0 sc1
    v_pk_fma_f32 v[20:21], v[20:21], v[128:129], v[144:145]
    v_pk_fma_f32 v[22:23], v[22:23], v[130:131], v[146:147]
    v_pk_fma_f32 v[48:49], v[48:49], v[132:133], v[148:149]
    v_pk_fma_f32 v[50:51], v[50:51], v[134:135], v[150:151]
    v_cvt_pk_bf16_f32 v176, v20, v21
    v_cvt_pk_bf16_f32 v177, v22, v23
    v_cvt_pk_bf16_f32 v178, v48, v49
    v_cvt_pk_bf16_f32 v179, v50, v51
    s_nop 1
    v_permlane16_swap_b32 v176, v178
    v_permlane16_swap_b32 v177, v179
    buffer_store_dwordx4 v[176:179], v12, s[16:19], s39 offen offset:1024 sc1
    v_pk_fma_f32 v[24:25], v[24:25], v[128:129], v[144:145]
    v_pk_fma_f32 v[26:27], v[26:27], v[130:131], v[146:147]
    v_pk_fma_f32 v[52:53], v[52:53], v[132:133], v[148:149]
    v_pk_fma_f32 v[54:55], v[54:55], v[134:135], v[150:151]
    v_cvt_pk_bf16_f32 v180, v24, v25
    v_cvt_pk_bf16_f32 v181, v26, v27
    v_cvt_pk_bf16_f32 v182, v52, v53
    v_cvt_pk_bf16_f32 v183, v54, v55
    s_nop 1
    v_permlane16_swap_b32 v180, v182
    v_permlane16_swap_b32 v181, v183
    buffer_store_dwordx4 v[180:183], v12, s[16:19], s39 offen offset:2048 sc1
    v_pk_fma_f32 v[28:29], v[28:29], v[128:129], v[144:145]
    v_pk_fma_f32 v[30:31], v[30:31], v[130:131], v[146:147]
    v_pk_fma_f32 v[56:57], v[56:57], v[132:133], v[148:149]
    v_pk_fma_f32 v[58:59], v[58:59], v[134:135], v[150:151]
    v_cvt_pk_bf16_f32 v184, v28, v29
    v_cvt_pk_bf16_f32 v185, v30, v31
    v_cvt_pk_bf16_f32 v186, v56, v57
    v_cvt_pk_bf16_f32 v187, v58, v59
    s_nop 1
    v_permlane16_swap_b32 v184, v186
    v_permlane16_swap_b32 v185, v187
    buffer_store_dwordx4 v[184:187], v12, s[16:19], s39 offen offset:3072 sc1
    s_add_u32 s39, s39, 7168
    v_pk_fma_f32 v[72:73], v[72:73], v[136:137], v[152:153]
    v_pk_fma_f32 v[74:75], v[74:75], v[138:139], v[154:155]
    v_pk_fma_f32 v[100:101], v[100:101], v[140:141], v[156:157]
    v_pk_fma_f32 v[102:103], v[102:103], v[142:143], v[158:159]
    v_cvt_pk_bf16_f32 v188, v72, v73
    v_cvt_pk_bf16_f32 v189, v74, v75
    v_cvt_pk_bf16_f32 v190, v100, v101
    v_cvt_pk_bf16_f32 v191, v102, v103
    s_nop 1
    v_permlane16_swap_b32 v188, v190
    v_permlane16_swap_b32 v189, v191
    buffer_store_dwordx4 v[188:191], v12, s[16:19], s39 offen offset:0 sc1
    v_pk_fma_f32 v[76:77], v[76:77], v[136:137], v[152:153]
    v_pk_fma_f32 v[78:79], v[78:79], v[138:139], v[154:155]
    v_pk_fma_f32 v[104:105], v[104:105], v[140:141], v[156:157]
    v_pk_fma_f32 v[106:107], v[106:107], v[142:143], v[158:159]
    v_cvt_pk_bf16_f32 v192, v76, v77
    v_cvt_pk_bf16_f32 v193, v78, v79
    v_cvt_pk_bf16_f32 v194, v104, v105
    v_cvt_pk_bf16_f32 v195, v106, v107
    s_nop 1
    v_permlane16_swap_b32 v192, v194
    v_permlane16_swap_b32 v193, v195
    buffer_store_dwordx4 v[192:195], v12, s[16:19], s39 offen offset:1024 sc1
    v_pk_fma_f32 v[80:81], v[80:81], v[136:137], v[152:153]
    v_pk_fma_f32 v[82:83], v[82:83], v[138:139], v[154:155]
    v_pk_fma_f32 v[108:109], v[108:109], v[140:141], v[156:157]
    v_pk_fma_f32 v[110:111], v[110:111], v[142:143], v[158:159]
    v_cvt_pk_bf16_f32 v196, v80, v81
    v_cvt_pk_bf16_f32 v197, v82, v83
    v_cvt_pk_bf16_f32 v198, v108, v109
    v_cvt_pk_bf16_f32 v199, v110, v111
    s_nop 1
    v_permlane16_swap_b32 v196, v198
    v_permlane16_swap_b32 v197, v199
    buffer_store_dwordx4 v[196:199], v12, s[16:19], s39 offen offset:2048 sc1
    v_pk_fma_f32 v[84:85], v[84:85], v[136:137], v[152:153]
    v_pk_fma_f32 v[86:87], v[86:87], v[138:139], v[154:155]
    v_pk_fma_f32 v[112:113], v[112:113], v[140:141], v[156:157]
    v_pk_fma_f32 v[114:115], v[114:115], v[142:143], v[158:159]
    v_cvt_pk_bf16_f32 v200, v84, v85
    v_cvt_pk_bf16_f32 v201, v86, v87
    v_cvt_pk_bf16_f32 v202, v112, v113
    v_cvt_pk_bf16_f32 v203, v114, v115
    s_nop 1
    v_permlane16_swap_b32 v200, v202
    v_permlane16_swap_b32 v201, v203
    buffer_store_dwordx4 v[200:203], v12, s[16:19], s39 offen offset:3072 sc1
    s_add_u32 s39, s39, 7168
    v_mov_b32 v3, 1
    s_waitcnt vmcnt(0)
    s_mov_b64 exec, 1
    ds_add_u32 v254, v3 offset:32
    s_mov_b64 exec, -1
    s_branch L_ce
L_d1:
    s_barrier
    ds_read_b128 v[128:131], v4 offset:0
    ds_read_b128 v[132:135], v4 offset:1024
    ds_read_b128 v[136:139], v4 offset:2048
    ds_read_b128 v[140:143], v4 offset:3072
    ds_read_b128 v[144:147], v6 offset:0
    ds_read_b128 v[148:151], v6 offset:1024
    ds_read_b128 v[152:155], v6 offset:2048
    ds_read_b128 v[156:159], v6 offset:3072
    ds_read_b128 v[160:163], v6 offset:4096
    ds_read_b128 v[164:167], v6 offset:5120
    ds_read_b128 v[168:171], v6 offset:6144
    s_mov_b32 s36, 16
    s_branch L_dmidb
    .p2align 4
L_dloopb:
    s_barrier
    v_mfma_f32_16x16x32_bf16 v[16:19], v[172:175], v[188:191], v[16:19]
    ds_read_b128 v[128:131], v4 offset:0
    v_mfma_f32_16x16x32_bf16 v[44:47], v[176:179], v[188:191], v[44:47]
    ds_read_b128 v[132:135], v4 offset:1024
    v_mfma_f32_16x16x32_bf16 v[72:75], v[180:183], v[188:191], v[72:75]
    ds_read_b128 v[136:139], v4 offset:2048
    v_mfma_f32_16x16x32_bf16 v[100:103], v[184:187], v[188:191], v[100:103]
    ds_read_b128 v[140:143], v4 offset:3072
    v_mfma_f32_16x16x32_bf16 v[20:23], v[172:175], v[192:195], v[20:23]
    ds_read_b128 v[144:147], v6 offset:0
    v_mfma_f32_16x16x32_bf16 v[48:51], v[176:179], v[192:195], v[48:51]
    ds_read_b128 v[148:151], v6 offset:1024
    v_mfma_f32_16x16x32_bf16 v[76:79], v[180:183], v[192:195], v[76:79]
    ds_read_b128 v[152:155], v6 offset:2048
    v_mfma_f32_16x16x32_bf16 v[104:107], v[184:187], v[192:195], v[104:107]
    ds_read_b128 v[156:159], v6 offset:3072
    v_mfma_f32_16x16x32_bf16 v[24:27], v[172:175], v[196:199], v[24:27]
    ds_read_b128 v[160:163], v6 offset:4096
    v_mfma_f32_16x16x32_bf16 v[52:55], v[176:179], v[196:199], v[52:55]
    ds_read_b128 v[164:167], v6 offset:5120
    v_mfma_f32_16x16x32_bf16 v[80:83], v[180:183], v[196:199], v[80:83]
    ds_read_b128 v[168:171], v6 offset:6144
    v_mfma_f32_16x16x32_bf16 v[108:111], v[184:187], v[196:199], v[108:111]
    v_mfma_f32_16x16x32_bf16 v[28:31], v[200:203], v[172:175], v[28:31]
    v_mfma_f32_16x16x32_bf16 v[56:59], v[200:203], v[176:179], v[56:59]
    v_mfma_f32_16x16x32_bf16 v[84:87], v[200:203], v[180:183], v[84:87]
    v_mfma_f32_16x16x32_bf16 v[112:115], v[200:203], v[184:187], v[112:115]
    v_mfma_f32_16x16x32_bf16 v[32:35], v[204:207], v[172:175], v[32:35]
    v_mfma_f32_16x16x32_bf16 v[60:63], v[204:207], v[176:179], v[60:63]
    v_mfma_f32_16x16x32_bf16 v[88:91], v[204:207], v[180:183], v[88:91]
    v_mfma_f32_16x16x32_bf16 v[116:119], v[204:207], v[184:187], v[116:119]
    v_mfma_f32_16x16x32_bf16 v[36:39], v[208:211], v[172:175], v[36:39]
    v_mfma_f32_16x16x32_bf16 v[64:67], v[208:211], v[176:179], v[64:67]
    v_mfma_f32_16x16x32_bf16 v[92:95], v[208:211], v[180:183], v[92:95]
    v_mfma_f32_16x16x32_bf16 v[120:123], v[208:211], v[184:187], v[120:123]
    v_mfma_f32_16x16x32_bf16 v[40:43], v[212:215], v[172:175], v[40:43]
    v_mfma_f32_16x16x32_bf16 v[68:71], v[212:215], v[176:179], v[68:71]
    v_mfma_f32_16x16x32_bf16 v[96:99], v[212:215], v[180:183], v[96:99]
    v_mfma_f32_16x16x32_bf16 v[124:127], v[212:215], v[184:187], v[124:127]
L_dmidb:
    s_waitcnt lgkmcnt(0)
    v_mfma_f32_16x16x32_bf16 v[16:19], v[128:131], v[144:147], v[16:19]
    ds_read_b128 v[172:175], v5 offset:0
    v_mfma_f32_16x16x32_bf16 v[44:47], v[132:135], v[144:147], v[44:47]
    ds_read_b128 v[176:179], v5 offset:1024
    v_mfma_f32_16x16x32_bf16 v[72:75], v[136:139], v[144:147], v[72:75]
    ds_read_b128 v[180:183], v5 offset:2048
    v_mfma_f32_16x16x32_bf16 v[100:103], v[140:143], v[144:147], v[100:103]
    ds_read_b128 v[184:187], v5 offset:3072
    v_mfma_f32_16x16x32_bf16 v[20:23], v[128:131], v[148:151], v[20:23]
    ds_read_b128 v[188:191], v6 offset:14336
    v_mfma_f32_16x16x32_bf16 v[48:51], v[132:135], v[148:151], v[48:51]
    ds_read_b128 v[192:195], v6 offset:15360
    v_mfma_f32_16x16x32_bf16 v[76:79], v[136:139], v[148:151], v[76:79]
    ds_read_b128 v[196:199], v6 offset:16384
    v_mfma_f32_16x16x32_bf16 v[104:107], v[140:143], v[148:151], v[104:107]
    ds_read_b128 v[200:203], v6 offset:17408
    v_mfma_f32_16x16x32_bf16 v[24:27], v[128:131], v[152:155], v[24:27]
    ds_read_b128 v[204:207], v6 offset:18432
    v_mfma_f32_16x16x32_bf16 v[52:55], v[132:135], v[152:155], v[52:55]
    ds_read_b128 v[208:211], v6 offset:19456
    v_mfma_f32_16x16x32_bf16 v[80:83], v[136:139], v[152:155], v[80:83]
    ds_read_b128 v[212:215], v6 offset:20480
    v_mfma_f32_16x16x32_bf16 v[108:111], v[140:143], v[152:155], v[108:111]
    s_add_u32 s32, s32, 1
    s_cmp_eq_u32 s32, 3
    v_mfma_f32_16x16x32_bf16 v[28:31], v[156:159], v[128:131], v[28:31]
    s_mov_b32 s6, 45056
    s_cselect_b32 s6, -90112, s6
    v_mfma_f32_16x16x32_bf16 v[56:59], v[156:159], v[132:135], v[56:59]
    s_cselect_b32 s32, 0, s32
    v_add_u32 v4, s6, v4
    v_mfma_f32_16x16x32_bf16 v[84:87], v[156:159], v[136:139], v[84:87]
    v_add_u32 v5, s6, v5
    v_add_u32 v6, s6, v6
    v_mfma_f32_16x16x32_bf16 v[112:115], v[156:159], v[140:143], v[112:115]
    s_sub_u32 s36, s36, 1
    s_cmp_lg_u32 s36, 0
    v_mfma_f32_16x16x32_bf16 v[32:35], v[160:163], v[128:131], v[32:35]
    v_mfma_f32_16x16x32_bf16 v[60:63], v[160:163], v[132:135], v[60:63]
    v_mfma_f32_16x16x32_bf16 v[88:91], v[160:163], v[136:139], v[88:91]
    v_mfma_f32_16x16x32_bf16 v[116:119], v[160:163], v[140:143], v[116:119]
    v_mfma_f32_16x16x32_bf16 v[36:39], v[164:167], v[128:131], v[36:39]
    v_mfma_f32_16x16x32_bf16 v[64:67], v[164:167], v[132:135], v[64:67]
    v_mfma_f32_16x16x32_bf16 v[92:95], v[164:167], v[136:139], v[92:95]
    v_mfma_f32_16x16x32_bf16 v[120:123], v[164:167], v[140:143], v[120:123]
    v_mfma_f32_16x16x32_bf16 v[40:43], v[168:171], v[128:131], v[40:43]
    v_mfma_f32_16x16x32_bf16 v[68:71], v[168:171], v[132:135], v[68:71]
    v_mfma_f32_16x16x32_bf16 v[96:99], v[168:171], v[136:139], v[96:99]
    v_mfma_f32_16x16x32_bf16 v[124:127], v[168:171], v[140:143], v[124:127]
    s_waitcnt lgkmcnt(0)
    s_cbranch_scc1 L_dloopb
    s_barrier
    v_mfma_f32_16x16x32_bf16 v[16:19], v[172:175], v[188:191], v[16:19]
    v_mfma_f32_16x16x32_bf16 v[44:47], v[176:179], v[188:191], v[44:47]
    v_mfma_f32_16x16x32_bf16 v[72:75], v[180:183], v[188:191], v[72:75]
    v_mfma_f32_16x16x32_bf16 v[100:103], v[184:187], v[188:191], v[100:103]
    v_mfma_f32_16x16x32_bf16 v[20:23], v[172:175], v[192:195], v[20:23]
    v_mfma_f32_16x16x32_bf16 v[48:51], v[176:179], v[192:195], v[48:51]
    v_mfma_f32_16x16x32_bf16 v[76:79], v[180:183], v[192:195], v[76:79]
    v_mfma_f32_16x16x32_bf16 v[104:107], v[184:187], v[192:195], v[104:107]
    v_mfma_f32_16x16x32_bf16 v[24:27], v[172:175], v[196:199], v[24:27]
    v_mfma_f32_16x16x32_bf16 v[52:55], v[176:179], v[196:199], v[52:55]
    v_mfma_f32_16x16x32_bf16 v[80:83], v[180:183], v[196:199], v[80:83]
    v_mfma_f32_16x16x32_bf16 v[108:111], v[184:187], v[196:199], v[108:111]
    v_mfma_f32_16x16x32_bf16 v[28:31], v[200:203], v[172:175], v[28:31]
    v_mfma_f32_16x16x32_bf16 v[56:59], v[200:203], v[176:179], v[56:59]
    v_mfma_f32_16x16x32_bf16 v[84:87], v[200:203], v[180:183], v[84:87]
    v_mfma_f32_16x16x32_bf16 v[112:115], v[200:203], v[184:187], v[112:115]
    v_mfma_f32_16x16x32_bf16 v[32:35], v[204:207], v[172:175], v[32:35]
    v_mfma_f32_16x16x32_bf16 v[60:63], v[204:207], v[176:179], v[60:63]
    v_mfma_f32_16x16x32_bf16 v[88:91], v[204:207], v[180:183], v[88:91]
    v_mfma_f32_16x16x32_bf16 v[116:119], v[204:207], v[184:187], v[116:119]
    v_mfma_f32_16x16x32_bf16 v[36:39], v[208:211], v[172:175], v[36:39]
    v_mfma_f32_16x16x32_bf16 v[64:67], v[208:211], v[176:179], v[64:67]
    v_mfma_f32_16x16x32_bf16 v[92:95], v[208:211], v[180:183], v[92:95]
    v_mfma_f32_16x16x32_bf16 v[120:123], v[208:211], v[184:187], v[120:123]
    v_mfma_f32_16x16x32_bf16 v[40:43], v[212:215], v[172:175], v[40:43]
    v_mfma_f32_16x16x32_bf16 v[68:71], v[212:215], v[176:179], v[68:71]
    v_mfma_f32_16x16x32_bf16 v[96:99], v[212:215], v[180:183], v[96:99]
    v_mfma_f32_16x16x32_bf16 v[124:127], v[212:215], v[184:187], v[124:127]
    s_nop 7
    s_lshl_b32 s6, s30, 8
    s_add_u32 s6, s6, 151552
    v_lshl_add_u32 v4, v2, 4, s6
    v_lshl_add_u32 v14, v1, 2, s6
    s_mov_b32 s6, 153024
    v_lshl_add_u32 v5, v1, 2, s6
    v_lshl_add_u32 v15, v2, 4, s6
    v_mov_b32 v10, 0xc0135761
    v_mov_b32 v11, v10
    ds_read_b128 v[128:131], v4 offset:0
    ds_read_b128 v[144:147], v4 offset:512
    ds_read_b128 v[132:135], v4 offset:64
    ds_read_b128 v[148:151], v4 offset:576
    ds_read_b128 v[136:139], v4 offset:128
    ds_read_b128 v[152:155], v4 offset:640
    ds_read_b128 v[140:143], v4 offset:192
    ds_read_b128 v[156:159], v4 offset:704
    ds_read_b32 v160, v5 offset:0
    ds_read_b32 v162, v5 offset:64
    ds_read_b32 v164, v5 offset:128
    s_waitcnt lgkmcnt(0)
    ds_read_b32 v204, v14 offset:0
    ds_read_b32 v205, v14 offset:512
    ds_read_b32 v206, v14 offset:64
    ds_read_b32 v207, v14 offset:576
    ds_read_b32 v208, v14 offset:128
    ds_read_b32 v209, v14 offset:640
    ds_read_b32 v210, v14 offset:192
    ds_read_b32 v211, v14 offset:704
    ds_read_b128 v[212:215], v15 offset:192
    ds_read_b128 v[216:219], v15 offset:256
    ds_read_b128 v[220:223], v15 offset:320
    ds_read_b128 v[224:227], v15 offset:384
    v_pk_mul_f32 v[16:17], v[16:17], v[128:129]
    v_pk_mul_f32 v[18:19], v[18:19], v[130:131]
    v_pk_fma_f32 v[16:17], v[144:145], v[160:161], v[16:17] op_sel_hi:[1,0,1]
    v_pk_fma_f32 v[18:19], v[146:147], v[160:161], v[18:19] op_sel_hi:[1,0,1]
    v_pk_mul_f32 v[168:169], v[16:17], v[16:17]
    v_pk_mul_f32 v[170:171], v[18:19], v[18:19]
    v_pk_fma_f32 v[168:169], v[168:169], s[48:49], v[10:11]
    v_pk_fma_f32 v[170:171], v[170:171], s[48:49], v[10:11]
    v_pk_mul_f32 v[168:169], v[168:169], v[16:17]
    v_pk_mul_f32 v[170:171], v[170:171], v[18:19]
    v_exp_f32 v168, v168
    v_exp_f32 v169, v169
    v_exp_f32 v170, v170
    v_exp_f32 v171, v171
    s_nop 0
    v_pk_add_f32 v[168:169], v[168:169], 1.0 op_sel_hi:[1,0]
    v_pk_add_f32 v[170:171], v[170:171], 1.0 op_sel_hi:[1,0]
    v_rcp_f32 v168, v168
    v_rcp_f32 v169, v169
    v_rcp_f32 v170, v170
    v_rcp_f32 v171, v171
    s_nop 0
    v_pk_mul_f32 v[16:17], v[16:17], v[168:169]
    v_pk_mul_f32 v[18:19], v[18:19], v[170:171]
    v_mov_b32 v172, v16
    v_mov_b32 v173, v17
    v_pk_mul_f32 v[176:177], v[16:17], v[16:17]
    v_mov_b32 v174, v18
    v_mov_b32 v175, v19
    v_pk_mul_f32 v[178:179], v[18:19], v[18:19]
    v_pk_mul_f32 v[20:21], v[20:21], v[128:129]
    v_pk_mul_f32 v[22:23], v[22:23], v[130:131]
    v_pk_fma_f32 v[20:21], v[144:145], v[162:163], v[20:21] op_sel_hi:[1,0,1]
    v_pk_fma_f32 v[22:23], v[146:147], v[162:163], v[22:23] op_sel_hi:[1,0,1]
    v_pk_mul_f32 v[168:169], v[20:21], v[20:21]
    v_pk_mul_f32 v[170:171], v[22:23], v[22:23]
    v_pk_fma_f32 v[168:169], v[168:169], s[48:49], v[10:11]
    v_pk_fma_f32 v[170:171], v[170:171], s[48:49], v[10:11]
    v_pk_mul_f32 v[168:169], v[168:169], v[20:21]
    v_pk_mul_f32 v[170:171], v[170:171], v[22:23]
    v_exp_f32 v168, v168
    v_exp_f32 v169, v169
    v_exp_f32 v170, v170
    v_exp_f32 v171, v171
    s_nop 0
    v_pk_add_f32 v[168:169], v[168:169], 1.0 op_sel_hi:[1,0]
    v_pk_add_f32 v[170:171], v[170:171], 1.0 op_sel_hi:[1,0]
    v_rcp_f32 v168, v168
    v_rcp_f32 v169, v169
    v_rcp_f32 v170, v170
    v_rcp_f32 v171, v171
    s_nop 0
    v_pk_mul_f32 v[20:21], v[20:21], v[168:169]
    v_pk_mul_f32 v[22:23], v[22:23], v[170:171]
    v_pk_add_f32 v[172:173], v[172:173], v[20:21]
    v_pk_fma_f32 v[176:177], v[20:21], v[20:21], v[176:177]
    v_pk_add_f32 v[174:175], v[174:175], v[22:23]
    v_pk_fma_f32 v[178:179], v[22:23], v[22:23], v[178:179]
    v_pk_mul_f32 v[24:25], v[24:25], v[128:129]
    v_pk_mul_f32 v[26:27], v[26:27], v[130:131]
    v_pk_fma_f32 v[24:25], v[144:145], v[164:165], v[24:25] op_sel_hi:[1,0,1]
    v_pk_fma_f32 v[26:27], v[146:147], v[164:165], v[26:27] op_sel_hi:[1,0,1]
    v_pk_mul_f32 v[168:169], v[24:25], v[24:25]
    v_pk_mul_f32 v[170:171], v[26:27], v[26:27]
    v_pk_fma_f32 v[168:169], v[168:169], s[48:49], v[10:11]
    v_pk_fma_f32 v[170:171], v[170:171], s[48:49], v[10:11]
    v_pk_mul_f32 v[168:169], v[168:169], v[24:25]
    v_pk_mul_f32 v[170:171], v[170:171], v[26:27]
    v_exp_f32 v168, v168
    v_exp_f32 v169, v169
    v_exp_f32 v170, v170
    v_exp_f32 v171, v171
    s_nop 0
    v_pk_add_f32 v[168:169], v[168:169], 1.0 op_sel_hi:[1,0]
    v_pk_add_f32 v[170:171], v[170:171], 1.0 op_sel_hi:[1,0]
    v_rcp_f32 v168, v168
    v_rcp_f32 v169, v169
    v_rcp_f32 v170, v170
    v_rcp_f32 v171, v171
    s_nop 0
    v_pk_mul_f32 v[24:25], v[24:25], v[168:169]
    v_pk_mul_f32 v[26:27], v[26:27], v[170:171]
    v_pk_add_f32 v[172:173], v[172:173], v[24:25]
    v_pk_fma_f32 v[176:177], v[24:25], v[24:25], v[176:177]
    v_pk_add_f32 v[174:175], v[174:175], v[26:27]
    v_pk_fma_f32 v[178:179], v[26:27], v[26:27], v[178:179]
    v_pk_mul_f32 v[44:45], v[44:45], v[132:133]
    v_pk_mul_f32 v[46:47], v[46:47], v[134:135]
    v_pk_fma_f32 v[44:45], v[148:149], v[160:161], v[44:45] op_sel_hi:[1,0,1]
    v_pk_fma_f32 v[46:47], v[150:151], v[160:161], v[46:47] op_sel_hi:[1,0,1]
    v_pk_mul_f32 v[168:169], v[44:45], v[44:45]
    v_pk_mul_f32 v[170:171], v[46:47], v[46:47]
    v_pk_fma_f32 v[168:169], v[168:169], s[48:49], v[10:11]
    v_pk_fma_f32 v[170:171], v[170:171], s[48:49], v[10:11]
    v_pk_mul_f32 v[168:169], v[168:169], v[44:45]
    v_pk_mul_f32 v[170:171], v[170:171], v[46:47]
    v_exp_f32 v168, v168
    v_exp_f32 v169, v169
    v_exp_f32 v170, v170
    v_exp_f32 v171, v171
    s_nop 0
    v_pk_add_f32 v[168:169], v[168:169], 1.0 op_sel_hi:[1,0]
    v_pk_add_f32 v[170:171], v[170:171], 1.0 op_sel_hi:[1,0]
    v_rcp_f32 v168, v168
    v_rcp_f32 v169, v169
    v_rcp_f32 v170, v170
    v_rcp_f32 v171, v171
    s_nop 0
    v_pk_mul_f32 v[44:45], v[44:45], v[168:169]
    v_pk_mul_f32 v[46:47], v[46:47], v[170:171]
    v_mov_b32 v180, v44
    v_mov_b32 v181, v45
    v_pk_mul_f32 v[184:185], v[44:45], v[44:45]
    v_mov_b32 v182, v46
    v_mov_b32 v183, v47
    v_pk_mul_f32 v[186:187], v[46:47], v[46:47]
    v_pk_mul_f32 v[48:49], v[48:49], v[132:133]
    v_pk_mul_f32 v[50:51], v[50:51], v[134:135]
    v_pk_fma_f32 v[48:49], v[148:149], v[162:163], v[48:49] op_sel_hi:[1,0,1]
    v_pk_fma_f32 v[50:51], v[150:151], v[162:163], v[50:51] op_sel_hi:[1,0,1]
    v_pk_mul_f32 v[168:169], v[48:49], v[48:49]
    v_pk_mul_f32 v[170:171], v[50:51], v[50:51]
    v_pk_fma_f32 v[168:169], v[168:169], s[48:49], v[10:11]
    v_pk_fma_f32 v[170:171], v[170:171], s[48:49], v[10:11]
    v_pk_mul_f32 v[168:169], v[168:169], v[48:49]
    v_pk_mul_f32 v[170:171], v[170:171], v[50:51]
    v_exp_f32 v168, v168
    v_exp_f32 v169, v169
    v_exp_f32 v170, v170
    v_exp_f32 v171, v171
    s_nop 0
    v_pk_add_f32 v[168:169], v[168:169], 1.0 op_sel_hi:[1,0]
    v_pk_add_f32 v[170:171], v[170:171], 1.0 op_sel_hi:[1,0]
    v_rcp_f32 v168, v168
    v_rcp_f32 v169, v169
    v_rcp_f32 v170, v170
    v_rcp_f32 v171, v171
    s_nop 0
    v_pk_mul_f32 v[48:49], v[48:49], v[168:169]
    v_pk_mul_f32 v[50:51], v[50:51], v[170:171]
    v_pk_add_f32 v[180:181], v[180:181], v[48:49]
    v_pk_fma_f32 v[184:185], v[48:49], v[48:49], v[184:185]
    v_pk_add_f32 v[182:183], v[182:183], v[50:51]
    v_pk_fma_f32 v[186:187], v[50:51], v[50:51], v[186:187]
    v_pk_mul_f32 v[52:53], v[52:53], v[132:133]
    v_pk_mul_f32 v[54:55], v[54:55], v[134:135]
    v_pk_fma_f32 v[52:53], v[148:149], v[164:165], v[52:53] op_sel_hi:[1,0,1]
    v_pk_fma_f32 v[54:55], v[150:151], v[164:165], v[54:55] op_sel_hi:[1,0,1]
    v_pk_mul_f32 v[168:169], v[52:53], v[52:53]
    v_pk_mul_f32 v[170:171], v[54:55], v[54:55]
    v_pk_fma_f32 v[168:169], v[168:169], s[48:49], v[10:11]
    v_pk_fma_f32 v[170:171], v[170:171], s[48:49], v[10:11]
    v_pk_mul_f32 v[168:169], v[168:169], v[52:53]
    v_pk_mul_f32 v[170:171], v[170:171], v[54:55]
    v_exp_f32 v168, v168
    v_exp_f32 v169, v169
    v_exp_f32 v170, v170
    v_exp_f32 v171, v171
    s_nop 0
    v_pk_add_f32 v[168:169], v[168:169], 1.0 op_sel_hi:[1,0]
    v_pk_add_f32 v[170:171], v[170:171], 1.0 op_sel_hi:[1,0]
    v_rcp_f32 v168, v168
    v_rcp_f32 v169, v169
    v_rcp_f32 v170, v170
    v_rcp_f32 v171, v171
    s_nop 0
    v_pk_mul_f32 v[52:53], v[52:53], v[168:169]
    v_pk_mul_f32 v[54:55], v[54:55], v[170:171]
    v_pk_add_f32 v[180:181], v[180:181], v[52:53]
    v_pk_fma_f32 v[184:185], v[52:53], v[52:53], v[184:185]
    v_pk_add_f32 v[182:183], v[182:183], v[54:55]
    v_pk_fma_f32 v[186:187], v[54:55], v[54:55], v[186:187]
    v_pk_mul_f32 v[72:73], v[72:73], v[136:137]
    v_pk_mul_f32 v[74:75], v[74:75], v[138:139]
    v_pk_fma_f32 v[72:73], v[152:153], v[160:161], v[72:73] op_sel_hi:[1,0,1]
    v_pk_fma_f32 v[74:75], v[154:155], v[160:161], v[74:75] op_sel_hi:[1,0,1]
    v_pk_mul_f32 v[168:169], v[72:73], v[72:73]
    v_pk_mul_f32 v[170:171], v[74:75], v[74:75]
    v_pk_fma_f32 v[168:169], v[168:169], s[48:49], v[10:11]
    v_pk_fma_f32 v[170:171], v[170:171], s[48:49], v[10:11]
    v_pk_mul_f32 v[168:169], v[168:169], v[72:73]
    v_pk_mul_f32 v[170:171], v[170:171], v[74:75]
    v_exp_f32 v168, v168
    v_exp_f32 v169, v169
    v_exp_f32 v170, v170
    v_exp_f32 v171, v171
    s_nop 0
    v_pk_add_f32 v[168:169], v[168:169], 1.0 op_sel_hi:[1,0]
    v_pk_add_f32 v[170:171], v[170:171], 1.0 op_sel_hi:[1,0]
    v_rcp_f32 v168, v168
    v_rcp_f32 v169, v169
    v_rcp_f32 v170, v170
    v_rcp_f32 v171, v171
    s_nop 0
    v_pk_mul_f32 v[72:73], v[72:73], v[168:169]
    v_pk_mul_f32 v[74:75], v[74:75], v[170:171]
    v_mov_b32 v188, v72
    v_mov_b32 v189, v73
    v_pk_mul_f32 v[192:193], v[72:73], v[72:73]
    v_mov_b32 v190, v74
    v_mov_b32 v191, v75
    v_pk_mul_f32 v[194:195], v[74:75], v[74:75]
    v_pk_mul_f32 v[76:77], v[76:77], v[136:137]
    v_pk_mul_f32 v[78:79], v[78:79], v[138:139]
    v_pk_fma_f32 v[76:77], v[152:153], v[162:163], v[76:77] op_sel_hi:[1,0,1]
    v_pk_fma_f32 v[78:79], v[154:155], v[162:163], v[78:79] op_sel_hi:[1,0,1]
    v_pk_mul_f32 v[168:169], v[76:77], v[76:77]
    v_pk_mul_f32 v[170:171], v[78:79], v[78:79]
    v_pk_fma_f32 v[168:169], v[168:169], s[48:49], v[10:11]
    v_pk_fma_f32 v[170:171], v[170:171], s[48:49], v[10:11]
    v_pk_mul_f32 v[168:169], v[168:169], v[76:77]
    v_pk_mul_f32 v[170:171], v[170:171], v[78:79]
    v_exp_f32 v168, v168
    v_exp_f32 v169, v169
    v_exp_f32 v170, v170
    v_exp_f32 v171, v171
    s_nop 0
    v_pk_add_f32 v[168:169], v[168:169], 1.0 op_sel_hi:[1,0]
    v_pk_add_f32 v[170:171], v[170:171], 1.0 op_sel_hi:[1,0]
    v_rcp_f32 v168, v168
    v_rcp_f32 v169, v169
    v_rcp_f32 v170, v170
    v_rcp_f32 v171, v171
    s_nop 0
    v_pk_mul_f32 v[76:77], v[76:77], v[168:169]
    v_pk_mul_f32 v[78:79], v[78:79], v[170:171]
    v_pk_add_f32 v[188:189], v[188:189], v[76:77]
    v_pk_fma_f32 v[192:193], v[76:77], v[76:77], v[192:193]
    v_pk_add_f32 v[190:191], v[190:191], v[78:79]
    v_pk_fma_f32 v[194:195], v[78:79], v[78:79], v[194:195]
    v_pk_mul_f32 v[80:81], v[80:81], v[136:137]
    v_pk_mul_f32 v[82:83], v[82:83], v[138:139]
    v_pk_fma_f32 v[80:81], v[152:153], v[164:165], v[80:81] op_sel_hi:[1,0,1]
    v_pk_fma_f32 v[82:83], v[154:155], v[164:165], v[82:83] op_sel_hi:[1,0,1]
    v_pk_mul_f32 v[168:169], v[80:81], v[80:81]
    v_pk_mul_f32 v[170:171], v[82:83], v[82:83]
    v_pk_fma_f32 v[168:169], v[168:169], s[48:49], v[10:11]
    v_pk_fma_f32 v[170:171], v[170:171], s[48:49], v[10:11]
    v_pk_mul_f32 v[168:169], v[168:169], v[80:81]
    v_pk_mul_f32 v[170:171], v[170:171], v[82:83]
    v_exp_f32 v168, v168
    v_exp_f32 v169, v169
    v_exp_f32 v170, v170
    v_exp_f32 v171, v171
    s_nop 0
    v_pk_add_f32 v[168:169], v[168:169], 1.0 op_sel_hi:[1,0]
    v_pk_add_f32 v[170:171], v[170:171], 1.0 op_sel_hi:[1,0]
    v_rcp_f32 v168, v168
    v_rcp_f32 v169, v169
    v_rcp_f32 v170, v170
    v_rcp_f32 v171, v171
    s_nop 0
    v_pk_mul_f32 v[80:81], v[80:81], v[168:169]
    v_pk_mul_f32 v[82:83], v[82:83], v[170:171]
    v_pk_add_f32 v[188:189], v[188:189], v[80:81]
    v_pk_fma_f32 v[192:193], v[80:81], v[80:81], v[192:193]
    v_pk_add_f32 v[190:191], v[190:191], v[82:83]
    v_pk_fma_f32 v[194:195], v[82:83], v[82:83], v[194:195]
    v_pk_mul_f32 v[100:101], v[100:101], v[140:141]
    v_pk_mul_f32 v[102:103], v[102:103], v[142:143]
    v_pk_fma_f32 v[100:101], v[156:157], v[160:161], v[100:101] op_sel_hi:[1,0,1]
    v_pk_fma_f32 v[102:103], v[158:159], v[160:161], v[102:103] op_sel_hi:[1,0,1]
    v_pk_mul_f32 v[168:169], v[100:101], v[100:101]
    v_pk_mul_f32 v[170:171], v[102:103], v[102:103]
    v_pk_fma_f32 v[168:169], v[168:169], s[48:49], v[10:11]
    v_pk_fma_f32 v[170:171], v[170:171], s[48:49], v[10:11]
    v_pk_mul_f32 v[168:169], v[168:169], v[100:101]
    v_pk_mul_f32 v[170:171], v[170:171], v[102:103]
    v_exp_f32 v168, v168
    v_exp_f32 v169, v169
    v_exp_f32 v170, v170
    v_exp_f32 v171, v171
    s_nop 0
    v_pk_add_f32 v[168:169], v[168:169], 1.0 op_sel_hi:[1,0]
    v_pk_add_f32 v[170:171], v[170:171], 1.0 op_sel_hi:[1,0]
    v_rcp_f32 v168, v168
    v_rcp_f32 v169, v169
    v_rcp_f32 v170, v170
    v_rcp_f32 v171, v171
    s_nop 0
    v_pk_mul_f32 v[100:101], v[100:101], v[168:169]
    v_pk_mul_f32 v[102:103], v[102:103], v[170:171]
    v_mov_b32 v196, v100
    v_mov_b32 v197, v101
    v_pk_mul_f32 v[200:201], v[100:101], v[100:101]
    v_mov_b32 v198, v102
    v_mov_b32 v199, v103
    v_pk_mul_f32 v[202:203], v[102:103], v[102:103]
    v_pk_mul_f32 v[104:105], v[104:105], v[140:141]
    v_pk_mul_f32 v[106:107], v[106:107], v[142:143]
    v_pk_fma_f32 v[104:105], v[156:157], v[162:163], v[104:105] op_sel_hi:[1,0,1]
    v_pk_fma_f32 v[106:107], v[158:159], v[162:163], v[106:107] op_sel_hi:[1,0,1]
    v_pk_mul_f32 v[168:169], v[104:105], v[104:105]
    v_pk_mul_f32 v[170:171], v[106:107], v[106:107]
    v_pk_fma_f32 v[168:169], v[168:169], s[48:49], v[10:11]
    v_pk_fma_f32 v[170:171], v[170:171], s[48:49], v[10:11]
    v_pk_mul_f32 v[168:169], v[168:169], v[104:105]
    v_pk_mul_f32 v[170:171], v[170:171], v[106:107]
    v_exp_f32 v168, v168
    v_exp_f32 v169, v169
    v_exp_f32 v170, v170
    v_exp_f32 v171, v171
    s_nop 0
    v_pk_add_f32 v[168:169], v[168:169], 1.0 op_sel_hi:[1,0]
    v_pk_add_f32 v[170:171], v[170:171], 1.0 op_sel_hi:[1,0]
    v_rcp_f32 v168, v168
    v_rcp_f32 v169, v169
    v_rcp_f32 v170, v170
    v_rcp_f32 v171, v171
    s_nop 0
    v_pk_mul_f32 v[104:105], v[104:105], v[168:169]
    v_pk_mul_f32 v[106:107], v[106:107], v[170:171]
    v_pk_add_f32 v[196:197], v[196:197], v[104:105]
    v_pk_fma_f32 v[200:201], v[104:105], v[104:105], v[200:201]
    v_pk_add_f32 v[198:199], v[198:199], v[106:107]
    v_pk_fma_f32 v[202:203], v[106:107], v[106:107], v[202:203]
    v_pk_mul_f32 v[108:109], v[108:109], v[140:141]
    v_pk_mul_f32 v[110:111], v[110:111], v[142:143]
    v_pk_fma_f32 v[108:109], v[156:157], v[164:165], v[108:109] op_sel_hi:[1,0,1]
    v_pk_fma_f32 v[110:111], v[158:159], v[164:165], v[110:111] op_sel_hi:[1,0,1]
    v_pk_mul_f32 v[168:169], v[108:109], v[108:109]
    v_pk_mul_f32 v[170:171], v[110:111], v[110:111]
    v_pk_fma_f32 v[168:169], v[168:169], s[48:49], v[10:11]
    v_pk_fma_f32 v[170:171], v[170:171], s[48:49], v[10:11]
    v_pk_mul_f32 v[168:169], v[168:169], v[108:109]
    v_pk_mul_f32 v[170:171], v[170:171], v[110:111]
    v_exp_f32 v168, v168
    v_exp_f32 v169, v169
    v_exp_f32 v170, v170
    v_exp_f32 v171, v171
    s_nop 0
    v_pk_add_f32 v[168:169], v[168:169], 1.0 op_sel_hi:[1,0]
    v_pk_add_f32 v[170:171], v[170:171], 1.0 op_sel_hi:[1,0]
    v_rcp_f32 v168, v168
    v_rcp_f32 v169, v169
    v_rcp_f32 v170, v170
    v_rcp_f32 v171, v171
    s_nop 0
    v_pk_mul_f32 v[108:109], v[108:109], v[168:169]
    v_pk_mul_f32 v[110:111], v[110:111], v[170:171]
    v_pk_add_f32 v[196:197], v[196:197], v[108:109]
    v_pk_fma_f32 v[200:201], v[108:109], v[108:109], v[200:201]
    v_pk_add_f32 v[198:199], v[198:199], v[110:111]
    v_pk_fma_f32 v[202:203], v[110:111], v[110:111], v[202:203]
    v_bfe_u32 v6, v0, 3, 1
    v_lshlrev_b32 v6, 2, v6
    v_add_u32 v6, v6, v2
    v_lshlrev_b32 v6, 1, v6
    v_bfe_u32 v7, v0, 2, 1
    v_add_u32 v6, v6, v7
    v_lshlrev_b32 v6, 2, v6
    v_and_b32 v7, 3, v0
    v_add_lshl_u32 v6, v6, v7, 2
    s_mov_b32 s56, 0xaaaaaaaa
    s_mov_b32 s57, s56
    s_mov_b32 s58, 0xcccccccc
    s_mov_b32 s59, s58
    s_lshl_b32 s38, s4, 10
    s_lshl_b32 s7, s30, 9
    s_add_u32 s38, s38, s7
    s_add_u32 s38, s38, 16384
    v_add_f32_dpp v172, v172, v172 row_ror:8 row_mask:0xf bank_mask:0x3
    v_add_f32_dpp v173, v173, v173 row_ror:8 row_mask:0xf bank_mask:0x3
    v_add_f32_dpp v174, v174, v174 row_ror:8 row_mask:0xf bank_mask:0x3
    v_add_f32_dpp v175, v175, v175 row_ror:8 row_mask:0xf bank_mask:0x3
    v_add_f32_dpp v176, v176, v176 row_ror:8 row_mask:0xf bank_mask:0x3
    v_add_f32_dpp v177, v177, v177 row_ror:8 row_mask:0xf bank_mask:0x3
    v_add_f32_dpp v178, v178, v178 row_ror:8 row_mask:0xf bank_mask:0x3
    v_add_f32_dpp v179, v179, v179 row_ror:8 row_mask:0xf bank_mask:0x3
    v_add_f32_dpp v172, v180, v180 row_ror:8 row_mask:0xf bank_mask:0xc
    v_add_f32_dpp v173, v181, v181 row_ror:8 row_mask:0xf bank_mask:0xc
    v_add_f32_dpp v174, v182, v182 row_ror:8 row_mask:0xf bank_mask:0xc
    v_add_f32_dpp v175, v183, v183 row_ror:8 row_mask:0xf bank_mask:0xc
    v_add_f32_dpp v176, v184, v184 row_ror:8 row_mask:0xf bank_mask:0xc
    v_add_f32_dpp v177, v185, v185 row_ror:8 row_mask:0xf bank_mask:0xc
    v_add_f32_dpp v178, v186, v186 row_ror:8 row_mask:0xf bank_mask:0xc
    v_add_f32_dpp v179, v187, v187 row_ror:8 row_mask:0xf bank_mask:0xc
    v_add_f32_dpp v172, v172, v172 row_shl:4 row_mask:0xf bank_mask:0x5
    v_add_f32_dpp v173, v173, v173 row_shl:4 row_mask:0xf bank_mask:0x5
    v_add_f32_dpp v176, v176, v176 row_shl:4 row_mask:0xf bank_mask:0x5
    v_add_f32_dpp v177, v177, v177 row_shl:4 row_mask:0xf bank_mask:0x5
    v_add_f32_dpp v172, v174, v174 row_shr:4 row_mask:0xf bank_mask:0xa
    v_add_f32_dpp v173, v175, v175 row_shr:4 row_mask:0xf bank_mask:0xa
    v_add_f32_dpp v176, v178, v178 row_shr:4 row_mask:0xf bank_mask:0xa
    v_add_f32_dpp v177, v179, v179 row_shr:4 row_mask:0xf bank_mask:0xa
    v_add_f32_dpp v172, v172, v172 quad_perm:[2,3,0,1] row_mask:0xf bank_mask:0xf
    v_add_f32_dpp v173, v173, v173 quad_perm:[2,3,0,1] row_mask:0xf bank_mask:0xf
    v_add_f32_dpp v176, v176, v176 quad_perm:[2,3,0,1] row_mask:0xf bank_mask:0xf
    v_add_f32_dpp v177, v177, v177 quad_perm:[2,3,0,1] row_mask:0xf bank_mask:0xf
    v_add_f32_dpp v172, v172, v172 quad_perm:[1,0,3,2] row_mask:0xf bank_mask:0xf
    v_add_f32_dpp v173, v173, v173 quad_perm:[1,0,3,2] row_mask:0xf bank_mask:0xf
    v_add_f32_dpp v176, v176, v176 quad_perm:[1,0,3,2] row_mask:0xf bank_mask:0xf
    v_add_f32_dpp v177, v177, v177 quad_perm:[1,0,3,2] row_mask:0xf bank_mask:0xf
    v_cndmask_b32 v172, v172, v176, s[56:57]
    v_cndmask_b32 v173, v173, v177, s[56:57]
    v_cndmask_b32 v172, v172, v173, s[58:59]
    buffer_atomic_add_f32 v172, v6, s[44:47], s38 offen offset:0
    v_add_f32_dpp v188, v188, v188 row_ror:8 row_mask:0xf bank_mask:0x3
    v_add_f32_dpp v189, v189, v189 row_ror:8 row_mask:0xf bank_mask:0x3
    v_add_f32_dpp v190, v190, v190 row_ror:8 row_mask:0xf bank_mask:0x3
    v_add_f32_dpp v191, v191, v191 row_ror:8 row_mask:0xf bank_mask:0x3
    v_add_f32_dpp v192, v192, v192 row_ror:8 row_mask:0xf bank_mask:0x3
    v_add_f32_dpp v193, v193, v193 row_ror:8 row_mask:0xf bank_mask:0x3
    v_add_f32_dpp v194, v194, v194 row_ror:8 row_mask:0xf bank_mask:0x3
    v_add_f32_dpp v195, v195, v195 row_ror:8 row_mask:0xf bank_mask:0x3
    v_add_f32_dpp v188, v196, v196 row_ror:8 row_mask:0xf bank_mask:0xc
    v_add_f32_dpp v189, v197, v197 row_ror:8 row_mask:0xf bank_mask:0xc
    v_add_f32_dpp v190, v198, v198 row_ror:8 row_mask:0xf bank_mask:0xc
    v_add_f32_dpp v191, v199, v199 row_ror:8 row_mask:0xf bank_mask:0xc
    v_add_f32_dpp v192, v200, v200 row_ror:8 row_mask:0xf bank_mask:0xc
    v_add_f32_dpp v193, v201, v201 row_ror:8 row_mask:0xf bank_mask:0xc
    v_add_f32_dpp v194, v202, v202 row_ror:8 row_mask:0xf bank_mask:0xc
    v_add_f32_dpp v195, v203, v203 row_ror:8 row_mask:0xf bank_mask:0xc
    v_add_f32_dpp v188, v188, v188 row_shl:4 row_mask:0xf bank_mask:0x5
    v_add_f32_dpp v189, v189, v189 row_shl:4 row_mask:0xf bank_mask:0x5
    v_add_f32_dpp v192, v192, v192 row_shl:4 row_mask:0xf bank_mask:0x5
    v_add_f32_dpp v193, v193, v193 row_shl:4 row_mask:0xf bank_mask:0x5
    v_add_f32_dpp v188, v190, v190 row_shr:4 row_mask:0xf bank_mask:0xa
    v_add_f32_dpp v189, v191, v191 row_shr:4 row_mask:0xf bank_mask:0xa
    v_add_f32_dpp v192, v194, v194 row_shr:4 row_mask:0xf bank_mask:0xa
    v_add_f32_dpp v193, v195, v195 row_shr:4 row_mask:0xf bank_mask:0xa
    v_add_f32_dpp v188, v188, v188 quad_perm:[2,3,0,1] row_mask:0xf bank_mask:0xf
    v_add_f32_dpp v189, v189, v189 quad_perm:[2,3,0,1] row_mask:0xf bank_mask:0xf
    v_add_f32_dpp v192, v192, v192 quad_perm:[2,3,0,1] row_mask:0xf bank_mask:0xf
    v_add_f32_dpp v193, v193, v193 quad_perm:[2,3,0,1] row_mask:0xf bank_mask:0xf
    v_add_f32_dpp v188, v188, v188 quad_perm:[1,0,3,2] row_mask:0xf bank_mask:0xf
    v_add_f32_dpp v189, v189, v189 quad_perm:[1,0,3,2] row_mask:0xf bank_mask:0xf
    v_add_f32_dpp v192, v192, v192 quad_perm:[1,0,3,2] row_mask:0xf bank_mask:0xf
    v_add_f32_dpp v193, v193, v193 quad_perm:[1,0,3,2] row_mask:0xf bank_mask:0xf
    v_cndmask_b32 v188, v188, v192, s[56:57]
    v_cndmask_b32 v189, v189, v193, s[56:57]
    v_cndmask_b32 v188, v188, v189, s[58:59]
    buffer_atomic_add_f32 v188, v6, s[44:47], s38 offen offset:256
    s_mul_i32 s6, s30, 14336
    s_add_u32 s6, s6, 122880
    v_lshl_add_u32 v14, v0, 3, s6
    s_waitcnt lgkmcnt(0)
    v_mov_b32 v3, 1
    s_waitcnt vmcnt(0)
    s_mov_b64 exec, 1
    ds_add_u32 v254, v3 offset:24
    s_mov_b64 exec, -1
    v_pk_mul_f32 v[28:29], v[28:29], v[204:205] op_sel_hi:[1,0]
    v_pk_mul_f32 v[30:31], v[30:31], v[204:205] op_sel_hi:[1,0]
    v_pk_fma_f32 v[28:29], v[212:213], v[204:205], v[28:29] op_sel:[0,1,0]
    v_pk_fma_f32 v[30:31], v[214:215], v[204:205], v[30:31] op_sel:[0,1,0]
    v_pk_mul_f32 v[168:169], v[28:29], v[28:29]
    v_pk_mul_f32 v[170:171], v[30:31], v[30:31]
    v_pk_fma_f32 v[168:169], v[168:169], s[48:49], v[10:11]
    v_pk_fma_f32 v[170:171], v[170:171], s[48:49], v[10:11]
    v_pk_mul_f32 v[168:169], v[168:169], v[28:29]
    v_pk_mul_f32 v[170:171], v[170:171], v[30:31]
    v_exp_f32 v168, v168
    v_exp_f32 v169, v169
    v_exp_f32 v170, v170
    v_exp_f32 v171, v171
    s_nop 0
    v_pk_add_f32 v[168:169], v[168:169], 1.0 op_sel_hi:[1,0]
    v_pk_add_f32 v[170:171], v[170:171], 1.0 op_sel_hi:[1,0]
    v_rcp_f32 v168, v168
    v_rcp_f32 v169, v169
    v_rcp_f32 v170, v170
    v_rcp_f32 v171, v171
    s_nop 0
    v_pk_mul_f32 v[28:29], v[28:29], v[168:169]
    v_pk_mul_f32 v[30:31], v[30:31], v[170:171]
    v_cvt_pk_bf16_f32 v28, v28, v29
    v_cvt_pk_bf16_f32 v29, v30, v31
    ds_write_b64 v14, v[28:29] offset:1536
    v_pk_mul_f32 v[32:33], v[32:33], v[204:205] op_sel_hi:[1,0]
    v_pk_mul_f32 v[34:35], v[34:35], v[204:205] op_sel_hi:[1,0]
    v_pk_fma_f32 v[32:33], v[216:217], v[204:205], v[32:33] op_sel:[0,1,0]
    v_pk_fma_f32 v[34:35], v[218:219], v[204:205], v[34:35] op_sel:[0,1,0]
    v_pk_mul_f32 v[168:169], v[32:33], v[32:33]
    v_pk_mul_f32 v[170:171], v[34:35], v[34:35]
    v_pk_fma_f32 v[168:169], v[168:169], s[48:49], v[10:11]
    v_pk_fma_f32 v[170:171], v[170:171], s[48:49], v[10:11]
    v_pk_mul_f32 v[168:169], v[168:169], v[32:33]
    v_pk_mul_f32 v[170:171], v[170:171], v[34:35]
    v_exp_f32 v168, v168
    v_exp_f32 v169, v169
    v_exp_f32 v170, v170
    v_exp_f32 v171, v171
    s_nop 0
    v_pk_add_f32 v[168:169], v[168:169], 1.0 op_sel_hi:[1,0]
    v_pk_add_f32 v[170:171], v[170:171], 1.0 op_sel_hi:[1,0]
    v_rcp_f32 v168, v168
    v_rcp_f32 v169, v169
    v_rcp_f32 v170, v170
    v_rcp_f32 v171, v171
    s_nop 0
    v_pk_mul_f32 v[32:33], v[32:33], v[168:169]
    v_pk_mul_f32 v[34:35], v[34:35], v[170:171]
    v_cvt_pk_bf16_f32 v32, v32, v33
    v_cvt_pk_bf16_f32 v33, v34, v35
    ds_write_b64 v14, v[32:33] offset:2048
    v_pk_mul_f32 v[36:37], v[36:37], v[204:205] op_sel_hi:[1,0]
    v_pk_mul_f32 v[38:39], v[38:39], v[204:205] op_sel_hi:[1,0]
    v_pk_fma_f32 v[36:37], v[220:221], v[204:205], v[36:37] op_sel:[0,1,0]
    v_pk_fma_f32 v[38:39], v[222:223], v[204:205], v[38:39] op_sel:[0,1,0]
    v_pk_mul_f32 v[168:169], v[36:37], v[36:37]
    v_pk_mul_f32 v[170:171], v[38:39], v[38:39]
    v_pk_fma_f32 v[168:169], v[168:169], s[48:49], v[10:11]
    v_pk_fma_f32 v[170:171], v[170:171], s[48:49], v[10:11]
    v_pk_mul_f32 v[168:169], v[168:169], v[36:37]
    v_pk_mul_f32 v[170:171], v[170:171], v[38:39]
    v_exp_f32 v168, v168
    v_exp_f32 v169, v169
    v_exp_f32 v170, v170
    v_exp_f32 v171, v171
    s_nop 0
    v_pk_add_f32 v[168:169], v[168:169], 1.0 op_sel_hi:[1,0]
    v_pk_add_f32 v[170:171], v[170:171], 1.0 op_sel_hi:[1,0]
    v_rcp_f32 v168, v168
    v_rcp_f32 v169, v169
    v_rcp_f32 v170, v170
    v_rcp_f32 v171, v171
    s_nop 0
    v_pk_mul_f32 v[36:37], v[36:37], v[168:169]
    v_pk_mul_f32 v[38:39], v[38:39], v[170:171]
    v_cvt_pk_bf16_f32 v36, v36, v37
    v_cvt_pk_bf16_f32 v37, v38, v39
    ds_write_b64 v14, v[36:37] offset:2560
    v_pk_mul_f32 v[40:41], v[40:41], v[204:205] op_sel_hi:[1,0]
    v_pk_mul_f32 v[42:43], v[42:43], v[204:205] op_sel_hi:[1,0]
    v_pk_fma_f32 v[40:41], v[224:225], v[204:205], v[40:41] op_sel:[0,1,0]
    v_pk_fma_f32 v[42:43], v[226:227], v[204:205], v[42:43] op_sel:[0,1,0]
    v_pk_mul_f32 v[168:169], v[40:41], v[40:41]
    v_pk_mul_f32 v[170:171], v[42:43], v[42:43]
    v_pk_fma_f32 v[168:169], v[168:169], s[48:49], v[10:11]
    v_pk_fma_f32 v[170:171], v[170:171], s[48:49], v[10:11]
    v_pk_mul_f32 v[168:169], v[168:169], v[40:41]
    v_pk_mul_f32 v[170:171], v[170:171], v[42:43]
    v_exp_f32 v168, v168
    v_exp_f32 v169, v169
    v_exp_f32 v170, v170
    v_exp_f32 v171, v171
    s_nop 0
    v_pk_add_f32 v[168:169], v[168:169], 1.0 op_sel_hi:[1,0]
    v_pk_add_f32 v[170:171], v[170:171], 1.0 op_sel_hi:[1,0]
    v_rcp_f32 v168, v168
    v_rcp_f32 v169, v169
    v_rcp_f32 v170, v170
    v_rcp_f32 v171, v171
    s_nop 0
    v_pk_mul_f32 v[40:41], v[40:41], v[168:169]
    v_pk_mul_f32 v[42:43], v[42:43], v[170:171]
    v_cvt_pk_bf16_f32 v40, v40, v41
    v_cvt_pk_bf16_f32 v41, v42, v43
    ds_write_b64 v14, v[40:41] offset:3072
    v_pk_mul_f32 v[56:57], v[56:57], v[206:207] op_sel_hi:[1,0]
    v_pk_mul_f32 v[58:59], v[58:59], v[206:207] op_sel_hi:[1,0]
    v_pk_fma_f32 v[56:57], v[212:213], v[206:207], v[56:57] op_sel:[0,1,0]
    v_pk_fma_f32 v[58:59], v[214:215], v[206:207], v[58:59] op_sel:[0,1,0]
    v_pk_mul_f32 v[168:169], v[56:57], v[56:57]
    v_pk_mul_f32 v[170:171], v[58:59], v[58:59]
    v_pk_fma_f32 v[168:169], v[168:169], s[48:49], v[10:11]
    v_pk_fma_f32 v[170:171], v[170:171], s[48:49], v[10:11]
    v_pk_mul_f32 v[168:169], v[168:169], v[56:57]
    v_pk_mul_f32 v[170:171], v[170:171], v[58:59]
    v_exp_f32 v168, v168
    v_exp_f32 v169, v169
    v_exp_f32 v170, v170
    v_exp_f32 v171, v171
    s_nop 0
    v_pk_add_f32 v[168:169], v[168:169], 1.0 op_sel_hi:[1,0]
    v_pk_add_f32 v[170:171], v[170:171], 1.0 op_sel_hi:[1,0]
    v_rcp_f32 v168, v168
    v_rcp_f32 v169, v169
    v_rcp_f32 v170, v170
    v_rcp_f32 v171, v171
    s_nop 0
    v_pk_mul_f32 v[56:57], v[56:57], v[168:169]
    v_pk_mul_f32 v[58:59], v[58:59], v[170:171]
    v_cvt_pk_bf16_f32 v56, v56, v57
    v_cvt_pk_bf16_f32 v57, v58, v59
    ds_write_b64 v14, v[56:57] offset:5120
    v_pk_mul_f32 v[60:61], v[60:61], v[206:207] op_sel_hi:[1,0]
    v_pk_mul_f32 v[62:63], v[62:63], v[206:207] op_sel_hi:[1,0]
    v_pk_fma_f32 v[60:61], v[216:217], v[206:207], v[60:61] op_sel:[0,1,0]
    v_pk_fma_f32 v[62:63], v[218:219], v[206:207], v[62:63] op_sel:[0,1,0]
    v_pk_mul_f32 v[168:169], v[60:61], v[60:61]
    v_pk_mul_f32 v[170:171], v[62:63], v[62:63]
    v_pk_fma_f32 v[168:169], v[168:169], s[48:49], v[10:11]
    v_pk_fma_f32 v[170:171], v[170:171], s[48:49], v[10:11]
    v_pk_mul_f32 v[168:169], v[168:169], v[60:61]
    v_pk_mul_f32 v[170:171], v[170:171], v[62:63]
    v_exp_f32 v168, v168
    v_exp_f32 v169, v169
    v_exp_f32 v170, v170
    v_exp_f32 v171, v171
    s_nop 0
    v_pk_add_f32 v[168:169], v[168:169], 1.0 op_sel_hi:[1,0]
    v_pk_add_f32 v[170:171], v[170:171], 1.0 op_sel_hi:[1,0]
    v_rcp_f32 v168, v168
    v_rcp_f32 v169, v169
    v_rcp_f32 v170, v170
    v_rcp_f32 v171, v171
    s_nop 0
    v_pk_mul_f32 v[60:61], v[60:61], v[168:169]
    v_pk_mul_f32 v[62:63], v[62:63], v[170:171]
    v_cvt_pk_bf16_f32 v60, v60, v61
    v_cvt_pk_bf16_f32 v61, v62, v63
    ds_write_b64 v14, v[60:61] offset:5632
    v_pk_mul_f32 v[64:65], v[64:65], v[206:207] op_sel_hi:[1,0]
    v_pk_mul_f32 v[66:67], v[66:67], v[206:207] op_sel_hi:[1,0]
    v_pk_fma_f32 v[64:65], v[220:221], v[206:207], v[64:65] op_sel:[0,1,0]
    v_pk_fma_f32 v[66:67], v[222:223], v[206:207], v[66:67] op_sel:[0,1,0]
    v_pk_mul_f32 v[168:169], v[64:65], v[64:65]
    v_pk_mul_f32 v[170:171], v[66:67], v[66:67]
    v_pk_fma_f32 v[168:169], v[168:169], s[48:49], v[10:11]
    v_pk_fma_f32 v[170:171], v[170:171], s[48:49], v[10:11]
    v_pk_mul_f32 v[168:169], v[168:169], v[64:65]
    v_pk_mul_f32 v[170:171], v[170:171], v[66:67]
    v_exp_f32 v168, v168
    v_exp_f32 v169, v169
    v_exp_f32 v170, v170
    v_exp_f32 v171, v171
    s_nop 0
    v_pk_add_f32 v[168:169], v[168:169], 1.0 op_sel_hi:[1,0]
    v_pk_add_f32 v[170:171], v[170:171], 1.0 op_sel_hi:[1,0]
    v_rcp_f32 v168, v168
    v_rcp_f32 v169, v169
    v_rcp_f32 v170, v170
    v_rcp_f32 v171, v171
    s_nop 0
    v_pk_mul_f32 v[64:65], v[64:65], v[168:169]
    v_pk_mul_f32 v[66:67], v[66:67], v[170:171]
    v_cvt_pk_bf16_f32 v64, v64, v65
    v_cvt_pk_bf16_f32 v65, v66, v67
    ds_write_b64 v14, v[64:65] offset:6144
    v_pk_mul_f32 v[68:69], v[68:69], v[206:207] op_sel_hi:[1,0]
    v_pk_mul_f32 v[70:71], v[70:71], v[206:207] op_sel_hi:[1,0]
    v_pk_fma_f32 v[68:69], v[224:225], v[206:207], v[68:69] op_sel:[0,1,0]
    v_pk_fma_f32 v[70:71], v[226:227], v[206:207], v[70:71] op_sel:[0,1,0]
    v_pk_mul_f32 v[168:169], v[68:69], v[68:69]
    v_pk_mul_f32 v[170:171], v[70:71], v[70:71]
    v_pk_fma_f32 v[168:169], v[168:169], s[48:49], v[10:11]
    v_pk_fma_f32 v[170:171], v[170:171], s[48:49], v[10:11]
    v_pk_mul_f32 v[168:169], v[168:169], v[68:69]
    v_pk_mul_f32 v[170:171], v[170:171], v[70:71]
    v_exp_f32 v168, v168
    v_exp_f32 v169, v169
    v_exp_f32 v170, v170
    v_exp_f32 v171, v171
    s_nop 0
    v_pk_add_f32 v[168:169], v[168:169], 1.0 op_sel_hi:[1,0]
    v_pk_add_f32 v[170:171], v[170:171], 1.0 op_sel_hi:[1,0]
    v_rcp_f32 v168, v168
    v_rcp_f32 v169, v169
    v_rcp_f32 v170, v170
    v_rcp_f32 v171, v171
    s_nop 0
    v_pk_mul_f32 v[68:69], v[68:69], v[168:169]
    v_pk_mul_f32 v[70:71], v[70:71], v[170:171]
    v_cvt_pk_bf16_f32 v68, v68, v69
    v_cvt_pk_bf16_f32 v69, v70, v71
    ds_write_b64 v14, v[68:69] offset:6656
    v_pk_mul_f32 v[84:85], v[84:85], v[208:209] op_sel_hi:[1,0]
    v_pk_mul_f32 v[86:87], v[86:87], v[208:209] op_sel_hi:[1,0]
    v_pk_fma_f32 v[84:85], v[212:213], v[208:209], v[84:85] op_sel:[0,1,0]
    v_pk_fma_f32 v[86:87], v[214:215], v[208:209], v[86:87] op_sel:[0,1,0]
    v_pk_mul_f32 v[168:169], v[84:85], v[84:85]
    v_pk_mul_f32 v[170:171], v[86:87], v[86:87]
    v_pk_fma_f32 v[168:169], v[168:169], s[48:49], v[10:11]
    v_pk_fma_f32 v[170:171], v[170:171], s[48:49], v[10:11]
    v_pk_mul_f32 v[168:169], v[168:169], v[84:85]
    v_pk_mul_f32 v[170:171], v[170:171], v[86:87]
    v_exp_f32 v168, v168
    v_exp_f32 v169, v169
    v_exp_f32 v170, v170
    v_exp_f32 v171, v171
    s_nop 0
    v_pk_add_f32 v[168:169], v[168:169], 1.0 op_sel_hi:[1,0]
    v_pk_add_f32 v[170:171], v[170:171], 1.0 op_sel_hi:[1,0]
    v_rcp_f32 v168, v168
    v_rcp_f32 v169, v169
    v_rcp_f32 v170, v170
    v_rcp_f32 v171, v171
    s_nop 0
    v_pk_mul_f32 v[84:85], v[84:85], v[168:169]
    v_pk_mul_f32 v[86:87], v[86:87], v[170:171]
    v_cvt_pk_bf16_f32 v84, v84, v85
    v_cvt_pk_bf16_f32 v85, v86, v87
    ds_write_b64 v14, v[84:85] offset:8704
    v_pk_mul_f32 v[88:89], v[88:89], v[208:209] op_sel_hi:[1,0]
    v_pk_mul_f32 v[90:91], v[90:91], v[208:209] op_sel_hi:[1,0]
    v_pk_fma_f32 v[88:89], v[216:217], v[208:209], v[88:89] op_sel:[0,1,0]
    v_pk_fma_f32 v[90:91], v[218:219], v[208:209], v[90:91] op_sel:[0,1,0]
    v_pk_mul_f32 v[168:169], v[88:89], v[88:89]
    v_pk_mul_f32 v[170:171], v[90:91], v[90:91]
    v_pk_fma_f32 v[168:169], v[168:169], s[48:49], v[10:11]
    v_pk_fma_f32 v[170:171], v[170:171], s[48:49], v[10:11]
    v_pk_mul_f32 v[168:169], v[168:169], v[88:89]
    v_pk_mul_f32 v[170:171], v[170:171], v[90:91]
    v_exp_f32 v168, v168
    v_exp_f32 v169, v169
    v_exp_f32 v170, v170
    v_exp_f32 v171, v171
    s_nop 0
    v_pk_add_f32 v[168:169], v[168:169], 1.0 op_sel_hi:[1,0]
    v_pk_add_f32 v[170:171], v[170:171], 1.0 op_sel_hi:[1,0]
    v_rcp_f32 v168, v168
    v_rcp_f32 v169, v169
    v_rcp_f32 v170, v170
    v_rcp_f32 v171, v171
    s_nop 0
    v_pk_mul_f32 v[88:89], v[88:89], v[168:169]
    v_pk_mul_f32 v[90:91], v[90:91], v[170:171]
    v_cvt_pk_bf16_f32 v88, v88, v89
    v_cvt_pk_bf16_f32 v89, v90, v91
    ds_write_b64 v14, v[88:89] offset:9216
    v_pk_mul_f32 v[92:93], v[92:93], v[208:209] op_sel_hi:[1,0]
    v_pk_mul_f32 v[94:95], v[94:95], v[208:209] op_sel_hi:[1,0]
    v_pk_fma_f32 v[92:93], v[220:221], v[208:209], v[92:93] op_sel:[0,1,0]
    v_pk_fma_f32 v[94:95], v[222:223], v[208:209], v[94:95] op_sel:[0,1,0]
    v_pk_mul_f32 v[168:169], v[92:93], v[92:93]
    v_pk_mul_f32 v[170:171], v[94:95], v[94:95]
    v_pk_fma_f32 v[168:169], v[168:169], s[48:49], v[10:11]
    v_pk_fma_f32 v[170:171], v[170:171], s[48:49], v[10:11]
    v_pk_mul_f32 v[168:169], v[168:169], v[92:93]
    v_pk_mul_f32 v[170:171], v[170:171], v[94:95]
    v_exp_f32 v168, v168
    v_exp_f32 v169, v169
    v_exp_f32 v170, v170
    v_exp_f32 v171, v171
    s_nop 0
    v_pk_add_f32 v[168:169], v[168:169], 1.0 op_sel_hi:[1,0]
    v_pk_add_f32 v[170:171], v[170:171], 1.0 op_sel_hi:[1,0]
    v_rcp_f32 v168, v168
    v_rcp_f32 v169, v169
    v_rcp_f32 v170, v170
    v_rcp_f32 v171, v171
    s_nop 0
    v_pk_mul_f32 v[92:93], v[92:93], v[168:169]
    v_pk_mul_f32 v[94:95], v[94:95], v[170:171]
    v_cvt_pk_bf16_f32 v92, v92, v93
    v_cvt_pk_bf16_f32 v93, v94, v95
    ds_write_b64 v14, v[92:93] offset:9728
    v_pk_mul_f32 v[96:97], v[96:97], v[208:209] op_sel_hi:[1,0]
    v_pk_mul_f32 v[98:99], v[98:99], v[208:209] op_sel_hi:[1,0]
    v_pk_fma_f32 v[96:97], v[224:225], v[208:209], v[96:97] op_sel:[0,1,0]
    v_pk_fma_f32 v[98:99], v[226:227], v[208:209], v[98:99] op_sel:[0,1,0]
    v_pk_mul_f32 v[168:169], v[96:97], v[96:97]
    v_pk_mul_f32 v[170:171], v[98:99], v[98:99]
    v_pk_fma_f32 v[168:169], v[168:169], s[48:49], v[10:11]
    v_pk_fma_f32 v[170:171], v[170:171], s[48:49], v[10:11]
    v_pk_mul_f32 v[168:169], v[168:169], v[96:97]
    v_pk_mul_f32 v[170:171], v[170:171], v[98:99]
    v_exp_f32 v168, v168
    v_exp_f32 v169, v169
    v_exp_f32 v170, v170
    v_exp_f32 v171, v171
    s_nop 0
    v_pk_add_f32 v[168:169], v[168:169], 1.0 op_sel_hi:[1,0]
    v_pk_add_f32 v[170:171], v[170:171], 1.0 op_sel_hi:[1,0]
    v_rcp_f32 v168, v168
    v_rcp_f32 v169, v169
    v_rcp_f32 v170, v170
    v_rcp_f32 v171, v171
    s_nop 0
    v_pk_mul_f32 v[96:97], v[96:97], v[168:169]
    v_pk_mul_f32 v[98:99], v[98:99], v[170:171]
    v_cvt_pk_bf16_f32 v96, v96, v97
    v_cvt_pk_bf16_f32 v97, v98, v99
    ds_write_b64 v14, v[96:97] offset:10240
L_spin49:
    ds_read_b32 v6, v254 offset:28
    s_sub_u32 s37, s37, 1
    s_cselect_b32 s37, 0, s37
    s_cbranch_scc1 L_spin49x
    s_waitcnt lgkmcnt(0)
    v_readfirstlane_b32 s6, v6
    s_cmp_ge_u32 s6, 1
    s_cbranch_scc1 L_spin49x
    s_sleep 1
    s_branch L_spin49
L_spin49x:
    s_waitcnt lgkmcnt(0)
    v_lshlrev_b32 v7, 3, v0
    buffer_load_dwordx2 v[8:9], v7, s[44:47], s38 offen sc1
    s_lshl_b32 s7, s3, 9
    s_add_u32 s7, s7, 153600
    v_lshl_add_u32 v6, v0, 2, s7
    v_lshl_add_u32 v4, v2, 4, s7
    v_and_b32 v12, 1, v2
    v_lshlrev_b32 v12, 5, v12
    v_lshrrev_b32 v3, 1, v2
    v_lshl_add_u32 v12, v3, 4, v12
    v_lshlrev_b32 v12, 4, v12
    v_lshl_add_u32 v12, v1, 4, v12
    s_lshl_b32 s39, s5, 6
    s_lshl_b32 s7, s4, 2
    s_add_u32 s39, s39, s7
    s_lshl_b32 s7, s30, 1
    s_add_u32 s39, s39, s7
    s_mul_i32 s39, s39, 7168
    s_add_u32 s39, s39, 4096
    v_pk_mul_f32 v[112:113], v[112:113], v[210:211] op_sel_hi:[1,0]
    v_pk_mul_f32 v[114:115], v[114:115], v[210:211] op_sel_hi:[1,0]
    v_pk_fma_f32 v[112:113], v[212:213], v[210:211], v[112:113] op_sel:[0,1,0]
    v_pk_fma_f32 v[114:115], v[214:215], v[210:211], v[114:115] op_sel:[0,1,0]
    v_pk_mul_f32 v[168:169], v[112:113], v[112:113]
    v_pk_mul_f32 v[170:171], v[114:115], v[114:115]
    v_pk_fma_f32 v[168:169], v[168:169], s[48:49], v[10:11]
    v_pk_fma_f32 v[170:171], v[170:171], s[48:49], v[10:11]
    v_pk_mul_f32 v[168:169], v[168:169], v[112:113]
    v_pk_mul_f32 v[170:171], v[170:171], v[114:115]
    v_exp_f32 v168, v168
    v_exp_f32 v169, v169
    v_exp_f32 v170, v170
    v_exp_f32 v171, v171
    s_nop 0
    v_pk_add_f32 v[168:169], v[168:169], 1.0 op_sel_hi:[1,0]
    v_pk_add_f32 v[170:171], v[170:171], 1.0 op_sel_hi:[1,0]
    v_rcp_f32 v168, v168
    v_rcp_f32 v169, v169
    v_rcp_f32 v170, v170
    v_rcp_f32 v171, v171
    s_nop 0
    v_pk_mul_f32 v[112:113], v[112:113], v[168:169]
    v_pk_mul_f32 v[114:115], v[114:115], v[170:171]
    v_cvt_pk_bf16_f32 v112, v112, v113
    v_cvt_pk_bf16_f32 v113, v114, v115
    ds_write_b64 v14, v[112:113] offset:12288
    v_pk_mul_f32 v[116:117], v[116:117], v[210:211] op_sel_hi:[1,0]
    v_pk_mul_f32 v[118:119], v[118:119], v[210:211] op_sel_hi:[1,0]
    v_pk_fma_f32 v[116:117], v[216:217], v[210:211], v[116:117] op_sel:[0,1,0]
    v_pk_fma_f32 v[118:119], v[218:219], v[210:211], v[118:119] op_sel:[0,1,0]
    v_pk_mul_f32 v[168:169], v[116:117], v[116:117]
    v_pk_mul_f32 v[170:171], v[118:119], v[118:119]
    v_pk_fma_f32 v[168:169], v[168:169], s[48:49], v[10:11]
    v_pk_fma_f32 v[170:171], v[170:171], s[48:49], v[10:11]
    v_pk_mul_f32 v[168:169], v[168:169], v[116:117]
    v_pk_mul_f32 v[170:171], v[170:171], v[118:119]
    v_exp_f32 v168, v168
    v_exp_f32 v169, v169
    v_exp_f32 v170, v170
    v_exp_f32 v171, v171
    s_nop 0
    v_pk_add_f32 v[168:169], v[168:169], 1.0 op_sel_hi:[1,0]
    v_pk_add_f32 v[170:171], v[170:171], 1.0 op_sel_hi:[1,0]
    v_rcp_f32 v168, v168
    v_rcp_f32 v169, v169
    v_rcp_f32 v170, v170
    v_rcp_f32 v171, v171
    s_nop 0
    v_pk_mul_f32 v[116:117], v[116:117], v[168:169]
    v_pk_mul_f32 v[118:119], v[118:119], v[170:171]
    v_cvt_pk_bf16_f32 v116, v116, v117
    v_cvt_pk_bf16_f32 v117, v118, v119
    ds_write_b64 v14, v[116:117] offset:12800
    v_pk_mul_f32 v[120:121], v[120:121], v[210:211] op_sel_hi:[1,0]
    v_pk_mul_f32 v[122:123], v[122:123], v[210:211] op_sel_hi:[1,0]
    v_pk_fma_f32 v[120:121], v[220:221], v[210:211], v[120:121] op_sel:[0,1,0]
    v_pk_fma_f32 v[122:123], v[222:223], v[210:211], v[122:123] op_sel:[0,1,0]
    v_pk_mul_f32 v[168:169], v[120:121], v[120:121]
    v_pk_mul_f32 v[170:171], v[122:123], v[122:123]
    v_pk_fma_f32 v[168:169], v[168:169], s[48:49], v[10:11]
    v_pk_fma_f32 v[170:171], v[170:171], s[48:49], v[10:11]
    v_pk_mul_f32 v[168:169], v[168:169], v[120:121]
    v_pk_mul_f32 v[170:171], v[170:171], v[122:123]
    v_exp_f32 v168, v168
    v_exp_f32 v169, v169
    v_exp_f32 v170, v170
    v_exp_f32 v171, v171
    s_nop 0
    v_pk_add_f32 v[168:169], v[168:169], 1.0 op_sel_hi:[1,0]
    v_pk_add_f32 v[170:171], v[170:171], 1.0 op_sel_hi:[1,0]
    v_rcp_f32 v168, v168
    v_rcp_f32 v169, v169
    v_rcp_f32 v170, v170
    v_rcp_f32 v171, v171
    s_nop 0
    v_pk_mul_f32 v[120:121], v[120:121], v[168:169]
    v_pk_mul_f32 v[122:123], v[122:123], v[170:171]
    v_cvt_pk_bf16_f32 v120, v120, v121
    v_cvt_pk_bf16_f32 v121, v122, v123
    ds_write_b64 v14, v[120:121] offset:13312
    v_pk_mul_f32 v[124:125], v[124:125], v[210:211] op_sel_hi:[1,0]
    v_pk_mul_f32 v[126:127], v[126:127], v[210:211] op_sel_hi:[1,0]
    v_pk_fma_f32 v[124:125], v[224:225], v[210:211], v[124:125] op_sel:[0,1,0]
    v_pk_fma_f32 v[126:127], v[226:227], v[210:211], v[126:127] op_sel:[0,1,0]
    v_pk_mul_f32 v[168:169], v[124:125], v[124:125]
    v_pk_mul_f32 v[170:171], v[126:127], v[126:127]
    v_pk_fma_f32 v[168:169], v[168:169], s[48:49], v[10:11]
    v_pk_fma_f32 v[170:171], v[170:171], s[48:49], v[10:11]
    v_pk_mul_f32 v[168:169], v[168:169], v[124:125]
    v_pk_mul_f32 v[170:171], v[170:171], v[126:127]
    v_exp_f32 v168, v168
    v_exp_f32 v169, v169
    v_exp_f32 v170, v170
    v_exp_f32 v171, v171
    s_nop 0
    v_pk_add_f32 v[168:169], v[168:169], 1.0 op_sel_hi:[1,0]
    v_pk_add_f32 v[170:171], v[170:171], 1.0 op_sel_hi:[1,0]
    v_rcp_f32 v168, v168
    v_rcp_f32 v169, v169
    v_rcp_f32 v170, v170
    v_rcp_f32 v171, v171
    s_nop 0
    v_pk_mul_f32 v[124:125], v[124:125], v[168:169]
    v_pk_mul_f32 v[126:127], v[126:127], v[170:171]
    v_cvt_pk_bf16_f32 v124, v124, v125
    v_cvt_pk_bf16_f32 v125, v126, v127
    ds_write_b64 v14, v[124:125] offset:13824
    s_waitcnt vmcnt(0)
    v_mul_f32 v3, 0x3a124925, v8
    v_mul_f32 v9, 0x3a124925, v9
    v_fma_f32 v9, -v3, v3, v9
    v_max_f32 v9, 0, v9
    v_add_f32 v9, 0x3727c5ac, v9
    v_rsq_f32 v8, v9
    s_nop 0
    v_mul_f32_e64 v9, -v3, v8
    ds_write_b32 v6, v8
    ds_write_b32 v6, v9 offset:256
    s_waitcnt lgkmcnt(0)
    ds_read_b128 v[128:131], v4 offset:0
    ds_read_b128 v[144:147], v4 offset:256
    ds_read_b128 v[132:135], v4 offset:64
    ds_read_b128 v[148:151], v4 offset:320
    ds_read_b128 v[136:139], v4 offset:128
    ds_read_b128 v[152:155], v4 offset:384
    ds_read_b128 v[140:143], v4 offset:192
    ds_read_b128 v[156:159], v4 offset:448
    s_waitcnt lgkmcnt(0)
    v_pk_fma_f32 v[16:17], v[16:17], v[128:129], v[144:145]
    v_pk_fma_f32 v[18:19], v[18:19], v[130:131], v[146:147]
    v_pk_fma_f32 v[44:45], v[44:45], v[132:133], v[148:149]
    v_pk_fma_f32 v[46:47], v[46:47], v[134:135], v[150:151]
    v_cvt_pk_bf16_f32 v172, v16, v17
    v_cvt_pk_bf16_f32 v173, v18, v19
    v_cvt_pk_bf16_f32 v174, v44, v45
    v_cvt_pk_bf16_f32 v175, v46, v47
    s_nop 1
    v_permlane16_swap_b32 v172, v174
    v_permlane16_swap_b32 v173, v175
    buffer_store_dwordx4 v[172:175], v12, s[16:19], s39 offen offset:0 sc1
    v_pk_fma_f32 v[20:21], v[20:21], v[128:129], v[144:145]
    v_pk_fma_f32 v[22:23], v[22:23], v[130:131], v[146:147]
    v_pk_fma_f32 v[48:49], v[48:49], v[132:133], v[148:149]
    v_pk_fma_f32 v[50:51], v[50:51], v[134:135], v[150:151]
    v_cvt_pk_bf16_f32 v176, v20, v21
    v_cvt_pk_bf16_f32 v177, v22, v23
    v_cvt_pk_bf16_f32 v178, v48, v49
    v_cvt_pk_bf16_f32 v179, v50, v51
    s_nop 1
    v_permlane16_swap_b32 v176, v178
    v_permlane16_swap_b32 v177, v179
    buffer_store_dwordx4 v[176:179], v12, s[16:19], s39 offen offset:1024 sc1
    v_pk_fma_f32 v[24:25], v[24:25], v[128:129], v[144:145]
    v_pk_fma_f32 v[26:27], v[26:27], v[130:131], v[146:147]
    v_pk_fma_f32 v[52:53], v[52:53], v[132:133], v[148:149]
    v_pk_fma_f32 v[54:55], v[54:55], v[134:135], v[150:151]
    v_cvt_pk_bf16_f32 v180, v24, v25
    v_cvt_pk_bf16_f32 v181, v26, v27
    v_cvt_pk_bf16_f32 v182, v52, v53
    v_cvt_pk_bf16_f32 v183, v54, v55
    s_nop 1
    v_permlane16_swap_b32 v180, v182
    v_permlane16_swap_b32 v181, v183
    buffer_store_dwordx4 v[180:183], v12, s[16:19], s39 offen offset:2048 sc1
    s_add_u32 s39, s39, 7168
    v_pk_fma_f32 v[72:73], v[72:73], v[136:137], v[152:153]
    v_pk_fma_f32 v[74:75], v[74:75], v[138:139], v[154:155]
    v_pk_fma_f32 v[100:101], v[100:101], v[140:141], v[156:157]
    v_pk_fma_f32 v[102:103], v[102:103], v[142:143], v[158:159]
    v_cvt_pk_bf16_f32 v184, v72, v73
    v_cvt_pk_bf16_f32 v185, v74, v75
    v_cvt_pk_bf16_f32 v186, v100, v101
    v_cvt_pk_bf16_f32 v187, v102, v103
    s_nop 1
    v_permlane16_swap_b32 v184, v186
    v_permlane16_swap_b32 v185, v187
    buffer_store_dwordx4 v[184:187], v12, s[16:19], s39 offen offset:0 sc1
    v_pk_fma_f32 v[76:77], v[76:77], v[136:137], v[152:153]
    v_pk_fma_f32 v[78:79], v[78:79], v[138:139], v[154:155]
    v_pk_fma_f32 v[104:105], v[104:105], v[140:141], v[156:157]
    v_pk_fma_f32 v[106:107], v[106:107], v[142:143], v[158:159]
    v_cvt_pk_bf16_f32 v188, v76, v77
    v_cvt_pk_bf16_f32 v189, v78, v79
    v_cvt_pk_bf16_f32 v190, v104, v105
    v_cvt_pk_bf16_f32 v191, v106, v107
    s_nop 1
    v_permlane16_swap_b32 v188, v190
    v_permlane16_swap_b32 v189, v191
    buffer_store_dwordx4 v[188:191], v12, s[16:19], s39 offen offset:1024 sc1
    v_pk_fma_f32 v[80:81], v[80:81], v[136:137], v[152:153]
    v_pk_fma_f32 v[82:83], v[82:83], v[138:139], v[154:155]
    v_pk_fma_f32 v[108:109], v[108:109], v[140:141], v[156:157]
    v_pk_fma_f32 v[110:111], v[110:111], v[142:143], v[158:159]
    v_cvt_pk_bf16_f32 v192, v80, v81
    v_cvt_pk_bf16_f32 v193, v82, v83
    v_cvt_pk_bf16_f32 v194, v108, v109
    v_cvt_pk_bf16_f32 v195, v110, v111
    s_nop 1
    v_permlane16_swap_b32 v192, v194
    v_permlane16_swap_b32 v193, v195
    buffer_store_dwordx4 v[192:195], v12, s[16:19], s39 offen offset:2048 sc1
    s_add_u32 s39, s39, 7168
    v_mov_b32 v3, 1
    s_waitcnt vmcnt(0)
    s_mov_b64 exec, 1
    ds_add_u32 v254, v3 offset:32
    s_mov_b64 exec, -1
L_ce:
    s_add_u32 s40, s84, 41943040
    s_addc_u32 s41, s85, 0
    s_mov_b32 s42, 7340032
    s_mov_b32 s43, 0x20000
    s_add_u32 s44, s76, 0
    s_addc_u32 s45, s77, 0
    s_mov_b32 s46, 4096
    s_mov_b32 s47, 0x20000
    s_lshl_b32 s38, s4, 3
    s_lshl_b32 s7, s3, 1
    s_add_u32 s38, s38, s7
    s_lshl_b32 s7, s38, 5
    v_lshlrev_b32 v15, 1, v1
    buffer_load_ushort v172, v15, s[44:47], s7 offen offset:0
    buffer_load_ushort v174, v15, s[44:47], s7 offen offset:32
    s_and_b32 s31, s3, 0
    s_lshr_b32 s30, s3, 0
    v_lshrrev_b32 v3, 1, v1
    v_xor_b32 v3, v3, v2
    v_lshlrev_b32 v3, 4, v3
    v_lshl_add_u32 v3, v1, 7, v3
    s_mul_i32 s6, s30, 4096
    v_add_u32 v4, s6, v3
    v_xor_b32 v5, 64, v4
    v_lshlrev_b32 v6, 4, v0
    s_mul_i32 s6, s31, 7168
    s_add_u32 s6, s6, 16384
    v_add_u32 v6, s6, v6
    v_mov_b32 v16, 0
    v_mov_b32 v17, 0
    v_mov_b32 v18, 0
    v_mov_b32 v19, 0
    v_mov_b32 v20, 0
    v_mov_b32 v21, 0
    v_mov_b32 v22, 0
    v_mov_b32 v23, 0
    v_mov_b32 v24, 0
    v_mov_b32 v25, 0
    v_mov_b32 v26, 0
    v_mov_b32 v27, 0
    v_mov_b32 v28, 0
    v_mov_b32 v29, 0
    v_mov_b32 v30, 0
    v_mov_b32 v31, 0
    v_mov_b32 v32, 0
    v_mov_b32 v33, 0
    v_mov_b32 v34, 0
    v_mov_b32 v35, 0
    v_mov_b32 v36, 0
    v_mov_b32 v37, 0
    v_mov_b32 v38, 0
    v_mov_b32 v39, 0
    v_mov_b32 v40, 0
    v_mov_b32 v41, 0
    v_mov_b32 v42, 0
    v_mov_b32 v43, 0
    v_mov_b32 v44, 0
    v_mov_b32 v45, 0
    v_mov_b32 v46, 0
    v_mov_b32 v47, 0
    v_mov_b32 v48, 0
    v_mov_b32 v49, 0
    v_mov_b32 v50, 0
    v_mov_b32 v51, 0
    v_mov_b32 v52, 0
    v_mov_b32 v53, 0
    v_mov_b32 v54, 0
    v_mov_b32 v55, 0
    v_mov_b32 v56, 0
    v_mov_b32 v57, 0
    v_mov_b32 v58, 0
    v_mov_b32 v59, 0
    v_mov_b32 v60, 0
    v_mov_b32 v61, 0
    v_mov_b32 v62, 0
    v_mov_b32 v63, 0
    v_mov_b32 v64, 0
    v_mov_b32 v65, 0
    v_mov_b32 v66, 0
    v_mov_b32 v67, 0
    v_mov_b32 v68, 0
    v_mov_b32 v69, 0
    v_mov_b32 v70, 0
    v_mov_b32 v71, 0
    s_mov_b32 s32, 0
    s_barrier
    ds_read_b128 v[72:75], v4 offset:0
    ds_read_b128 v[76:79], v4 offset:2048
    ds_read_b128 v[80:83], v6 offset:0
    ds_read_b128 v[84:87], v6 offset:1024
    ds_read_b128 v[88:91], v6 offset:2048
    ds_read_b128 v[92:95], v6 offset:3072
    ds_read_b128 v[96:99], v6 offset:4096
    ds_read_b128 v[100:103], v6 offset:5120
    ds_read_b128 v[104:107], v6 offset:6144
    s_mov_b32 s36, 32
    s_branch L_emid
    .p2align 4
L_eloop:
    s_barrier
    v_mfma_f32_16x16x32_bf16 v[16:19], v[116:119], v[108:111], v[16:19]
    ds_read_b128 v[72:75], v4 offset:0
    ds_read_b128 v[76:79], v4 offset:2048
    v_mfma_f32_16x16x32_bf16 v[44:47], v[116:119], v[112:115], v[44:47]
    ds_read_b128 v[80:83], v6 offset:0
    ds_read_b128 v[84:87], v6 offset:1024
    v_mfma_f32_16x16x32_bf16 v[20:23], v[120:123], v[108:111], v[20:23]
    ds_read_b128 v[88:91], v6 offset:2048
    ds_read_b128 v[92:95], v6 offset:3072
    v_mfma_f32_16x16x32_bf16 v[48:51], v[120:123], v[112:115], v[48:51]
    ds_read_b128 v[96:99], v6 offset:4096
    ds_read_b128 v[100:103], v6 offset:5120
    v_mfma_f32_16x16x32_bf16 v[24:27], v[124:127], v[108:111], v[24:27]
    ds_read_b128 v[104:107], v6 offset:6144
    v_mfma_f32_16x16x32_bf16 v[52:55], v[124:127], v[112:115], v[52:55]
    v_mfma_f32_16x16x32_bf16 v[28:31], v[128:131], v[108:111], v[28:31]
    v_mfma_f32_16x16x32_bf16 v[56:59], v[128:131], v[112:115], v[56:59]
    v_mfma_f32_16x16x32_bf16 v[32:35], v[132:135], v[108:111], v[32:35]
    v_mfma_f32_16x16x32_bf16 v[60:63], v[132:135], v[112:115], v[60:63]
    v_mfma_f32_16x16x32_bf16 v[36:39], v[136:139], v[108:111], v[36:39]
    v_mfma_f32_16x16x32_bf16 v[64:67], v[136:139], v[112:115], v[64:67]
    v_mfma_f32_16x16x32_bf16 v[40:43], v[140:143], v[108:111], v[40:43]
    v_mfma_f32_16x16x32_bf16 v[68:71], v[140:143], v[112:115], v[68:71]
L_emid:
    s_waitcnt lgkmcnt(0)
    v_mfma_f32_16x16x32_bf16 v[16:19], v[80:83], v[72:75], v[16:19]
    ds_read_b128 v[108:111], v5 offset:0
    ds_read_b128 v[112:115], v5 offset:2048
    v_mfma_f32_16x16x32_bf16 v[44:47], v[80:83], v[76:79], v[44:47]
    ds_read_b128 v[116:119], v6 offset:7168
    ds_read_b128 v[120:123], v6 offset:8192
    v_mfma_f32_16x16x32_bf16 v[20:23], v[84:87], v[72:75], v[20:23]
    ds_read_b128 v[124:127], v6 offset:9216
    ds_read_b128 v[128:131], v6 offset:10240
    v_mfma_f32_16x16x32_bf16 v[48:51], v[84:87], v[76:79], v[48:51]
    ds_read_b128 v[132:135], v6 offset:11264
    ds_read_b128 v[136:139], v6 offset:12288
    v_mfma_f32_16x16x32_bf16 v[24:27], v[88:91], v[72:75], v[24:27]
    ds_read_b128 v[140:143], v6 offset:13312
    v_mfma_f32_16x16x32_bf16 v[52:55], v[88:91], v[76:79], v[52:55]
    s_add_u32 s32, s32, 1
    s_cmp_eq_u32 s32, 4
    v_mfma_f32_16x16x32_bf16 v[28:31], v[92:95], v[72:75], v[28:31]
    s_mov_b32 s6, 30720
    s_cselect_b32 s6, -92160, s6
    v_mfma_f32_16x16x32_bf16 v[56:59], v[92:95], v[76:79], v[56:59]
    s_cselect_b32 s32, 0, s32
    v_add_u32 v4, s6, v4
    v_mfma_f32_16x16x32_bf16 v[32:35], v[96:99], v[72:75], v[32:35]
    v_add_u32 v5, s6, v5
    v_add_u32 v6, s6, v6
    v_mfma_f32_16x16x32_bf16 v[60:63], v[96:99], v[76:79], v[60:63]
    s_sub_u32 s36, s36, 1
    s_cmp_lg_u32 s36, 0
    v_mfma_f32_16x16x32_bf16 v[36:39], v[100:103], v[72:75], v[36:39]
    v_mfma_f32_16x16x32_bf16 v[64:67], v[100:103], v[76:79], v[64:67]
    v_mfma_f32_16x16x32_bf16 v[40:43], v[104:107], v[72:75], v[40:43]
    v_mfma_f32_16x16x32_bf16 v[68:71], v[104:107], v[76:79], v[68:71]
    s_waitcnt lgkmcnt(0)
    s_cbranch_scc1 L_eloop
    s_barrier
    v_mfma_f32_16x16x32_bf16 v[16:19], v[116:119], v[108:111], v[16:19]
    v_mfma_f32_16x16x32_bf16 v[44:47], v[116:119], v[112:115], v[44:47]
    v_mfma_f32_16x16x32_bf16 v[20:23], v[120:123], v[108:111], v[20:23]
    v_mfma_f32_16x16x32_bf16 v[48:51], v[120:123], v[112:115], v[48:51]
    v_mfma_f32_16x16x32_bf16 v[24:27], v[124:127], v[108:111], v[24:27]
    v_mfma_f32_16x16x32_bf16 v[52:55], v[124:127], v[112:115], v[52:55]
    v_mfma_f32_16x16x32_bf16 v[28:31], v[128:131], v[108:111], v[28:31]
    v_mfma_f32_16x16x32_bf16 v[56:59], v[128:131], v[112:115], v[56:59]
    v_mfma_f32_16x16x32_bf16 v[32:35], v[132:135], v[108:111], v[32:35]
    v_mfma_f32_16x16x32_bf16 v[60:63], v[132:135], v[112:115], v[60:63]
    v_mfma_f32_16x16x32_bf16 v[36:39], v[136:139], v[108:111], v[36:39]
    v_mfma_f32_16x16x32_bf16 v[64:67], v[136:139], v[112:115], v[64:67]
    v_mfma_f32_16x16x32_bf16 v[40:43], v[140:143], v[108:111], v[40:43]
    v_mfma_f32_16x16x32_bf16 v[68:71], v[140:143], v[112:115], v[68:71]
    s_nop 7
    s_mul_i32 s6, s3, 7168
    s_add_u32 s6, s6, 122880
    v_lshl_add_u32 v6, v0, 3, s6
    ds_read_b64 v[144:145], v6 offset:0
    ds_read_b64 v[146:147], v6 offset:512
    ds_read_b64 v[148:149], v6 offset:1024
    ds_read_b64 v[150:151], v6 offset:1536
    ds_read_b64 v[152:153], v6 offset:2048
    ds_read_b64 v[154:155], v6 offset:2560
    ds_read_b64 v[156:157], v6 offset:3072
    ds_read_b64 v[158:159], v6 offset:3584
    ds_read_b64 v[160:161], v6 offset:4096
    ds_read_b64 v[162:163], v6 offset:4608
    ds_read_b64 v[164:165], v6 offset:5120
    ds_read_b64 v[166:167], v6 offset:5632
    ds_read_b64 v[168:169], v6 offset:6144
    ds_read_b64 v[170:171], v6 offset:6656
    v_and_b32 v4, 1, v2
    v_lshlrev_b32 v4, 5, v4
    v_lshrrev_b32 v3, 1, v2
    v_lshl_add_u32 v4, v3, 4, v4
    v_lshlrev_b32 v4, 4, v4
    v_lshl_add_u32 v4, v1, 4, v4
    v_and_b32 v5, 1, v2
    v_lshrrev_b32 v3, 1, v2
    v_lshl_add_u32 v5, v5, 2, v3
    v_lshl_add_u32 v5, v5, 4, v1
    v_lshlrev_b32 v5, 4, v5
    s_mul_i32 s6, s4, 458752
    s_lshr_b32 s7, s5, 1
    s_mul_i32 s7, s7, 57344
    s_add_u32 s6, s6, s7
    s_lshl_b32 s7, s3, 11
    s_add_u32 s6, s6, s7
    s_waitcnt vmcnt(0) lgkmcnt(0)
    v_lshlrev_b32 v172, 16, v172
    v_lshlrev_b32 v174, 16, v174
    s_bitcmp1_b32 s5, 0
    s_cbranch_scc1 L_eodd
    s_add_u32 s7, s6, 0
    v_lshlrev_b32 v72, 16, v144
    v_and_b32 v73, 0xffff0000, v144
    v_lshlrev_b32 v74, 16, v145
    v_and_b32 v75, 0xffff0000, v145
    v_pk_add_f32 v[16:17], v[16:17], v[172:173] op_sel_hi:[1,0]
    v_pk_add_f32 v[18:19], v[18:19], v[172:173] op_sel_hi:[1,0]
    v_pk_mul_f32 v[16:17], v[16:17], v[72:73]
    v_pk_mul_f32 v[18:19], v[18:19], v[74:75]
    v_lshlrev_b32 v72, 16, v146
    v_and_b32 v73, 0xffff0000, v146
    v_lshlrev_b32 v74, 16, v147
    v_and_b32 v75, 0xffff0000, v147
    v_pk_add_f32 v[20:21], v[20:21], v[172:173] op_sel_hi:[1,0]
    v_pk_add_f32 v[22:23], v[22:23], v[172:173] op_sel_hi:[1,0]
    v_pk_mul_f32 v[20:21], v[20:21], v[72:73]
    v_pk_mul_f32 v[22:23], v[22:23], v[74:75]
    v_cvt_pk_bf16_f32 v76, v16, v17
    v_cvt_pk_bf16_f32 v77, v18, v19
    v_cvt_pk_bf16_f32 v78, v20, v21
    v_cvt_pk_bf16_f32 v79, v22, v23
    s_nop 1
    v_permlane16_swap_b32 v76, v78
    v_permlane16_swap_b32 v77, v79
    buffer_store_dwordx4 v[76:79], v4, s[40:43], s7 offen offset:0 sc1
    v_lshlrev_b32 v72, 16, v158
    v_and_b32 v73, 0xffff0000, v158
    v_lshlrev_b32 v74, 16, v159
    v_and_b32 v75, 0xffff0000, v159
    v_pk_add_f32 v[44:45], v[44:45], v[174:175] op_sel_hi:[1,0]
    v_pk_add_f32 v[46:47], v[46:47], v[174:175] op_sel_hi:[1,0]
    v_pk_mul_f32 v[44:45], v[44:45], v[72:73]
    v_pk_mul_f32 v[46:47], v[46:47], v[74:75]
    v_lshlrev_b32 v72, 16, v160
    v_and_b32 v73, 0xffff0000, v160
    v_lshlrev_b32 v74, 16, v161
    v_and_b32 v75, 0xffff0000, v161
    v_pk_add_f32 v[48:49], v[48:49], v[174:175] op_sel_hi:[1,0]
    v_pk_add_f32 v[50:51], v[50:51], v[174:175] op_sel_hi:[1,0]
    v_pk_mul_f32 v[48:49], v[48:49], v[72:73]
    v_pk_mul_f32 v[50:51], v[50:51], v[74:75]
    v_cvt_pk_bf16_f32 v80, v44, v45
    v_cvt_pk_bf16_f32 v81, v46, v47
    v_cvt_pk_bf16_f32 v82, v48, v49
    v_cvt_pk_bf16_f32 v83, v50, v51
    s_nop 1
    v_permlane16_swap_b32 v80, v82
    v_permlane16_swap_b32 v81, v83
    buffer_store_dwordx4 v[80:83], v4, s[40:43], s7 offen offset:1024 sc1
    s_add_u32 s7, s6, 8192
    v_lshlrev_b32 v72, 16, v148
    v_and_b32 v73, 0xffff0000, v148
    v_lshlrev_b32 v74, 16, v149
    v_and_b32 v75, 0xffff0000, v149
    v_pk_add_f32 v[24:25], v[24:25], v[172:173] op_sel_hi:[1,0]
    v_pk_add_f32 v[26:27], v[26:27], v[172:173] op_sel_hi:[1,0]
    v_pk_mul_f32 v[24:25], v[24:25], v[72:73]
    v_pk_mul_f32 v[26:27], v[26:27], v[74:75]
    v_lshlrev_b32 v72, 16, v150
    v_and_b32 v73, 0xffff0000, v150
    v_lshlrev_b32 v74, 16, v151
    v_and_b32 v75, 0xffff0000, v151
    v_pk_add_f32 v[28:29], v[28:29], v[172:173] op_sel_hi:[1,0]
    v_pk_add_f32 v[30:31], v[30:31], v[172:173] op_sel_hi:[1,0]
    v_pk_mul_f32 v[28:29], v[28:29], v[72:73]
    v_pk_mul_f32 v[30:31], v[30:31], v[74:75]
    v_cvt_pk_bf16_f32 v84, v24, v25
    v_cvt_pk_bf16_f32 v85, v26, v27
    v_cvt_pk_bf16_f32 v86, v28, v29
    v_cvt_pk_bf16_f32 v87, v30, v31
    s_nop 1
    v_permlane16_swap_b32 v84, v86
    v_permlane16_swap_b32 v85, v87
    buffer_store_dwordx4 v[84:87], v4, s[40:43], s7 offen offset:0 sc1
    v_lshlrev_b32 v72, 16, v162
    v_and_b32 v73, 0xffff0000, v162
    v_lshlrev_b32 v74, 16, v163
    v_and_b32 v75, 0xffff0000, v163
    v_pk_add_f32 v[52:53], v[52:53], v[174:175] op_sel_hi:[1,0]
    v_pk_add_f32 v[54:55], v[54:55], v[174:175] op_sel_hi:[1,0]
    v_pk_mul_f32 v[52:53], v[52:53], v[72:73]
    v_pk_mul_f32 v[54:55], v[54:55], v[74:75]
    v_lshlrev_b32 v72, 16, v164
    v_and_b32 v73, 0xffff0000, v164
    v_lshlrev_b32 v74, 16, v165
    v_and_b32 v75, 0xffff0000, v165
    v_pk_add_f32 v[56:57], v[56:57], v[174:175] op_sel_hi:[1,0]
    v_pk_add_f32 v[58:59], v[58:59], v[174:175] op_sel_hi:[1,0]
    v_pk_mul_f32 v[56:57], v[56:57], v[72:73]
    v_pk_mul_f32 v[58:59], v[58:59], v[74:75]
    v_cvt_pk_bf16_f32 v88, v52, v53
    v_cvt_pk_bf16_f32 v89, v54, v55
    v_cvt_pk_bf16_f32 v90, v56, v57
    v_cvt_pk_bf16_f32 v91, v58, v59
    s_nop 1
    v_permlane16_swap_b32 v88, v90
    v_permlane16_swap_b32 v89, v91
    buffer_store_dwordx4 v[88:91], v4, s[40:43], s7 offen offset:1024 sc1
    s_add_u32 s7, s6, 16384
    v_lshlrev_b32 v72, 16, v152
    v_and_b32 v73, 0xffff0000, v152
    v_lshlrev_b32 v74, 16, v153
    v_and_b32 v75, 0xffff0000, v153
    v_pk_add_f32 v[32:33], v[32:33], v[172:173] op_sel_hi:[1,0]
    v_pk_add_f32 v[34:35], v[34:35], v[172:173] op_sel_hi:[1,0]
    v_pk_mul_f32 v[32:33], v[32:33], v[72:73]
    v_pk_mul_f32 v[34:35], v[34:35], v[74:75]
    v_lshlrev_b32 v72, 16, v154
    v_and_b32 v73, 0xffff0000, v154
    v_lshlrev_b32 v74, 16, v155
    v_and_b32 v75, 0xffff0000, v155
    v_pk_add_f32 v[36:37], v[36:37], v[172:173] op_sel_hi:[1,0]
    v_pk_add_f32 v[38:39], v[38:39], v[172:173] op_sel_hi:[1,0]
    v_pk_mul_f32 v[36:37], v[36:37], v[72:73]
    v_pk_mul_f32 v[38:39], v[38:39], v[74:75]
    v_cvt_pk_bf16_f32 v92, v32, v33
    v_cvt_pk_bf16_f32 v93, v34, v35
    v_cvt_pk_bf16_f32 v94, v36, v37
    v_cvt_pk_bf16_f32 v95, v38, v39
    s_nop 1
    v_permlane16_swap_b32 v92, v94
    v_permlane16_swap_b32 v93, v95
    buffer_store_dwordx4 v[92:95], v4, s[40:43], s7 offen offset:0 sc1
    v_lshlrev_b32 v72, 16, v166
    v_and_b32 v73, 0xffff0000, v166
    v_lshlrev_b32 v74, 16, v167
    v_and_b32 v75, 0xffff0000, v167
    v_pk_add_f32 v[60:61], v[60:61], v[174:175] op_sel_hi:[1,0]
    v_pk_add_f32 v[62:63], v[62:63], v[174:175] op_sel_hi:[1,0]
    v_pk_mul_f32 v[60:61], v[60:61], v[72:73]
    v_pk_mul_f32 v[62:63], v[62:63], v[74:75]
    v_lshlrev_b32 v72, 16, v168
    v_and_b32 v73, 0xffff0000, v168
    v_lshlrev_b32 v74, 16, v169
    v_and_b32 v75, 0xffff0000, v169
    v_pk_add_f32 v[64:65], v[64:65], v[174:175] op_sel_hi:[1,0]
    v_pk_add_f32 v[66:67], v[66:67], v[174:175] op_sel_hi:[1,0]
    v_pk_mul_f32 v[64:65], v[64:65], v[72:73]
    v_pk_mul_f32 v[66:67], v[66:67], v[74:75]
    v_cvt_pk_bf16_f32 v96, v60, v61
    v_cvt_pk_bf16_f32 v97, v62, v63
    v_cvt_pk_bf16_f32 v98, v64, v65
    v_cvt_pk_bf16_f32 v99, v66, v67
    s_nop 1
    v_permlane16_swap_b32 v96, v98
    v_permlane16_swap_b32 v97, v99
    buffer_store_dwordx4 v[96:99], v4, s[40:43], s7 offen offset:1024 sc1
    v_lshlrev_b32 v72, 16, v156
    v_and_b32 v73, 0xffff0000, v156
    v_lshlrev_b32 v74, 16, v157
    v_and_b32 v75, 0xffff0000, v157
    v_pk_add_f32 v[40:41], v[40:41], v[172:173] op_sel_hi:[1,0]
    v_pk_add_f32 v[42:43], v[42:43], v[172:173] op_sel_hi:[1,0]
    v_pk_mul_f32 v[40:41], v[40:41], v[72:73]
    v_pk_mul_f32 v[42:43], v[42:43], v[74:75]
    v_lshlrev_b32 v72, 16, v170
    v_and_b32 v73, 0xffff0000, v170
    v_lshlrev_b32 v74, 16, v171
    v_and_b32 v75, 0xffff0000, v171
    v_pk_add_f32 v[68:69], v[68:69], v[174:175] op_sel_hi:[1,0]
    v_pk_add_f32 v[70:71], v[70:71], v[174:175] op_sel_hi:[1,0]
    v_pk_mul_f32 v[68:69], v[68:69], v[72:73]
    v_pk_mul_f32 v[70:71], v[70:71], v[74:75]
    v_cvt_pk_bf16_f32 v100, v40, v41
    v_cvt_pk_bf16_f32 v101, v42, v43
    v_cvt_pk_bf16_f32 v102, v68, v69
    v_cvt_pk_bf16_f32 v103, v70, v71
    s_nop 1
    v_permlane16_swap_b32 v100, v102
    v_permlane16_swap_b32 v101, v103
    s_add_u32 s7, s6, 24576
    buffer_store_dwordx4 v[100:103], v5, s[40:43], s7 offen offset:0 sc1
    s_branch L_eex
L_eodd:
    s_add_u32 s7, s6, 32768
    v_lshlrev_b32 v72, 16, v146
    v_and_b32 v73, 0xffff0000, v146
    v_lshlrev_b32 v74, 16, v147
    v_and_b32 v75, 0xffff0000, v147
    v_pk_add_f32 v[20:21], v[20:21], v[172:173] op_sel_hi:[1,0]
    v_pk_add_f32 v[22:23], v[22:23], v[172:173] op_sel_hi:[1,0]
    v_pk_mul_f32 v[20:21], v[20:21], v[72:73]
    v_pk_mul_f32 v[22:23], v[22:23], v[74:75]
    v_lshlrev_b32 v72, 16, v148
    v_and_b32 v73, 0xffff0000, v148
    v_lshlrev_b32 v74, 16, v149
    v_and_b32 v75, 0xffff0000, v149
    v_pk_add_f32 v[24:25], v[24:25], v[172:173] op_sel_hi:[1,0]
    v_pk_add_f32 v[26:27], v[26:27], v[172:173] op_sel_hi:[1,0]
    v_pk_mul_f32 v[24:25], v[24:25], v[72:73]
    v_pk_mul_f32 v[26:27], v[26:27], v[74:75]
    v_cvt_pk_bf16_f32 v76, v20, v21
    v_cvt_pk_bf16_f32 v77, v22, v23
    v_cvt_pk_bf16_f32 v78, v24, v25
    v_cvt_pk_bf16_f32 v79, v26, v27
    s_nop 1
    v_permlane16_swap_b32 v76, v78
    v_permlane16_swap_b32 v77, v79
    buffer_store_dwordx4 v[76:79], v4, s[40:43], s7 offen offset:0 sc1
    v_lshlrev_b32 v72, 16, v160
    v_and_b32 v73, 0xffff0000, v160
    v_lshlrev_b32 v74, 16, v161
    v_and_b32 v75, 0xffff0000, v161
    v_pk_add_f32 v[48:49], v[48:49], v[174:175] op_sel_hi:[1,0]
    v_pk_add_f32 v[50:51], v[50:51], v[174:175] op_sel_hi:[1,0]
    v_pk_mul_f32 v[48:49], v[48:49], v[72:73]
    v_pk_mul_f32 v[50:51], v[50:51], v[74:75]
    v_lshlrev_b32 v72, 16, v162
    v_and_b32 v73, 0xffff0000, v162
    v_lshlrev_b32 v74, 16, v163
    v_and_b32 v75, 0xffff0000, v163
    v_pk_add_f32 v[52:53], v[52:53], v[174:175] op_sel_hi:[1,0]
    v_pk_add_f32 v[54:55], v[54:55], v[174:175] op_sel_hi:[1,0]
    v_pk_mul_f32 v[52:53], v[52:53], v[72:73]
    v_pk_mul_f32 v[54:55], v[54:55], v[74:75]
    v_cvt_pk_bf16_f32 v80, v48, v49
    v_cvt_pk_bf16_f32 v81, v50, v51
    v_cvt_pk_bf16_f32 v82, v52, v53
    v_cvt_pk_bf16_f32 v83, v54, v55
    s_nop 1
    v_permlane16_swap_b32 v80, v82
    v_permlane16_swap_b32 v81, v83
    buffer_store_dwordx4 v[80:83], v4, s[40:43], s7 offen offset:1024 sc1
    s_add_u32 s7, s6, 40960
    v_lshlrev_b32 v72, 16, v150
    v_and_b32 v73, 0xffff0000, v150
    v_lshlrev_b32 v74, 16, v151
    v_and_b32 v75, 0xffff0000, v151
    v_pk_add_f32 v[28:29], v[28:29], v[172:173] op_sel_hi:[1,0]
    v_pk_add_f32 v[30:31], v[30:31], v[172:173] op_sel_hi:[1,0]
    v_pk_mul_f32 v[28:29], v[28:29], v[72:73]
    v_pk_mul_f32 v[30:31], v[30:31], v[74:75]
    v_lshlrev_b32 v72, 16, v152
    v_and_b32 v73, 0xffff0000, v152
    v_lshlrev_b32 v74, 16, v153
    v_and_b32 v75, 0xffff0000, v153
    v_pk_add_f32 v[32:33], v[32:33], v[172:173] op_sel_hi:[1,0]
    v_pk_add_f32 v[34:35], v[34:35], v[172:173] op_sel_hi:[1,0]
    v_pk_mul_f32 v[32:33], v[32:33], v[72:73]
    v_pk_mul_f32 v[34:35], v[34:35], v[74:75]
    v_cvt_pk_bf16_f32 v84, v28, v29
    v_cvt_pk_bf16_f32 v85, v30, v31
    v_cvt_pk_bf16_f32 v86, v32, v33
    v_cvt_pk_bf16_f32 v87, v34, v35
    s_nop 1
    v_permlane16_swap_b32 v84, v86
    v_permlane16_swap_b32 v85, v87
    buffer_store_dwordx4 v[84:87], v4, s[40:43], s7 offen offset:0 sc1
    v_lshlrev_b32 v72, 16, v164
    v_and_b32 v73, 0xffff0000, v164
    v_lshlrev_b32 v74, 16, v165
    v_and_b32 v75, 0xffff0000, v165
    v_pk_add_f32 v[56:57], v[56:57], v[174:175] op_sel_hi:[1,0]
    v_pk_add_f32 v[58:59], v[58:59], v[174:175] op_sel_hi:[1,0]
    v_pk_mul_f32 v[56:57], v[56:57], v[72:73]
    v_pk_mul_f32 v[58:59], v[58:59], v[74:75]
    v_lshlrev_b32 v72, 16, v166
    v_and_b32 v73, 0xffff0000, v166
    v_lshlrev_b32 v74, 16, v167
    v_and_b32 v75, 0xffff0000, v167
    v_pk_add_f32 v[60:61], v[60:61], v[174:175] op_sel_hi:[1,0]
    v_pk_add_f32 v[62:63], v[62:63], v[174:175] op_sel_hi:[1,0]
    v_pk_mul_f32 v[60:61], v[60:61], v[72:73]
    v_pk_mul_f32 v[62:63], v[62:63], v[74:75]
    v_cvt_pk_bf16_f32 v88, v56, v57
    v_cvt_pk_bf16_f32 v89, v58, v59
    v_cvt_pk_bf16_f32 v90, v60, v61
    v_cvt_pk_bf16_f32 v91, v62, v63
    s_nop 1
    v_permlane16_swap_b32 v88, v90
    v_permlane16_swap_b32 v89, v91
    buffer_store_dwordx4 v[88:91], v4, s[40:43], s7 offen offset:1024 sc1
    s_add_u32 s7, s6, 49152
    v_lshlrev_b32 v72, 16, v154
    v_and_b32 v73, 0xffff0000, v154
    v_lshlrev_b32 v74, 16, v155
    v_and_b32 v75, 0xffff0000, v155
    v_pk_add_f32 v[36:37], v[36:37], v[172:173] op_sel_hi:[1,0]
    v_pk_add_f32 v[38:39], v[38:39], v[172:173] op_sel_hi:[1,0]
    v_pk_mul_f32 v[36:37], v[36:37], v[72:73]
    v_pk_mul_f32 v[38:39], v[38:39], v[74:75]
    v_lshlrev_b32 v72, 16, v156
    v_and_b32 v73, 0xffff0000, v156
    v_lshlrev_b32 v74, 16, v157
    v_and_b32 v75, 0xffff0000, v157
    v_pk_add_f32 v[40:41], v[40:41], v[172:173] op_sel_hi:[1,0]
    v_pk_add_f32 v[42:43], v[42:43], v[172:173] op_sel_hi:[1,0]
    v_pk_mul_f32 v[40:41], v[40:41], v[72:73]
    v_pk_mul_f32 v[42:43], v[42:43], v[74:75]
    v_cvt_pk_bf16_f32 v92, v36, v37
    v_cvt_pk_bf16_f32 v93, v38, v39
    v_cvt_pk_bf16_f32 v94, v40, v41
    v_cvt_pk_bf16_f32 v95, v42, v43
    s_nop 1
    v_permlane16_swap_b32 v92, v94
    v_permlane16_swap_b32 v93, v95
    buffer_store_dwordx4 v[92:95], v4, s[40:43], s7 offen offset:0 sc1
    v_lshlrev_b32 v72, 16, v168
    v_and_b32 v73, 0xffff0000, v168
    v_lshlrev_b32 v74, 16, v169
    v_and_b32 v75, 0xffff0000, v169
    v_pk_add_f32 v[64:65], v[64:65], v[174:175] op_sel_hi:[1,0]
    v_pk_add_f32 v[66:67], v[66:67], v[174:175] op_sel_hi:[1,0]
    v_pk_mul_f32 v[64:65], v[64:65], v[72:73]
    v_pk_mul_f32 v[66:67], v[66:67], v[74:75]
    v_lshlrev_b32 v72, 16, v170
    v_and_b32 v73, 0xffff0000, v170
    v_lshlrev_b32 v74, 16, v171
    v_and_b32 v75, 0xffff0000, v171
    v_pk_add_f32 v[68:69], v[68:69], v[174:175] op_sel_hi:[1,0]
    v_pk_add_f32 v[70:71], v[70:71], v[174:175] op_sel_hi:[1,0]
    v_pk_mul_f32 v[68:69], v[68:69], v[72:73]
    v_pk_mul_f32 v[70:71], v[70:71], v[74:75]
    v_cvt_pk_bf16_f32 v96, v64, v65
    v_cvt_pk_bf16_f32 v97, v66, v67
    v_cvt_pk_bf16_f32 v98, v68, v69
    v_cvt_pk_bf16_f32 v99, v70, v71
    s_nop 1
    v_permlane16_swap_b32 v96, v98
    v_permlane16_swap_b32 v97, v99
    buffer_store_dwordx4 v[96:99], v4, s[40:43], s7 offen offset:1024 sc1
    v_lshlrev_b32 v72, 16, v144
    v_and_b32 v73, 0xffff0000, v144
    v_lshlrev_b32 v74, 16, v145
    v_and_b32 v75, 0xffff0000, v145
    v_pk_add_f32 v[16:17], v[16:17], v[172:173] op_sel_hi:[1,0]
    v_pk_add_f32 v[18:19], v[18:19], v[172:173] op_sel_hi:[1,0]
    v_pk_mul_f32 v[16:17], v[16:17], v[72:73]
    v_pk_mul_f32 v[18:19], v[18:19], v[74:75]
    v_lshlrev_b32 v72, 16, v158
    v_and_b32 v73, 0xffff0000, v158
    v_lshlrev_b32 v74, 16, v159
    v_and_b32 v75, 0xffff0000, v159
    v_pk_add_f32 v[44:45], v[44:45], v[174:175] op_sel_hi:[1,0]
    v_pk_add_f32 v[46:47], v[46:47], v[174:175] op_sel_hi:[1,0]
    v_pk_mul_f32 v[44:45], v[44:45], v[72:73]
    v_pk_mul_f32 v[46:47], v[46:47], v[74:75]
    v_cvt_pk_bf16_f32 v100, v16, v17
    v_cvt_pk_bf16_f32 v101, v18, v19
    v_cvt_pk_bf16_f32 v102, v44, v45
    v_cvt_pk_bf16_f32 v103, v46, v47
    s_nop 1
    v_permlane16_swap_b32 v100, v102
    v_permlane16_swap_b32 v101, v103
    s_add_u32 s7, s6, 24576
    buffer_store_dwordx4 v[100:103], v5, s[40:43], s7 offen offset:512 sc1
L_eex:
    v_mov_b32 v3, 1
    s_waitcnt vmcnt(0)
    s_mov_b64 exec, 1
    ds_add_u32 v254, v3 offset:40
    s_mov_b64 exec, -1
    s_add_u32 s16, s84, 20971520
    s_addc_u32 s17, s85, 0
    s_mov_b32 s18, 4194304
    s_mov_b32 s19, 0x20000
    s_add_u32 s40, s80, 0
    s_addc_u32 s41, s81, 0
    s_mov_b32 s42, 4194304
    s_mov_b32 s43, 0x20000
    s_add_u32 s44, s84, 59768832
    s_addc_u32 s45, s85, 0
    s_mov_b32 s46, 32768
    s_mov_b32 s47, 0x20000
    v_and_b32 v13, 1, v2
    v_lshlrev_b32 v13, 5, v13
    v_lshrrev_b32 v3, 1, v2
    v_lshl_add_u32 v13, v3, 4, v13
    v_lshl_add_u32 v13, v1, 11, v13
    v_add_u32 v14, 32768, v13
    s_lshl_b32 s38, s4, 18
    s_lshl_b32 s6, s3, 16
    s_add_u32 s38, s38, s6
    s_lshl_b32 s6, s5, 7
    s_add_u32 s38, s38, s6
    s_lshl_b32 s50, s4, 18
    s_lshl_b32 s6, s5, 14
    s_add_u32 s50, s50, s6
    s_lshl_b32 s6, s3, 11
    s_add_u32 s50, s50, s6
    s_add_u32 s51, s50, 8192
    v_and_b32 v15, 1, v2
    v_lshlrev_b32 v15, 5, v15
    v_lshrrev_b32 v3, 1, v2
    v_lshl_add_u32 v15, v3, 4, v15
    v_lshlrev_b32 v15, 4, v15
    v_lshl_add_u32 v15, v1, 4, v15
    buffer_load_dwordx4 v[96:99], v15, s[16:19], s50 offen offset:0 sc1
    buffer_load_dwordx4 v[100:103], v15, s[16:19], s51 offen offset:0 sc1
    buffer_load_dwordx4 v[104:107], v15, s[16:19], s50 offen offset:1024 sc1
    buffer_load_dwordx4 v[108:111], v15, s[16:19], s51 offen offset:1024 sc1
    s_and_b32 s31, s3, 0
    s_lshr_b32 s30, s3, 0
    v_lshrrev_b32 v3, 1, v1
    v_xor_b32 v3, v3, v2
    v_lshlrev_b32 v3, 4, v3
    v_lshl_add_u32 v3, v1, 7, v3
    s_mul_i32 s6, s30, 4096
    v_add_u32 v4, s6, v3
    v_xor_b32 v5, 64, v4
    s_mul_i32 s6, s30, 2048
    v_lshl_add_u32 v4, v0, 4, s6
    v_add_u32 v5, 8192, v4
    v_lshrrev_b32 v10, 2, v1
    v_lshl_add_u32 v11, v2, 3, v10
    v_mul_u32_u24 v11, 128, v11
    v_and_b32 v12, 3, v0
    v_lshl_add_u32 v11, v12, 3, v11
    v_add_u32 v11, 16384, v11
    v_and_b32 v12, 1, v2
    v_lshrrev_b32 v10, 1, v10
    v_lshl_add_u32 v12, v12, 1, v10
    s_mul_i32 s6, s31, 4
    s_add_u32 s6, s6, 0
    v_xor_b32 v10, s6, v12
    v_lshl_add_u32 v6, v10, 5, v11
    s_mul_i32 s6, s31, 4
    s_add_u32 s6, s6, 1
    v_xor_b32 v10, s6, v12
    v_lshl_add_u32 v7, v10, 5, v11
    s_mul_i32 s6, s31, 4
    s_add_u32 s6, s6, 2
    v_xor_b32 v10, s6, v12
    v_lshl_add_u32 v8, v10, 5, v11
    s_mul_i32 s6, s31, 4
    s_add_u32 s6, s6, 3
    v_xor_b32 v10, s6, v12
    v_lshl_add_u32 v9, v10, 5, v11
    v_mov_b32 v16, 0
    v_mov_b32 v17, 0
    v_mov_b32 v18, 0
    v_mov_b32 v19, 0
    v_mov_b32 v20, 0
    v_mov_b32 v21, 0
    v_mov_b32 v22, 0
    v_mov_b32 v23, 0
    v_mov_b32 v24, 0
    v_mov_b32 v25, 0
    v_mov_b32 v26, 0
    v_mov_b32 v27, 0
    v_mov_b32 v28, 0
    v_mov_b32 v29, 0
    v_mov_b32 v30, 0
    v_mov_b32 v31, 0
    v_mov_b32 v32, 0
    v_mov_b32 v33, 0
    v_mov_b32 v34, 0
    v_mov_b32 v35, 0
    v_mov_b32 v36, 0
    v_mov_b32 v37, 0
    v_mov_b32 v38, 0
    v_mov_b32 v39, 0
    v_mov_b32 v40, 0
    v_mov_b32 v41, 0
    v_mov_b32 v42, 0
    v_mov_b32 v43, 0
    v_mov_b32 v44, 0
    v_mov_b32 v45, 0
    v_mov_b32 v46, 0
    v_mov_b32 v47, 0
    s_mov_b32 s32, 0
    s_barrier
    ds_read_b128 v[48:51], v4 offset:0
    ds_read_b128 v[52:55], v4 offset:1024
    ds_read_b64_tr_b16 v[56:57], v6 offset:0
    ds_read_b64_tr_b16 v[58:59], v6 offset:512
    ds_read_b64_tr_b16 v[60:61], v7 offset:0
    ds_read_b64_tr_b16 v[62:63], v7 offset:512
    ds_read_b64_tr_b16 v[64:65], v8 offset:0
    ds_read_b64_tr_b16 v[66:67], v8 offset:512
    ds_read_b64_tr_b16 v[68:69], v9 offset:0
    ds_read_b64_tr_b16 v[70:71], v9 offset:512
    s_mov_b32 s36, 28
    s_branch L_fmid
    .p2align 4
L_floop:
    s_barrier
    v_mfma_f32_16x16x32_bf16 v[16:19], v[80:83], v[72:75], v[16:19]
    ds_read_b128 v[48:51], v4 offset:0
    ds_read_b128 v[52:55], v4 offset:1024
    ds_read_b64_tr_b16 v[56:57], v6 offset:0
    v_mfma_f32_16x16x32_bf16 v[32:35], v[80:83], v[76:79], v[32:35]
    ds_read_b64_tr_b16 v[58:59], v6 offset:512
    ds_read_b64_tr_b16 v[60:61], v7 offset:0
    ds_read_b64_tr_b16 v[62:63], v7 offset:512
    v_mfma_f32_16x16x32_bf16 v[20:23], v[84:87], v[72:75], v[20:23]
    ds_read_b64_tr_b16 v[64:65], v8 offset:0
    ds_read_b64_tr_b16 v[66:67], v8 offset:512
    ds_read_b64_tr_b16 v[68:69], v9 offset:0
    v_mfma_f32_16x16x32_bf16 v[36:39], v[84:87], v[76:79], v[36:39]
    ds_read_b64_tr_b16 v[70:71], v9 offset:512
    v_mfma_f32_16x16x32_bf16 v[24:27], v[88:91], v[72:75], v[24:27]
    v_mfma_f32_16x16x32_bf16 v[40:43], v[88:91], v[76:79], v[40:43]
    v_mfma_f32_16x16x32_bf16 v[28:31], v[92:95], v[72:75], v[28:31]
    v_mfma_f32_16x16x32_bf16 v[44:47], v[92:95], v[76:79], v[44:47]
L_fmid:
    s_waitcnt lgkmcnt(0)
    v_mfma_f32_16x16x32_bf16 v[16:19], v[56:59], v[48:51], v[16:19]
    ds_read_b128 v[72:75], v5 offset:0
    ds_read_b128 v[76:79], v5 offset:1024
    ds_read_b64_tr_b16 v[80:81], v6 offset:4096
    v_mfma_f32_16x16x32_bf16 v[32:35], v[56:59], v[52:55], v[32:35]
    ds_read_b64_tr_b16 v[82:83], v6 offset:4608
    ds_read_b64_tr_b16 v[84:85], v7 offset:4096
    ds_read_b64_tr_b16 v[86:87], v7 offset:4608
    v_mfma_f32_16x16x32_bf16 v[20:23], v[60:63], v[48:51], v[20:23]
    ds_read_b64_tr_b16 v[88:89], v8 offset:4096
    ds_read_b64_tr_b16 v[90:91], v8 offset:4608
    ds_read_b64_tr_b16 v[92:93], v9 offset:4096
    v_mfma_f32_16x16x32_bf16 v[36:39], v[60:63], v[52:55], v[36:39]
    ds_read_b64_tr_b16 v[94:95], v9 offset:4608
    v_mfma_f32_16x16x32_bf16 v[24:27], v[64:67], v[48:51], v[24:27]
    s_add_u32 s32, s32, 1
    s_cmp_eq_u32 s32, 6
    v_mfma_f32_16x16x32_bf16 v[40:43], v[64:67], v[52:55], v[40:43]
    s_mov_b32 s6, 24576
    s_cselect_b32 s6, -122880, s6
    v_mfma_f32_16x16x32_bf16 v[28:31], v[68:71], v[48:51], v[28:31]
    s_cselect_b32 s32, 0, s32
    v_add_u32 v4, s6, v4
    v_mfma_f32_16x16x32_bf16 v[44:47], v[68:71], v[52:55], v[44:47]
    v_add_u32 v5, s6, v5
    v_add_u32 v6, s6, v6
    v_add_u32 v7, s6, v7
    v_add_u32 v8, s6, v8
    v_add_u32 v9, s6, v9
    s_sub_u32 s36, s36, 1
    s_cmp_lg_u32 s36, 0
    s_waitcnt lgkmcnt(0)
    s_cbranch_scc1 L_floop
    s_barrier
    v_mfma_f32_16x16x32_bf16 v[16:19], v[80:83], v[72:75], v[16:19]
    v_mfma_f32_16x16x32_bf16 v[32:35], v[80:83], v[76:79], v[32:35]
    v_mfma_f32_16x16x32_bf16 v[20:23], v[84:87], v[72:75], v[20:23]
    v_mfma_f32_16x16x32_bf16 v[36:39], v[84:87], v[76:79], v[36:39]
    v_mfma_f32_16x16x32_bf16 v[24:27], v[88:91], v[72:75], v[24:27]
    v_mfma_f32_16x16x32_bf16 v[40:43], v[88:91], v[76:79], v[40:43]
    v_mfma_f32_16x16x32_bf16 v[28:31], v[92:95], v[72:75], v[28:31]
    v_mfma_f32_16x16x32_bf16 v[44:47], v[92:95], v[76:79], v[44:47]
    s_nop 7
    v_lshrrev_b32 v4, 3, v1
    v_mul_u32_u24 v4, 16320, v4
    v_sub_u32 v13, v13, v4
    v_sub_u32 v14, v14, v4
    s_add_u32 s39, s38, 16384
    s_waitcnt vmcnt(0)
    v_permlane16_swap_b32 v96, v98
    v_permlane16_swap_b32 v97, v99
    v_lshlrev_b32 v48, 16, v96
    v_and_b32 v49, 0xffff0000, v96
    v_lshlrev_b32 v50, 16, v97
    v_and_b32 v51, 0xffff0000, v97
    v_lshlrev_b32 v52, 16, v98
    v_and_b32 v53, 0xffff0000, v98
    v_lshlrev_b32 v54, 16, v99
    v_and_b32 v55, 0xffff0000, v99
    v_pk_add_f32 v[16:17], v[16:17], v[48:49]
    v_pk_add_f32 v[18:19], v[18:19], v[50:51]
    v_pk_add_f32 v[20:21], v[20:21], v[52:53]
    v_pk_add_f32 v[22:23], v[22:23], v[54:55]
    v_cvt_pk_bf16_f32 v72, v16, v17
    v_cvt_pk_bf16_f32 v73, v18, v19
    v_cvt_pk_bf16_f32 v74, v20, v21
    v_cvt_pk_bf16_f32 v75, v22, v23
    s_nop 1
    v_permlane16_swap_b32 v72, v74
    v_permlane16_swap_b32 v73, v75
    v_permlane16_swap_b32 v100, v102
    v_permlane16_swap_b32 v101, v103
    v_lshlrev_b32 v48, 16, v100
    v_and_b32 v49, 0xffff0000, v100
    v_lshlrev_b32 v50, 16, v101
    v_and_b32 v51, 0xffff0000, v101
    v_lshlrev_b32 v52, 16, v102
    v_and_b32 v53, 0xffff0000, v102
    v_lshlrev_b32 v54, 16, v103
    v_and_b32 v55, 0xffff0000, v103
    v_pk_add_f32 v[24:25], v[24:25], v[48:49]
    v_pk_add_f32 v[26:27], v[26:27], v[50:51]
    v_pk_add_f32 v[28:29], v[28:29], v[52:53]
    v_pk_add_f32 v[30:31], v[30:31], v[54:55]
    v_cvt_pk_bf16_f32 v76, v24, v25
    v_cvt_pk_bf16_f32 v77, v26, v27
    v_cvt_pk_bf16_f32 v78, v28, v29
    v_cvt_pk_bf16_f32 v79, v30, v31
    s_nop 1
    v_permlane16_swap_b32 v76, v78
    v_permlane16_swap_b32 v77, v79
    v_mov_b32 v48, v72
    v_mov_b32 v49, v73
    v_mov_b32 v50, v74
    v_mov_b32 v51, v75
    v_mov_b32_dpp v72, v76 row_ror:8 row_mask:0xf bank_mask:0xc
    v_mov_b32_dpp v73, v77 row_ror:8 row_mask:0xf bank_mask:0xc
    v_mov_b32_dpp v74, v78 row_ror:8 row_mask:0xf bank_mask:0xc
    v_mov_b32_dpp v75, v79 row_ror:8 row_mask:0xf bank_mask:0xc
    v_mov_b32_dpp v76, v48 row_ror:8 row_mask:0xf bank_mask:0x3
    v_mov_b32_dpp v77, v49 row_ror:8 row_mask:0xf bank_mask:0x3
    v_mov_b32_dpp v78, v50 row_ror:8 row_mask:0xf bank_mask:0x3
    v_mov_b32_dpp v79, v51 row_ror:8 row_mask:0xf bank_mask:0x3
    buffer_store_dwordx4 v[72:75], v13, s[40:43], s38 offen nt
    buffer_store_dwordx4 v[76:79], v13, s[40:43], s39 offen nt
    v_permlane16_swap_b32 v104, v106
    v_permlane16_swap_b32 v105, v107
    v_lshlrev_b32 v48, 16, v104
    v_and_b32 v49, 0xffff0000, v104
    v_lshlrev_b32 v50, 16, v105
    v_and_b32 v51, 0xffff0000, v105
    v_lshlrev_b32 v52, 16, v106
    v_and_b32 v53, 0xffff0000, v106
    v_lshlrev_b32 v54, 16, v107
    v_and_b32 v55, 0xffff0000, v107
    v_pk_add_f32 v[32:33], v[32:33], v[48:49]
    v_pk_add_f32 v[34:35], v[34:35], v[50:51]
    v_pk_add_f32 v[36:37], v[36:37], v[52:53]
    v_pk_add_f32 v[38:39], v[38:39], v[54:55]
    v_cvt_pk_bf16_f32 v80, v32, v33
    v_cvt_pk_bf16_f32 v81, v34, v35
    v_cvt_pk_bf16_f32 v82, v36, v37
    v_cvt_pk_bf16_f32 v83, v38, v39
    s_nop 1
    v_permlane16_swap_b32 v80, v82
    v_permlane16_swap_b32 v81, v83
    v_permlane16_swap_b32 v108, v110
    v_permlane16_swap_b32 v109, v111
    v_lshlrev_b32 v48, 16, v108
    v_and_b32 v49, 0xffff0000, v108
    v_lshlrev_b32 v50, 16, v109
    v_and_b32 v51, 0xffff0000, v109
    v_lshlrev_b32 v52, 16, v110
    v_and_b32 v53, 0xffff0000, v110
    v_lshlrev_b32 v54, 16, v111
    v_and_b32 v55, 0xffff0000, v111
    v_pk_add_f32 v[40:41], v[40:41], v[48:49]
    v_pk_add_f32 v[42:43], v[42:43], v[50:51]
    v_pk_add_f32 v[44:45], v[44:45], v[52:53]
    v_pk_add_f32 v[46:47], v[46:47], v[54:55]
    v_cvt_pk_bf16_f32 v84, v40, v41
    v_cvt_pk_bf16_f32 v85, v42, v43
    v_cvt_pk_bf16_f32 v86, v44, v45
    v_cvt_pk_bf16_f32 v87, v46, v47
    s_nop 1
    v_permlane16_swap_b32 v84, v86
    v_permlane16_swap_b32 v85, v87
    v_mov_b32 v48, v80
    v_mov_b32 v49, v81
    v_mov_b32 v50, v82
    v_mov_b32 v51, v83
    v_mov_b32_dpp v80, v84 row_ror:8 row_mask:0xf bank_mask:0xc
    v_mov_b32_dpp v81, v85 row_ror:8 row_mask:0xf bank_mask:0xc
    v_mov_b32_dpp v82, v86 row_ror:8 row_mask:0xf bank_mask:0xc
    v_mov_b32_dpp v83, v87 row_ror:8 row_mask:0xf bank_mask:0xc
    v_mov_b32_dpp v84, v48 row_ror:8 row_mask:0xf bank_mask:0x3
    v_mov_b32_dpp v85, v49 row_ror:8 row_mask:0xf bank_mask:0x3
    v_mov_b32_dpp v86, v50 row_ror:8 row_mask:0xf bank_mask:0x3
    v_mov_b32_dpp v87, v51 row_ror:8 row_mask:0xf bank_mask:0x3
    buffer_store_dwordx4 v[80:83], v14, s[40:43], s38 offen nt
    buffer_store_dwordx4 v[84:87], v14, s[40:43], s39 offen nt
L_end:
    s_endpgm
.section .rodata,"a"
.p2align 6
.amdhsa_kernel sequential_preLN__sliding_block__mixer_gmlp__prompt_kernel
  .amdhsa_next_free_vgpr 256
  .amdhsa_next_free_sgpr 102
  .amdhsa_accum_offset 256
  .amdhsa_group_segment_fixed_size 0
  .amdhsa_kernarg_size 88
  .amdhsa_user_sgpr_count 2
  .amdhsa_user_sgpr_kernarg_segment_ptr 1
  .amdhsa_system_sgpr_workgroup_id_x 1
.end_amdhsa_kernel
```
